```python
import torch

def _softmax(x, axis=-1):
    return torch.softmax(x, dim=axis)
def _gelu(x):
    return torch.nn.functional.gelu(x, approximate="tanh")
def _silu(x):
    return torch.nn.functional.silu(x)
def _sigmoid(x):
    return torch.sigmoid(x)
def _layernorm(x, axis=-1, eps=1e-5):
    m = x.mean(dim=axis, keepdim=True)
    v = x.var(dim=axis, keepdim=True, unbiased=False)
    return (x - m) / torch.sqrt(v + eps)
def _scatter_add(tgt, idx, src, axis=0):
    return tgt.clone().index_add_(axis, idx, src)
def _segment_sum(src, seg, n):
    out = torch.zeros((n,) + src.shape[1:], dtype=src.dtype)
    return out.index_add_(0, seg, src)
def _pad(x, pw):
    flat = tuple(v for pair in reversed(pw) for v in pair)
    return torch.nn.functional.pad(x, flat)

kernel_name = 'concat_heads__mha_block_cached__mha_block_cached__near_ridge'

def setup_inputs():

    _w = (lambda a: (lambda t: t.to(torch.bfloat16) if t.is_floating_point() else t)(torch.as_tensor(a)))
    def _A_setup():
        B, Sq, D = 16, 128, 512
        H, Sk, Dh = 32, 512, 128
        return {
            "x": _w((lambda *s: torch.randn(*s, dtype=torch.bfloat16) * 0.8)(B, Sq, D)),
            "k_cache": _w((lambda *s: torch.randn(*s, dtype=torch.bfloat16) * 0.8)(B, H, Sk, Dh)),
            "v_cache": _w((lambda *s: torch.randn(*s, dtype=torch.bfloat16) * 0.05)(B, H, Sk, Dh)),
            "wq": _w((lambda *s: torch.randn(*s, dtype=torch.bfloat16) * 0.8)(D, H * Dh) * (D ** -0.5)),
            "wo": _w((lambda *s: torch.randn(*s, dtype=torch.bfloat16) * 0.05)(H * Dh, D) * ((H * Dh) ** -0.5)),
        }
    _A_in = _A_setup()

    def _B_setup():
        B, Sq, D = 16, 128, 512
        H, Sk, Dh = 32, 512, 128
        return {
            "x": _w((lambda *s: torch.randn(*s, dtype=torch.bfloat16) * 0.8)(B, Sq, D)),
            "k_cache": _w((lambda *s: torch.randn(*s, dtype=torch.bfloat16) * 0.8)(B, H, Sk, Dh)),
            "v_cache": _w((lambda *s: torch.randn(*s, dtype=torch.bfloat16) * 0.05)(B, H, Sk, Dh)),
            "wq": _w((lambda *s: torch.randn(*s, dtype=torch.bfloat16) * 0.8)(D, H * Dh) * (D ** -0.5)),
            "wo": _w((lambda *s: torch.randn(*s, dtype=torch.bfloat16) * 0.05)(H * Dh, D) * ((H * Dh) ** -0.5)),
        }
    _B_in = _B_setup()

    return {
        "A_x": _A_in["x"],
        "A_k_cache": _A_in["k_cache"],
        "A_v_cache": _A_in["v_cache"],
        "A_wq": _A_in["wq"],
        "A_wo": _A_in["wo"],
        "B_x": _B_in["x"],
        "B_k_cache": _B_in["k_cache"],
        "B_v_cache": _B_in["v_cache"],
        "B_wq": _B_in["wq"],
        "B_wo": _B_in["wo"],
    }

def reference(A_x, A_k_cache, A_v_cache, A_wq, A_wo, B_x, B_k_cache, B_v_cache, B_wq, B_wo):
    def _A_ref(x, k_cache, v_cache, wq, wo):
        B, Sq, D = x.shape
        H, Dh = 32, 128
        q = (lambda x, *d: x.permute(*d))((x @ wq).reshape(B, Sq, H, Dh), 0, 2, 1, 3)
        scores = torch.einsum("bhqd,bhkd->bhqk", q, k_cache) * (Dh ** -0.5)
        p = _softmax(scores, axis=-1)
        o = torch.einsum("bhqk,bhkd->bhqd", p, v_cache)
        return (lambda x, *d: x.permute(*d))(o, 0, 2, 1, 3).reshape(B, Sq, H * Dh) @ wo

    def _B_ref(x, k_cache, v_cache, wq, wo):
        B, Sq, D = x.shape
        H, Dh = 32, 128
        q = (lambda x, *d: x.permute(*d))((x @ wq).reshape(B, Sq, H, Dh), 0, 2, 1, 3)
        scores = torch.einsum("bhqd,bhkd->bhqk", q, k_cache) * (Dh ** -0.5)
        p = _softmax(scores, axis=-1)
        o = torch.einsum("bhqk,bhkd->bhqd", p, v_cache)
        return (lambda x, *d: x.permute(*d))(o, 0, 2, 1, 3).reshape(B, Sq, H * Dh) @ wo

    a = _A_ref(A_x, A_k_cache, A_v_cache, A_wq, A_wo)
    b = _B_ref(B_x, B_k_cache, B_v_cache, B_wq, B_wo)
    return torch.concatenate([a, b], axis=-1)
```

```asm
; @launch grid=(256,1,1) block=(512,1,1) lds=163840
.amdgcn_target "amdgcn-amd-amdhsa--gfx950"
.text
.globl concat_heads__mha_block_cached__mha_block_cached__near_ridge_kernel
.p2align 8
.type concat_heads__mha_block_cached__mha_block_cached__near_ridge_kernel,@function
concat_heads__mha_block_cached__mha_block_cached__near_ridge_kernel:
    s_cmp_ge_u32 s2, 256
    s_cbranch_scc1 L_end
    s_load_dwordx8 s[72:79], s[0:1], 0
    s_load_dwordx8 s[80:87], s[0:1], 32
    s_load_dwordx4 s[88:91], s[0:1], 64
    s_load_dwordx2 s[92:93], s[0:1], 96
    s_load_dwordx4 s[96:99], s[0:1], 80
    v_lshrrev_b32 v1, 6, v0
    v_and_b32 v0, 63, v0
    v_readfirstlane_b32 s36, v1
    v_lshlrev_b32 v252, 4, v0
    s_nop 1
    s_and_b32 s37, s36, 3
    s_lshl_b32 s45, s37, 10
    s_getpc_b64 s[70:71]
L_pc:
    s_sub_u32 s70, s70, L_pc-concat_heads__mha_block_cached__mha_block_cached__near_ridge_kernel
    s_subb_u32 s71, s71, 0
    s_lshr_b32 s56, s36, 1
    s_cmp_lg_u32 s56, 2
    s_cbranch_scc1 L_nopf
    s_lshr_b32 s56, s2, 3
    s_lshl_b32 s56, s56, 11
    s_add_u32 s56, s56, s45
    s_min_u32 s56, s56, L_cold-concat_heads__mha_block_cached__mha_block_cached__near_ridge_kernel-1024
    v_add_u32 v5, s56, v252
    global_load_dwordx4 v[184:187], v5, s[70:71]
L_nopf:
    s_and_b32 s3, s2, 7
    s_lshr_b32 s4, s2, 3
    s_and_b32 s5, s4, 15
    s_and_b32 s6, s3, 4
    s_lshl_b32 s6, s6, 2
    s_add_u32 s5, s5, s6
    s_and_b32 s6, s3, 3
    s_lshl_b32 s6, s6, 1
    s_lshr_b32 s4, s4, 4
    s_add_u32 s6, s6, s4
    s_and_b32 s59, s5, 3
    s_and_b32 s7, s5, 15
    s_mov_b32 s4, 0
    s_and_b32 s4, s4, 7
    s_lshl_b32 s4, s4, 14
    s_lshl_b32 s51, s59, 17
    v_and_b32 v1, 15, v0
    v_lshrrev_b32 v2, 4, v0
    v_lshrrev_b32 v3, 2, v1
    v_and_b32 v4, 3, v0
    s_lshl_b32 s43, s59, 8
    s_mov_b32 s56, 0
    s_lshl_b32 s58, s56, 7
    s_lshl_b32 s56, s56, 19
    s_add_u32 s43, s43, s56
    v_lshrrev_b32 v5, 3, v0
    v_bfe_u32 v6, v0, 4, 1
    s_and_b32 s44, s37, 1
    s_lshl_b32 s44, s44, 1
    v_or_b32 v6, s44, v6
    v_lshlrev_b32 v6, 1, v6
    v_and_b32 v7, 7, v0
    v_xor_b32 v6, v6, v7
    v_lshlrev_b32 v6, 4, v6
    s_lshl_b32 s44, s37, 3
    v_add_u32 v7, s44, v5
    v_lshl_add_u32 v244, v7, 13, v6
    v_lshrrev_b32 v5, 3, v0
    v_and_b32 v6, 7, v0
    v_xor_b32 v6, v6, v2
    v_lshlrev_b32 v6, 4, v6
    s_lshl_b32 s44, s37, 5
    v_add_u32 v5, s44, v5
    v_lshl_add_u32 v247, v5, 10, v6
    s_lshl_b32 s53, s37, 12
    s_waitcnt lgkmcnt(0)
    s_cmp_ge_u32 s5, 16
    s_cselect_b32 s72, s82, s72
    s_cselect_b32 s73, s83, s73
    s_cselect_b32 s78, s88, s78
    s_cselect_b32 s79, s89, s79
    s_lshl_b32 s56, s6, 10
    s_add_u32 s16, s78, s56
    s_addc_u32 s17, s79, 0
    s_sub_u32 s18, 0x400000, s56
    s_mov_b32 s19, 0x20000
    s_lshl_b32 s56, s7, 17
    s_add_u32 s24, s72, s56
    s_addc_u32 s25, s73, 0
    s_mov_b32 s26, 131072
    s_mov_b32 s27, 0x20000
    s_cmp_ge_u32 s36, 4
    s_cbranch_scc1 L_P
    s_add_u32 m0, s45, 131072
    s_add_u32 s44, s43, 0
    s_and_b32 s44, s44, 0x3fffff
    buffer_load_dwordx4 v244, s[16:19], s44 offen lds
    s_add_u32 m0, s45, 135168
    s_add_u32 s44, s43, 262144
    s_and_b32 s44, s44, 0x3fffff
    buffer_load_dwordx4 v244, s[16:19], s44 offen lds
    s_add_u32 m0, s45, 139264
    s_add_u32 s44, s43, 128
    s_and_b32 s44, s44, 0x3fffff
    buffer_load_dwordx4 v244, s[16:19], s44 offen lds
    s_add_u32 m0, s45, 143360
    s_add_u32 s44, s43, 262272
    s_and_b32 s44, s44, 0x3fffff
    buffer_load_dwordx4 v244, s[16:19], s44 offen lds
    s_add_u32 m0, s53, 147456
    s_add_u32 s44, s58, 0
    s_and_b32 s44, s44, 1023
    buffer_load_dwordx4 v247, s[24:27], s44 offen lds
    s_add_u32 m0, m0, 1024
    s_add_u32 s44, s44, 8192
    buffer_load_dwordx4 v247, s[24:27], s44 offen lds
    s_add_u32 m0, m0, 1024
    s_add_u32 s44, s44, 8192
    buffer_load_dwordx4 v247, s[24:27], s44 offen lds
    s_add_u32 m0, m0, 1024
    s_add_u32 s44, s44, 8192
    buffer_load_dwordx4 v247, s[24:27], s44 offen lds
    s_add_u32 m0, s45, 32768
    s_add_u32 s44, s43, 524288
    s_and_b32 s44, s44, 0x3fffff
    buffer_load_dwordx4 v244, s[16:19], s44 offen lds
    s_add_u32 m0, s45, 36864
    s_add_u32 s44, s43, 786432
    s_and_b32 s44, s44, 0x3fffff
    buffer_load_dwordx4 v244, s[16:19], s44 offen lds
    s_add_u32 m0, s45, 40960
    s_add_u32 s44, s43, 524416
    s_and_b32 s44, s44, 0x3fffff
    buffer_load_dwordx4 v244, s[16:19], s44 offen lds
    s_add_u32 m0, s45, 45056
    s_add_u32 s44, s43, 786560
    s_and_b32 s44, s44, 0x3fffff
    buffer_load_dwordx4 v244, s[16:19], s44 offen lds
    s_add_u32 m0, s53, 49152
    s_add_u32 s44, s58, 128
    s_and_b32 s44, s44, 1023
    buffer_load_dwordx4 v247, s[24:27], s44 offen lds
    s_add_u32 m0, m0, 1024
    s_add_u32 s44, s44, 8192
    buffer_load_dwordx4 v247, s[24:27], s44 offen lds
    s_add_u32 m0, m0, 1024
    s_add_u32 s44, s44, 8192
    buffer_load_dwordx4 v247, s[24:27], s44 offen lds
    s_add_u32 m0, m0, 1024
    s_add_u32 s44, s44, 8192
    buffer_load_dwordx4 v247, s[24:27], s44 offen lds
    s_cmp_ge_u32 s5, 16
    s_cselect_b32 s74, s84, s74
    s_cselect_b32 s75, s85, s75
    s_cselect_b32 s76, s86, s76
    s_cselect_b32 s77, s87, s77
    s_cselect_b32 s80, s90, s80
    s_cselect_b32 s81, s91, s81
    s_lshl_b32 s56, s7, 22
    s_lshl_b32 s57, s6, 19
    s_add_u32 s56, s56, s57
    s_add_u32 s8, s74, s56
    s_addc_u32 s9, s75, 0
    s_mov_b32 s10, 524288
    s_mov_b32 s11, 0x20000
    s_add_u32 s12, s76, s56
    s_addc_u32 s13, s77, 0
    s_mov_b32 s14, 524288
    s_mov_b32 s15, 0x20000
    s_add_u32 s20, s80, s57
    s_addc_u32 s21, s81, 0
    s_mov_b32 s22, 524288
    s_mov_b32 s23, 0x20000
    s_lshl_b32 s56, s5, 21
    s_add_u32 s56, s56, 0x100000
    s_add_u32 s32, s92, s56
    s_addc_u32 s33, s93, 0
    s_mov_b32 s34, 1048576
    s_mov_b32 s35, 0x20000
    s_lshl_b32 s56, s5, 3
    s_add_u32 s76, s98, s56
    s_addc_u32 s77, s99, 0
    s_mov_b32 s78, 4
    s_mov_b32 s79, 0x20000
    s_lshl_b32 s56, s7, 18
    s_lshl_b32 s57, s6, 15
    s_add_u32 s56, s56, s57
    s_lshr_b32 s57, s5, 4
    s_lshl_b32 s57, s57, 10
    s_add_u32 s56, s56, s57
    s_add_u32 s80, s96, s56
    s_addc_u32 s81, s97, 0
    s_mov_b32 s82, 0
    s_mov_b32 s83, 0x20000
    s_sub_u32 s82, 0x400000, s56
    s_lshl_b32 s44, s37, 2
    v_add_u32 v5, s44, v2
    v_xor_b32 v6, v5, v1
    v_lshlrev_b32 v6, 4, v6
    s_lshl_b32 s44, s37, 4
    v_add_u32 v7, s44, v2
    v_lshlrev_b32 v7, 8, v7
    v_add_u32 v242, v7, v6
    v_and_b32 v5, 7, v5
    v_lshlrev_b32 v5, 1, v5
    v_xor_b32 v6, v5, v1
    v_lshlrev_b32 v6, 4, v6
    v_add_u32 v243, v7, v6
    s_mov_b32 s47, s45
    s_waitcnt vmcnt(8)
    s_barrier
    s_add_u32 m0, s45, 98304
    s_add_u32 s44, s43, 1048576
    s_and_b32 s44, s44, 0x3fffff
    buffer_load_dwordx4 v244, s[16:19], s44 offen lds
    s_add_u32 m0, s45, 102400
    s_add_u32 s44, s43, 1310720
    s_and_b32 s44, s44, 0x3fffff
    buffer_load_dwordx4 v244, s[16:19], s44 offen lds
    s_add_u32 m0, s45, 106496
    s_add_u32 s44, s43, 1048704
    s_and_b32 s44, s44, 0x3fffff
    buffer_load_dwordx4 v244, s[16:19], s44 offen lds
    s_add_u32 m0, s45, 110592
    s_add_u32 s44, s43, 1310848
    s_and_b32 s44, s44, 0x3fffff
    buffer_load_dwordx4 v244, s[16:19], s44 offen lds
    s_add_u32 m0, s53, 114688
    s_add_u32 s44, s58, 256
    s_and_b32 s44, s44, 1023
    buffer_load_dwordx4 v247, s[24:27], s44 offen lds
    s_add_u32 m0, m0, 1024
    s_add_u32 s44, s44, 8192
    buffer_load_dwordx4 v247, s[24:27], s44 offen lds
    s_add_u32 m0, m0, 1024
    s_add_u32 s44, s44, 8192
    buffer_load_dwordx4 v247, s[24:27], s44 offen lds
    s_add_u32 m0, m0, 1024
    s_add_u32 s44, s44, 8192
    buffer_load_dwordx4 v247, s[24:27], s44 offen lds
    s_waitcnt vmcnt(8)
    s_barrier
    s_add_u32 m0, s45, 65536
    s_add_u32 s44, s43, 1572864
    s_and_b32 s44, s44, 0x3fffff
    buffer_load_dwordx4 v244, s[16:19], s44 offen lds
    s_add_u32 m0, s45, 69632
    s_add_u32 s44, s43, 1835008
    s_and_b32 s44, s44, 0x3fffff
    buffer_load_dwordx4 v244, s[16:19], s44 offen lds
    s_add_u32 m0, s45, 73728
    s_add_u32 s44, s43, 1572992
    s_and_b32 s44, s44, 0x3fffff
    buffer_load_dwordx4 v244, s[16:19], s44 offen lds
    s_add_u32 m0, s45, 77824
    s_add_u32 s44, s43, 1835136
    s_and_b32 s44, s44, 0x3fffff
    buffer_load_dwordx4 v244, s[16:19], s44 offen lds
    s_add_u32 m0, s53, 81920
    s_add_u32 s44, s58, 384
    s_and_b32 s44, s44, 1023
    buffer_load_dwordx4 v247, s[24:27], s44 offen lds
    s_add_u32 m0, m0, 1024
    s_add_u32 s44, s44, 8192
    buffer_load_dwordx4 v247, s[24:27], s44 offen lds
    s_add_u32 m0, m0, 1024
    s_add_u32 s44, s44, 8192
    buffer_load_dwordx4 v247, s[24:27], s44 offen lds
    s_add_u32 m0, m0, 1024
    s_add_u32 s44, s44, 8192
    buffer_load_dwordx4 v247, s[24:27], s44 offen lds
    s_waitcnt vmcnt(8)
    s_barrier
    s_add_u32 m0, s45, 0
    s_add_u32 s44, s43, 2097152
    s_and_b32 s44, s44, 0x3fffff
    buffer_load_dwordx4 v244, s[16:19], s44 offen lds
    s_add_u32 m0, s45, 4096
    s_add_u32 s44, s43, 2359296
    s_and_b32 s44, s44, 0x3fffff
    buffer_load_dwordx4 v244, s[16:19], s44 offen lds
    s_add_u32 m0, s45, 8192
    s_add_u32 s44, s43, 2097280
    s_and_b32 s44, s44, 0x3fffff
    buffer_load_dwordx4 v244, s[16:19], s44 offen lds
    s_add_u32 m0, s45, 12288
    s_add_u32 s44, s43, 2359424
    s_and_b32 s44, s44, 0x3fffff
    buffer_load_dwordx4 v244, s[16:19], s44 offen lds
    s_add_u32 m0, s53, 16384
    s_add_u32 s44, s58, 512
    s_and_b32 s44, s44, 1023
    buffer_load_dwordx4 v247, s[24:27], s44 offen lds
    s_add_u32 m0, m0, 1024
    s_add_u32 s44, s44, 8192
    buffer_load_dwordx4 v247, s[24:27], s44 offen lds
    s_add_u32 m0, m0, 1024
    s_add_u32 s44, s44, 8192
    buffer_load_dwordx4 v247, s[24:27], s44 offen lds
    s_add_u32 m0, m0, 1024
    s_add_u32 s44, s44, 8192
    buffer_load_dwordx4 v247, s[24:27], s44 offen lds
    s_waitcnt vmcnt(8)
    s_barrier
    s_add_u32 m0, s45, 131072
    s_add_u32 s44, s43, 2621440
    s_and_b32 s44, s44, 0x3fffff
    buffer_load_dwordx4 v244, s[16:19], s44 offen lds
    s_add_u32 m0, s45, 135168
    s_add_u32 s44, s43, 2883584
    s_and_b32 s44, s44, 0x3fffff
    buffer_load_dwordx4 v244, s[16:19], s44 offen lds
    s_add_u32 m0, s45, 139264
    s_add_u32 s44, s43, 2621568
    s_and_b32 s44, s44, 0x3fffff
    buffer_load_dwordx4 v244, s[16:19], s44 offen lds
    s_add_u32 m0, s45, 143360
    s_add_u32 s44, s43, 2883712
    s_and_b32 s44, s44, 0x3fffff
    buffer_load_dwordx4 v244, s[16:19], s44 offen lds
    s_add_u32 m0, s53, 147456
    s_add_u32 s44, s58, 640
    s_and_b32 s44, s44, 1023
    buffer_load_dwordx4 v247, s[24:27], s44 offen lds
    s_add_u32 m0, m0, 1024
    s_add_u32 s44, s44, 8192
    buffer_load_dwordx4 v247, s[24:27], s44 offen lds
    s_add_u32 m0, m0, 1024
    s_add_u32 s44, s44, 8192
    buffer_load_dwordx4 v247, s[24:27], s44 offen lds
    s_add_u32 m0, m0, 1024
    s_add_u32 s44, s44, 8192
    buffer_load_dwordx4 v247, s[24:27], s44 offen lds
    s_waitcnt vmcnt(8)
    s_barrier
    s_add_u32 m0, s45, 32768
    s_add_u32 s44, s43, 3145728
    s_and_b32 s44, s44, 0x3fffff
    buffer_load_dwordx4 v244, s[16:19], s44 offen lds
    s_add_u32 m0, s45, 36864
    s_add_u32 s44, s43, 3407872
    s_and_b32 s44, s44, 0x3fffff
    buffer_load_dwordx4 v244, s[16:19], s44 offen lds
    s_add_u32 m0, s45, 40960
    s_add_u32 s44, s43, 3145856
    s_and_b32 s44, s44, 0x3fffff
    buffer_load_dwordx4 v244, s[16:19], s44 offen lds
    s_add_u32 m0, s45, 45056
    s_add_u32 s44, s43, 3408000
    s_and_b32 s44, s44, 0x3fffff
    buffer_load_dwordx4 v244, s[16:19], s44 offen lds
    s_add_u32 m0, s53, 49152
    s_add_u32 s44, s58, 768
    s_and_b32 s44, s44, 1023
    buffer_load_dwordx4 v247, s[24:27], s44 offen lds
    s_add_u32 m0, m0, 1024
    s_add_u32 s44, s44, 8192
    buffer_load_dwordx4 v247, s[24:27], s44 offen lds
    s_add_u32 m0, m0, 1024
    s_add_u32 s44, s44, 8192
    buffer_load_dwordx4 v247, s[24:27], s44 offen lds
    s_add_u32 m0, m0, 1024
    s_add_u32 s44, s44, 8192
    buffer_load_dwordx4 v247, s[24:27], s44 offen lds
    s_waitcnt vmcnt(8)
    s_barrier
    s_add_u32 m0, s45, 98304
    s_add_u32 s44, s43, 3670016
    s_and_b32 s44, s44, 0x3fffff
    buffer_load_dwordx4 v244, s[16:19], s44 offen lds
    s_add_u32 m0, s45, 102400
    s_add_u32 s44, s43, 3932160
    s_and_b32 s44, s44, 0x3fffff
    buffer_load_dwordx4 v244, s[16:19], s44 offen lds
    s_add_u32 m0, s45, 106496
    s_add_u32 s44, s43, 3670144
    s_and_b32 s44, s44, 0x3fffff
    buffer_load_dwordx4 v244, s[16:19], s44 offen lds
    s_add_u32 m0, s45, 110592
    s_add_u32 s44, s43, 3932288
    s_and_b32 s44, s44, 0x3fffff
    buffer_load_dwordx4 v244, s[16:19], s44 offen lds
    s_add_u32 m0, s53, 114688
    s_add_u32 s44, s58, 896
    s_and_b32 s44, s44, 1023
    buffer_load_dwordx4 v247, s[24:27], s44 offen lds
    s_add_u32 m0, m0, 1024
    s_add_u32 s44, s44, 8192
    buffer_load_dwordx4 v247, s[24:27], s44 offen lds
    s_add_u32 m0, m0, 1024
    s_add_u32 s44, s44, 8192
    buffer_load_dwordx4 v247, s[24:27], s44 offen lds
    s_add_u32 m0, m0, 1024
    s_add_u32 s44, s44, 8192
    buffer_load_dwordx4 v247, s[24:27], s44 offen lds
    s_add_u32 s43, s43, 256
    s_and_b32 s43, s43, 0x3803ff
    s_add_u32 s46, s45, 65536
    s_add_u32 m0, s46, 0
    s_add_u32 s44, s43, 0
    s_and_b32 s44, s44, 0x403fffff
    buffer_load_dwordx4 v244, s[16:19], s44 offen lds
    s_add_u32 m0, s46, 4096
    s_add_u32 s44, s43, 262144
    s_and_b32 s44, s44, 0x403fffff
    buffer_load_dwordx4 v244, s[16:19], s44 offen lds
    s_add_u32 m0, s46, 8192
    s_add_u32 s44, s43, 524288
    s_and_b32 s44, s44, 0x403fffff
    buffer_load_dwordx4 v244, s[16:19], s44 offen lds
    s_add_u32 m0, s46, 12288
    s_add_u32 s44, s43, 786432
    s_and_b32 s44, s44, 0x403fffff
    buffer_load_dwordx4 v244, s[16:19], s44 offen lds
    s_add_u32 m0, s46, 16384
    s_add_u32 s44, s43, 1048576
    s_and_b32 s44, s44, 0x403fffff
    buffer_load_dwordx4 v244, s[16:19], s44 offen lds
    s_add_u32 m0, s46, 20480
    s_add_u32 s44, s43, 1310720
    s_and_b32 s44, s44, 0x403fffff
    buffer_load_dwordx4 v244, s[16:19], s44 offen lds
    s_add_u32 m0, s46, 24576
    s_add_u32 s44, s43, 1572864
    s_and_b32 s44, s44, 0x403fffff
    buffer_load_dwordx4 v244, s[16:19], s44 offen lds
    s_add_u32 m0, s46, 28672
    s_add_u32 s44, s43, 1835008
    s_and_b32 s44, s44, 0x403fffff
    buffer_load_dwordx4 v244, s[16:19], s44 offen lds
    s_waitcnt vmcnt(16)
    s_barrier
    s_add_u32 s54, s51, 0
    s_xor_b32 s54, s54, s4
    s_add_u32 m0, s47, 0
    s_nop 0
    buffer_load_dwordx4 v242, s[8:11], s54 offen nt lds
    s_add_u32 m0, s47, 3072
    s_nop 0
    buffer_load_dwordx4 v242, s[8:11], s54 offen offset:1024 nt lds
    s_add_u32 m0, s47, 6144
    s_nop 0
    buffer_load_dwordx4 v242, s[8:11], s54 offen offset:2048 nt lds
    s_add_u32 m0, s47, 9216
    s_nop 0
    buffer_load_dwordx4 v242, s[8:11], s54 offen offset:3072 nt lds
    s_add_u32 s54, s51, 16384
    s_xor_b32 s54, s54, s4
    s_add_u32 m0, s47, 16384
    s_nop 0
    buffer_load_dwordx4 v242, s[8:11], s54 offen nt lds
    s_add_u32 m0, s47, 19456
    s_nop 0
    buffer_load_dwordx4 v242, s[8:11], s54 offen offset:1024 nt lds
    s_add_u32 m0, s47, 22528
    s_nop 0
    buffer_load_dwordx4 v242, s[8:11], s54 offen offset:2048 nt lds
    s_add_u32 m0, s47, 25600
    s_nop 0
    buffer_load_dwordx4 v242, s[8:11], s54 offen offset:3072 nt lds
    s_waitcnt vmcnt(16)
    s_barrier
    s_waitcnt vmcnt(8)
    s_barrier
    s_add_u32 s55, s51, 0
    s_xor_b32 s55, s55, s4
    s_add_u32 m0, s47, 32768
    s_nop 0
    buffer_load_dwordx4 v243, s[12:15], s55 offen nt lds
    s_add_u32 m0, s47, 35840
    s_nop 0
    buffer_load_dwordx4 v243, s[12:15], s55 offen offset:1024 nt lds
    s_add_u32 m0, s47, 38912
    s_nop 0
    buffer_load_dwordx4 v243, s[12:15], s55 offen offset:2048 nt lds
    s_add_u32 m0, s47, 41984
    s_nop 0
    buffer_load_dwordx4 v243, s[12:15], s55 offen offset:3072 nt lds
    s_add_u32 s55, s51, 16384
    s_xor_b32 s55, s55, s4
    s_add_u32 m0, s47, 49152
    s_nop 0
    buffer_load_dwordx4 v243, s[12:15], s55 offen nt lds
    s_add_u32 m0, s47, 52224
    s_nop 0
    buffer_load_dwordx4 v243, s[12:15], s55 offen offset:1024 nt lds
    s_add_u32 m0, s47, 55296
    s_nop 0
    buffer_load_dwordx4 v243, s[12:15], s55 offen offset:2048 nt lds
    s_add_u32 m0, s47, 58368
    s_nop 0
    buffer_load_dwordx4 v243, s[12:15], s55 offen offset:3072 nt lds
    v_lshrrev_b32 v5, 3, v0
    v_bfe_u32 v6, v0, 4, 1
    s_and_b32 s44, s37, 1
    s_lshl_b32 s44, s44, 1
    v_or_b32 v6, s44, v6
    v_lshlrev_b32 v6, 1, v6
    v_and_b32 v7, 7, v0
    v_xor_b32 v6, v6, v7
    v_lshlrev_b32 v6, 4, v6
    v_and_b32 v7, 3, v5
    v_lshrrev_b32 v5, 2, v5
    v_lshl_add_u32 v7, v5, 4, v7
    s_lshl_b32 s44, s37, 2
    v_add_u32 v7, s44, v7
    v_lshl_add_u32 v245, v7, 10, v6
    v_mov_b32 v253, v245
    s_lshl_b32 s56, s5, 2
    s_lshr_b32 s58, s6, 1
    s_add_u32 s56, s56, s58
    s_lshl_b32 s56, s56, 10
    s_add_u32 s56, s56, 75497472
    s_add_u32 s72, s92, s56
    s_addc_u32 s73, s93, 0
    s_mov_b32 s74, 1024
    s_mov_b32 s75, 0x20000
    s_mov_b32 s39, 0x49800000
    v_add_u32 v5, 0, v2
    v_xor_b32 v5, v5, v1
    v_lshlrev_b32 v5, 4, v5
    v_lshl_add_u32 v238, v1, 8, v5
    v_add_u32 v5, 4, v2
    v_xor_b32 v5, v5, v1
    v_lshlrev_b32 v5, 4, v5
    v_lshl_add_u32 v239, v1, 8, v5
    v_add_u32 v5, 8, v2
    v_xor_b32 v5, v5, v1
    v_lshlrev_b32 v5, 4, v5
    v_lshl_add_u32 v240, v1, 8, v5
    v_add_u32 v5, 12, v2
    v_xor_b32 v5, v5, v1
    v_lshlrev_b32 v5, 4, v5
    v_lshl_add_u32 v241, v1, 8, v5
    v_and_b32 v5, 1, v2
    v_lshl_add_u32 v5, v5, 2, v3
    v_lshl_add_u32 v6, v2, 2, v3
    v_lshlrev_b32 v6, 8, v6
    v_lshl_add_u32 v6, v4, 3, v6
    v_xor_b32 v7, 0, v5
    v_lshl_add_u32 v242, v7, 5, v6
    v_xor_b32 v7, 1, v5
    v_lshl_add_u32 v243, v7, 5, v6
    v_xor_b32 v7, 2, v5
    v_lshl_add_u32 v244, v7, 5, v6
    v_xor_b32 v7, 3, v5
    v_lshl_add_u32 v245, v7, 5, v6
    v_xor_b32 v7, 4, v5
    v_lshl_add_u32 v246, v7, 5, v6
    v_xor_b32 v7, 5, v5
    v_lshl_add_u32 v247, v7, 5, v6
    v_xor_b32 v7, 6, v5
    v_lshl_add_u32 v248, v7, 5, v6
    v_xor_b32 v7, 7, v5
    v_lshl_add_u32 v249, v7, 5, v6
    s_lshl_b32 s57, s37, 13
    s_add_u32 s44, s57, 131072
    v_add_u32 v250, s44, v252
    s_waitcnt vmcnt(12)
    s_barrier
    ds_read_b128 v[8:11], v250 offset:0
    ds_read_b128 v[12:15], v250 offset:1024
    ds_read_b128 v[16:19], v250 offset:2048
    ds_read_b128 v[20:23], v250 offset:3072
    ds_read_b128 v[24:27], v250 offset:4096
    ds_read_b128 v[28:31], v250 offset:5120
    ds_read_b128 v[32:35], v250 offset:6144
    ds_read_b128 v[36:39], v250 offset:7168
    ds_read_b128 v[184:187], v238 offset:0
    ds_read_b128 v[188:191], v239 offset:0
    ds_read_b128 v[192:195], v240 offset:0
    ds_read_b128 v[196:199], v241 offset:0
    ds_read_b128 v[200:203], v238 offset:4096
    ds_read_b128 v[204:207], v239 offset:4096
    ds_read_b128 v[208:211], v240 offset:4096
    ds_read_b128 v[212:215], v241 offset:4096
    s_waitcnt lgkmcnt(4)
    v_mfma_f32_16x16x32_bf16 v[104:107], v[184:187], v[8:11], 0
    v_mfma_f32_16x16x32_bf16 v[104:107], v[188:191], v[16:19], v[104:107]
    v_mfma_f32_16x16x32_bf16 v[104:107], v[192:195], v[24:27], v[104:107]
    v_mfma_f32_16x16x32_bf16 v[104:107], v[196:199], v[32:35], v[104:107]
    v_mfma_f32_16x16x32_bf16 v[108:111], v[184:187], v[12:15], 0
    ds_read_b128 v[184:187], v238 offset:8192
    v_mfma_f32_16x16x32_bf16 v[108:111], v[188:191], v[20:23], v[108:111]
    ds_read_b128 v[188:191], v239 offset:8192
    v_mfma_f32_16x16x32_bf16 v[108:111], v[192:195], v[28:31], v[108:111]
    ds_read_b128 v[192:195], v240 offset:8192
    v_mfma_f32_16x16x32_bf16 v[108:111], v[196:199], v[36:39], v[108:111]
    ds_read_b128 v[196:199], v241 offset:8192
    s_barrier
    s_waitcnt lgkmcnt(4)
    v_mfma_f32_16x16x32_bf16 v[112:115], v[200:203], v[8:11], 0
    v_mfma_f32_16x16x32_bf16 v[112:115], v[204:207], v[16:19], v[112:115]
    v_mfma_f32_16x16x32_bf16 v[112:115], v[208:211], v[24:27], v[112:115]
    v_mfma_f32_16x16x32_bf16 v[112:115], v[212:215], v[32:35], v[112:115]
    v_mfma_f32_16x16x32_bf16 v[116:119], v[200:203], v[12:15], 0
    ds_read_b128 v[200:203], v238 offset:12288
    v_mfma_f32_16x16x32_bf16 v[116:119], v[204:207], v[20:23], v[116:119]
    ds_read_b128 v[204:207], v239 offset:12288
    s_barrier
    v_mfma_f32_16x16x32_bf16 v[116:119], v[208:211], v[28:31], v[116:119]
    ds_read_b128 v[208:211], v240 offset:12288
    v_mfma_f32_16x16x32_bf16 v[116:119], v[212:215], v[36:39], v[116:119]
    ds_read_b128 v[212:215], v241 offset:12288
    s_waitcnt lgkmcnt(4)
    v_mfma_f32_16x16x32_bf16 v[120:123], v[184:187], v[8:11], 0
    v_mfma_f32_16x16x32_bf16 v[120:123], v[188:191], v[16:19], v[120:123]
    v_mfma_f32_16x16x32_bf16 v[120:123], v[192:195], v[24:27], v[120:123]
    v_mfma_f32_16x16x32_bf16 v[120:123], v[196:199], v[32:35], v[120:123]
    s_waitcnt lgkmcnt(0)
    s_barrier
    v_mfma_f32_16x16x32_bf16 v[124:127], v[184:187], v[12:15], 0
    v_mfma_f32_16x16x32_bf16 v[124:127], v[188:191], v[20:23], v[124:127]
    v_mfma_f32_16x16x32_bf16 v[124:127], v[192:195], v[28:31], v[124:127]
    v_mfma_f32_16x16x32_bf16 v[124:127], v[196:199], v[36:39], v[124:127]
    v_mfma_f32_16x16x32_bf16 v[128:131], v[200:203], v[8:11], 0
    v_mfma_f32_16x16x32_bf16 v[128:131], v[204:207], v[16:19], v[128:131]
    v_mfma_f32_16x16x32_bf16 v[128:131], v[208:211], v[24:27], v[128:131]
    v_mfma_f32_16x16x32_bf16 v[128:131], v[212:215], v[32:35], v[128:131]
    v_mfma_f32_16x16x32_bf16 v[132:135], v[200:203], v[12:15], 0
    v_mfma_f32_16x16x32_bf16 v[132:135], v[204:207], v[20:23], v[132:135]
    v_mfma_f32_16x16x32_bf16 v[132:135], v[208:211], v[28:31], v[132:135]
    v_mfma_f32_16x16x32_bf16 v[132:135], v[212:215], v[36:39], v[132:135]
    v_max3_f32 v224, v104, v105, v106
    v_max3_f32 v225, v108, v109, v110
    v_max3_f32 v224, v224, v107, v112
    v_max3_f32 v225, v225, v111, v116
    v_max3_f32 v224, v224, v113, v114
    v_max3_f32 v225, v225, v117, v118
    v_max3_f32 v224, v224, v115, v120
    v_max3_f32 v225, v225, v119, v124
    v_max3_f32 v224, v224, v121, v122
    v_max3_f32 v225, v225, v125, v126
    v_max3_f32 v224, v224, v123, v128
    v_max3_f32 v225, v225, v127, v132
    v_max3_f32 v224, v224, v129, v130
    v_max3_f32 v225, v225, v133, v134
    v_max_f32 v224, v224, v131
    v_max_f32 v225, v225, v135
    v_mov_b32 v226, v224
    v_mov_b32 v227, v225
    s_nop 0
    v_permlane32_swap_b32 v226, v224
    v_permlane32_swap_b32 v227, v225
    v_max_f32 v224, v224, v226
    v_max_f32 v225, v225, v227
    v_mov_b32 v226, v224
    v_mov_b32 v227, v225
    s_nop 0
    v_permlane16_swap_b32 v226, v224
    v_permlane16_swap_b32 v227, v225
    v_max_f32 v224, v224, v226
    v_max_f32 v225, v225, v227
    v_sub_f32 v104, v104, v224
    v_sub_f32 v108, v108, v225
    v_sub_f32 v105, v105, v224
    v_sub_f32 v109, v109, v225
    v_sub_f32 v106, v106, v224
    v_sub_f32 v110, v110, v225
    v_sub_f32 v107, v107, v224
    v_sub_f32 v111, v111, v225
    v_sub_f32 v112, v112, v224
    v_sub_f32 v116, v116, v225
    v_sub_f32 v113, v113, v224
    v_sub_f32 v117, v117, v225
    v_sub_f32 v114, v114, v224
    v_sub_f32 v118, v118, v225
    v_sub_f32 v115, v115, v224
    v_sub_f32 v119, v119, v225
    v_exp_f32 v216, v104
    v_exp_f32 v217, v105
    v_exp_f32 v218, v106
    v_exp_f32 v219, v107
    v_add_f32 v236, v216, v217
    v_cvt_pk_bf16_f32 v152, v216, v217
    v_add_f32 v236, v236, v218
    v_add_f32 v236, v236, v219
    v_cvt_pk_bf16_f32 v153, v218, v219
    v_exp_f32 v220, v112
    v_exp_f32 v221, v113
    v_exp_f32 v222, v114
    v_exp_f32 v223, v115
    v_add_f32 v236, v236, v220
    v_add_f32 v236, v236, v221
    v_cvt_pk_bf16_f32 v154, v220, v221
    v_add_f32 v236, v236, v222
    v_add_f32 v236, v236, v223
    v_cvt_pk_bf16_f32 v155, v222, v223
    v_exp_f32 v216, v108
    v_exp_f32 v217, v109
    v_exp_f32 v218, v110
    v_exp_f32 v219, v111
    v_add_f32 v237, v216, v217
    v_cvt_pk_bf16_f32 v156, v216, v217
    v_add_f32 v237, v237, v218
    v_add_f32 v237, v237, v219
    v_cvt_pk_bf16_f32 v157, v218, v219
    v_exp_f32 v220, v116
    v_exp_f32 v221, v117
    v_add_f32 v237, v237, v220
    v_exp_f32 v222, v118
    v_exp_f32 v223, v119
    v_add_f32 v237, v237, v221
    v_cvt_pk_bf16_f32 v158, v220, v221
    v_add_f32 v237, v237, v222
    v_add_f32 v237, v237, v223
    v_cvt_pk_bf16_f32 v159, v222, v223
    v_sub_f32 v176, 0, v224
    v_sub_f32 v177, 0, v224
    v_sub_f32 v178, 0, v224
    v_sub_f32 v179, 0, v224
    v_sub_f32 v120, v120, v224
    v_sub_f32 v121, v121, v224
    v_sub_f32 v122, v122, v224
    v_sub_f32 v123, v123, v224
    v_sub_f32 v128, v128, v224
    s_waitcnt vmcnt(8)
    s_waitcnt lgkmcnt(0)
    s_barrier
    ds_read_b128 v[184:187], v238 offset:16384
    ds_read_b128 v[188:191], v239 offset:16384
    ds_read_b128 v[192:195], v240 offset:16384
    ds_read_b128 v[196:199], v241 offset:16384
    ds_read_b128 v[200:203], v238 offset:20480
    ds_read_b128 v[204:207], v239 offset:20480
    ds_read_b128 v[208:211], v240 offset:20480
    ds_read_b128 v[212:215], v241 offset:20480
    v_sub_f32 v129, v129, v224
    v_sub_f32 v130, v130, v224
    v_sub_f32 v131, v131, v224
    v_sub_f32 v180, 0, v225
    v_sub_f32 v181, 0, v225
    v_sub_f32 v182, 0, v225
    v_sub_f32 v183, 0, v225
    v_sub_f32 v124, v124, v225
    v_sub_f32 v125, v125, v225
    v_sub_f32 v126, v126, v225
    v_sub_f32 v127, v127, v225
    v_sub_f32 v132, v132, v225
    v_sub_f32 v133, v133, v225
    v_sub_f32 v134, v134, v225
    v_sub_f32 v135, v135, v225
    v_mov_b32 v232, v236
    v_mov_b32 v233, v237
    s_waitcnt lgkmcnt(4)
    v_mfma_f32_16x16x32_bf16 v[104:107], v[184:187], v[8:11], v[176:179]
    v_exp_f32 v216, v120
    v_mfma_f32_16x16x32_bf16 v[104:107], v[188:191], v[16:19], v[104:107]
    v_exp_f32 v217, v121
    v_exp_f32 v218, v122
    v_mfma_f32_16x16x32_bf16 v[104:107], v[192:195], v[24:27], v[104:107]
    v_exp_f32 v219, v123
    v_mfma_f32_16x16x32_bf16 v[104:107], v[196:199], v[32:35], v[104:107]
    v_add_f32 v236, v216, v217
    v_cvt_pk_bf16_f32 v168, v216, v217
    v_add_f32 v236, v236, v218
    v_add_f32 v236, v236, v219
    v_mfma_f32_16x16x32_bf16 v[108:111], v[184:187], v[12:15], v[180:183]
    ds_read_b128 v[184:187], v238 offset:24576
    v_cvt_pk_bf16_f32 v169, v218, v219
    v_mfma_f32_16x16x32_bf16 v[108:111], v[188:191], v[20:23], v[108:111]
    ds_read_b128 v[188:191], v239 offset:24576
    v_exp_f32 v220, v128
    v_mfma_f32_16x16x32_bf16 v[108:111], v[192:195], v[28:31], v[108:111]
    ds_read_b128 v[192:195], v240 offset:24576
    v_add_f32 v236, v236, v220
    v_mfma_f32_16x16x32_bf16 v[108:111], v[196:199], v[36:39], v[108:111]
    ds_read_b128 v[196:199], v241 offset:24576
    v_exp_f32 v221, v129
    s_waitcnt lgkmcnt(4)
    v_mfma_f32_16x16x32_bf16 v[112:115], v[200:203], v[8:11], v[176:179]
    v_exp_f32 v222, v130
    v_mfma_f32_16x16x32_bf16 v[112:115], v[204:207], v[16:19], v[112:115]
    v_exp_f32 v223, v131
    v_add_f32 v236, v236, v221
    v_cvt_pk_bf16_f32 v170, v220, v221
    v_mfma_f32_16x16x32_bf16 v[112:115], v[208:211], v[24:27], v[112:115]
    v_add_f32 v236, v236, v222
    v_add_f32 v236, v236, v223
    v_mfma_f32_16x16x32_bf16 v[112:115], v[212:215], v[32:35], v[112:115]
    v_cvt_pk_bf16_f32 v171, v222, v223
    v_exp_f32 v216, v124
    v_mfma_f32_16x16x32_bf16 v[116:119], v[200:203], v[12:15], v[180:183]
    ds_read_b128 v[200:203], v238 offset:28672
    v_mfma_f32_16x16x32_bf16 v[116:119], v[204:207], v[20:23], v[116:119]
    ds_read_b128 v[204:207], v239 offset:28672
    v_exp_f32 v217, v125
    v_mfma_f32_16x16x32_bf16 v[116:119], v[208:211], v[28:31], v[116:119]
    ds_read_b128 v[208:211], v240 offset:28672
    v_add_f32 v237, v216, v217
    v_mfma_f32_16x16x32_bf16 v[116:119], v[212:215], v[36:39], v[116:119]
    ds_read_b128 v[212:215], v241 offset:28672
    v_exp_f32 v218, v126
    s_waitcnt lgkmcnt(4)
    v_mfma_f32_16x16x32_bf16 v[136:139], v[184:187], v[8:11], v[176:179]
    v_exp_f32 v219, v127
    v_mfma_f32_16x16x32_bf16 v[136:139], v[188:191], v[16:19], v[136:139]
    v_cvt_pk_bf16_f32 v172, v216, v217
    v_add_f32 v237, v237, v218
    v_add_f32 v237, v237, v219
    v_cvt_pk_bf16_f32 v173, v218, v219
    v_mfma_f32_16x16x32_bf16 v[136:139], v[192:195], v[24:27], v[136:139]
    v_exp_f32 v220, v132
    v_mfma_f32_16x16x32_bf16 v[136:139], v[196:199], v[32:35], v[136:139]
    v_exp_f32 v221, v133
    s_waitcnt vmcnt(4)
    s_waitcnt lgkmcnt(0)
    s_barrier
    v_mfma_f32_16x16x32_bf16 v[140:143], v[184:187], v[12:15], v[180:183]
    ds_read_b64_tr_b16 v[184:185], v242 offset:32768
    v_add_f32 v237, v237, v220
    v_mfma_f32_16x16x32_bf16 v[140:143], v[188:191], v[20:23], v[140:143]
    ds_read_b64_tr_b16 v[186:187], v242 offset:36864
    ds_read_b64_tr_b16 v[188:189], v242 offset:40960
    v_exp_f32 v222, v134
    v_mfma_f32_16x16x32_bf16 v[140:143], v[192:195], v[28:31], v[140:143]
    ds_read_b64_tr_b16 v[190:191], v242 offset:45056
    v_add_f32 v237, v237, v221
    v_mfma_f32_16x16x32_bf16 v[140:143], v[196:199], v[36:39], v[140:143]
    ds_read_b64_tr_b16 v[192:193], v243 offset:32768
    ds_read_b64_tr_b16 v[194:195], v243 offset:36864
    v_cvt_pk_bf16_f32 v174, v220, v221
    v_mfma_f32_16x16x32_bf16 v[144:147], v[200:203], v[8:11], v[176:179]
    ds_read_b64_tr_b16 v[196:197], v243 offset:40960
    v_add_f32 v237, v237, v222
    v_mfma_f32_16x16x32_bf16 v[144:147], v[204:207], v[16:19], v[144:147]
    ds_read_b64_tr_b16 v[198:199], v243 offset:45056
    v_exp_f32 v223, v135
    v_mfma_f32_16x16x32_bf16 v[144:147], v[208:211], v[24:27], v[144:147]
    v_add_f32 v237, v237, v223
    v_cvt_pk_bf16_f32 v175, v222, v223
    v_mfma_f32_16x16x32_bf16 v[144:147], v[212:215], v[32:35], v[144:147]
    v_mfma_f32_16x16x32_bf16 v[148:151], v[200:203], v[12:15], v[180:183]
    ds_read_b64_tr_b16 v[200:201], v244 offset:32768
    v_mfma_f32_16x16x32_bf16 v[148:151], v[204:207], v[20:23], v[148:151]
    ds_read_b64_tr_b16 v[202:203], v244 offset:36864
    ds_read_b64_tr_b16 v[204:205], v244 offset:40960
    v_mfma_f32_16x16x32_bf16 v[148:151], v[208:211], v[28:31], v[148:151]
    ds_read_b64_tr_b16 v[206:207], v244 offset:45056
    v_mfma_f32_16x16x32_bf16 v[148:151], v[212:215], v[36:39], v[148:151]
    ds_read_b64_tr_b16 v[208:209], v245 offset:32768
    ds_read_b64_tr_b16 v[210:211], v245 offset:36864
    v_add_f32 v232, v232, v236
    v_add_f32 v233, v233, v237
    s_waitcnt lgkmcnt(10)
    v_mfma_f32_16x16x32_bf16 v[40:43], v[184:187], v[152:155], 0
    ds_read_b64_tr_b16 v[212:213], v245 offset:40960
    v_mfma_f32_16x16x32_bf16 v[40:43], v[188:191], v[168:171], v[40:43]
    ds_read_b64_tr_b16 v[214:215], v245 offset:45056
    v_exp_f32 v216, v104
    v_exp_f32 v217, v105
    v_mfma_f32_16x16x32_bf16 v[44:47], v[188:191], v[172:175], 0
    ds_read_b64_tr_b16 v[188:189], v246 offset:40960
    v_add_f32 v236, v216, v217
    v_mfma_f32_16x16x32_bf16 v[44:47], v[184:187], v[156:159], v[44:47]
    ds_read_b64_tr_b16 v[190:191], v246 offset:45056
    ds_read_b64_tr_b16 v[184:185], v246 offset:32768
    v_exp_f32 v218, v106
    s_waitcnt lgkmcnt(11)
    v_mfma_f32_16x16x32_bf16 v[48:51], v[192:195], v[152:155], 0
    ds_read_b64_tr_b16 v[186:187], v246 offset:36864
    v_cvt_pk_bf16_f32 v160, v216, v217
    v_mfma_f32_16x16x32_bf16 v[48:51], v[196:199], v[168:171], v[48:51]
    v_exp_f32 v219, v107
    v_add_f32 v236, v236, v218
    v_add_f32 v236, v236, v219
    v_cvt_pk_bf16_f32 v161, v218, v219
    v_mfma_f32_16x16x32_bf16 v[52:55], v[196:199], v[172:175], 0
    ds_read_b64_tr_b16 v[196:197], v247 offset:40960
    v_mfma_f32_16x16x32_bf16 v[52:55], v[192:195], v[156:159], v[52:55]
    ds_read_b64_tr_b16 v[198:199], v247 offset:45056
    ds_read_b64_tr_b16 v[192:193], v247 offset:32768
    v_exp_f32 v220, v112
    s_waitcnt lgkmcnt(11)
    v_mfma_f32_16x16x32_bf16 v[56:59], v[200:203], v[152:155], 0
    ds_read_b64_tr_b16 v[194:195], v247 offset:36864
    v_add_f32 v236, v236, v220
    v_mfma_f32_16x16x32_bf16 v[56:59], v[204:207], v[168:171], v[56:59]
    v_exp_f32 v221, v113
    v_exp_f32 v222, v114
    v_add_f32 v236, v236, v221
    v_mfma_f32_16x16x32_bf16 v[60:63], v[204:207], v[172:175], 0
    ds_read_b64_tr_b16 v[204:205], v248 offset:40960
    v_cvt_pk_bf16_f32 v162, v220, v221
    v_mfma_f32_16x16x32_bf16 v[60:63], v[200:203], v[156:159], v[60:63]
    ds_read_b64_tr_b16 v[206:207], v248 offset:45056
    ds_read_b64_tr_b16 v[200:201], v248 offset:32768
    v_exp_f32 v223, v115
    s_waitcnt lgkmcnt(11)
    v_mfma_f32_16x16x32_bf16 v[64:67], v[208:211], v[152:155], 0
    ds_read_b64_tr_b16 v[202:203], v248 offset:36864
    v_add_f32 v236, v236, v222
    v_mfma_f32_16x16x32_bf16 v[64:67], v[212:215], v[168:171], v[64:67]
    v_add_f32 v236, v236, v223
    v_cvt_pk_bf16_f32 v163, v222, v223
    v_exp_f32 v216, v108
    v_mfma_f32_16x16x32_bf16 v[68:71], v[212:215], v[172:175], 0
    ds_read_b64_tr_b16 v[212:213], v249 offset:40960
    v_mfma_f32_16x16x32_bf16 v[68:71], v[208:211], v[156:159], v[68:71]
    ds_read_b64_tr_b16 v[214:215], v249 offset:45056
    ds_read_b64_tr_b16 v[208:209], v249 offset:32768
    v_exp_f32 v217, v109
    s_waitcnt lgkmcnt(11)
    v_mfma_f32_16x16x32_bf16 v[72:75], v[184:187], v[152:155], 0
    ds_read_b64_tr_b16 v[210:211], v249 offset:36864
    v_add_f32 v237, v216, v217
    v_mfma_f32_16x16x32_bf16 v[72:75], v[188:191], v[168:171], v[72:75]
    v_exp_f32 v218, v110
    v_exp_f32 v219, v111
    v_cvt_pk_bf16_f32 v164, v216, v217
    v_mfma_f32_16x16x32_bf16 v[76:79], v[188:191], v[172:175], 0
    v_add_f32 v237, v237, v218
    v_add_f32 v237, v237, v219
    v_mfma_f32_16x16x32_bf16 v[76:79], v[184:187], v[156:159], v[76:79]
    v_cvt_pk_bf16_f32 v165, v218, v219
    v_exp_f32 v220, v116
    s_waitcnt lgkmcnt(8)
    v_mfma_f32_16x16x32_bf16 v[80:83], v[192:195], v[152:155], 0
    v_exp_f32 v221, v117
    v_mfma_f32_16x16x32_bf16 v[80:83], v[196:199], v[168:171], v[80:83]
    v_exp_f32 v222, v118
    v_exp_f32 v223, v119
    v_add_f32 v237, v237, v220
    v_mfma_f32_16x16x32_bf16 v[84:87], v[196:199], v[172:175], 0
    v_add_f32 v237, v237, v221
    v_cvt_pk_bf16_f32 v166, v220, v221
    v_mfma_f32_16x16x32_bf16 v[84:87], v[192:195], v[156:159], v[84:87]
    v_add_f32 v237, v237, v222
    v_add_f32 v237, v237, v223
    s_waitcnt vmcnt(0)
    s_waitcnt lgkmcnt(0)
    s_barrier
    s_mov_b32 s38, 0
L_Aloop:
    s_cmp_lt_u32 s38, 2
    s_cselect_b32 s44, 2, 1
    s_lshl_b32 s44, s44, 16
    s_add_u32 s44, s44, s57
    v_add_u32 v250, s44, v252
    v_mov_b32 v251, v250
    s_cmp_eq_u32 s38, 0
    s_cbranch_scc0 L_Ao
    v_add_u32 v251, -32768, v251
L_Ao:
    v_mfma_f32_16x16x32_bf16 v[88:91], v[200:203], v[152:155], 0
    ds_read_b128 v[184:187], v238 offset:0
    v_cvt_pk_bf16_f32 v167, v222, v223
    v_mfma_f32_16x16x32_bf16 v[88:91], v[204:207], v[168:171], v[88:91]
    ds_read_b128 v[188:191], v239 offset:0
    ds_read_b128 v[192:195], v240 offset:0
    v_max_f32 v224, v236, v237
    v_cmp_lt_f32 vcc, s39, v224
    v_mfma_f32_16x16x32_bf16 v[92:95], v[204:207], v[172:175], 0
    ds_read_b128 v[196:199], v241 offset:0
    v_mfma_f32_16x16x32_bf16 v[92:95], v[200:203], v[156:159], v[92:95]
    ds_read_b128 v[200:203], v238 offset:4096
    ds_read_b128 v[204:207], v239 offset:4096
    v_mfma_f32_16x16x32_bf16 v[96:99], v[208:211], v[152:155], 0
    v_mfma_f32_16x16x32_bf16 v[96:99], v[212:215], v[168:171], v[96:99]
    v_mfma_f32_16x16x32_bf16 v[100:103], v[212:215], v[172:175], 0
    v_mfma_f32_16x16x32_bf16 v[100:103], v[208:211], v[156:159], v[100:103]
    ds_read_b128 v[208:211], v240 offset:4096
    ds_read_b128 v[212:215], v241 offset:4096
    s_cbranch_vccnz L_fb_L1_0
L_ret_L1_0:
    v_add_f32 v232, v232, v236
    v_add_f32 v233, v233, v237
    s_waitcnt lgkmcnt(4)
    v_mfma_f32_16x16x32_bf16 v[104:107], v[184:187], v[8:11], v[176:179]
    v_exp_f32 v216, v136
    v_mfma_f32_16x16x32_bf16 v[104:107], v[188:191], v[16:19], v[104:107]
    v_exp_f32 v217, v137
    v_exp_f32 v218, v138
    v_mfma_f32_16x16x32_bf16 v[104:107], v[192:195], v[24:27], v[104:107]
    v_exp_f32 v219, v139
    v_mfma_f32_16x16x32_bf16 v[104:107], v[196:199], v[32:35], v[104:107]
    v_add_f32 v236, v216, v217
    v_cvt_pk_bf16_f32 v168, v216, v217
    v_add_f32 v236, v236, v218
    v_add_f32 v236, v236, v219
    v_mfma_f32_16x16x32_bf16 v[108:111], v[184:187], v[12:15], v[180:183]
    ds_read_b128 v[184:187], v238 offset:8192
    v_cvt_pk_bf16_f32 v169, v218, v219
    v_mfma_f32_16x16x32_bf16 v[108:111], v[188:191], v[20:23], v[108:111]
    ds_read_b128 v[188:191], v239 offset:8192
    v_exp_f32 v220, v144
    v_mfma_f32_16x16x32_bf16 v[108:111], v[192:195], v[28:31], v[108:111]
    ds_read_b128 v[192:195], v240 offset:8192
    v_add_f32 v236, v236, v220
    v_mfma_f32_16x16x32_bf16 v[108:111], v[196:199], v[36:39], v[108:111]
    ds_read_b128 v[196:199], v241 offset:8192
    v_exp_f32 v221, v145
    s_waitcnt lgkmcnt(4)
    v_mfma_f32_16x16x32_bf16 v[112:115], v[200:203], v[8:11], v[176:179]
    v_exp_f32 v222, v146
    v_mfma_f32_16x16x32_bf16 v[112:115], v[204:207], v[16:19], v[112:115]
    v_exp_f32 v223, v147
    v_add_f32 v236, v236, v221
    v_cvt_pk_bf16_f32 v170, v220, v221
    v_mfma_f32_16x16x32_bf16 v[112:115], v[208:211], v[24:27], v[112:115]
    v_add_f32 v236, v236, v222
    v_add_f32 v236, v236, v223
    v_mfma_f32_16x16x32_bf16 v[112:115], v[212:215], v[32:35], v[112:115]
    v_cvt_pk_bf16_f32 v171, v222, v223
    v_exp_f32 v216, v140
    v_mfma_f32_16x16x32_bf16 v[116:119], v[200:203], v[12:15], v[180:183]
    ds_read_b128 v[200:203], v238 offset:12288
    v_mfma_f32_16x16x32_bf16 v[116:119], v[204:207], v[20:23], v[116:119]
    ds_read_b128 v[204:207], v239 offset:12288
    v_exp_f32 v217, v141
    v_mfma_f32_16x16x32_bf16 v[116:119], v[208:211], v[28:31], v[116:119]
    ds_read_b128 v[208:211], v240 offset:12288
    v_add_f32 v237, v216, v217
    v_mfma_f32_16x16x32_bf16 v[116:119], v[212:215], v[36:39], v[116:119]
    ds_read_b128 v[212:215], v241 offset:12288
    v_exp_f32 v218, v142
    s_waitcnt lgkmcnt(4)
    v_mfma_f32_16x16x32_bf16 v[120:123], v[184:187], v[8:11], v[176:179]
    v_exp_f32 v219, v143
    v_mfma_f32_16x16x32_bf16 v[120:123], v[188:191], v[16:19], v[120:123]
    v_cvt_pk_bf16_f32 v172, v216, v217
    v_add_f32 v237, v237, v218
    v_add_f32 v237, v237, v219
    v_cvt_pk_bf16_f32 v173, v218, v219
    v_mfma_f32_16x16x32_bf16 v[120:123], v[192:195], v[24:27], v[120:123]
    v_exp_f32 v220, v148
    v_mfma_f32_16x16x32_bf16 v[120:123], v[196:199], v[32:35], v[120:123]
    v_exp_f32 v221, v149
    s_waitcnt lgkmcnt(0)
    s_barrier
    v_mfma_f32_16x16x32_bf16 v[124:127], v[184:187], v[12:15], v[180:183]
    ds_read_b64_tr_b16 v[184:185], v242 offset:49152
    v_add_f32 v237, v237, v220
    v_mfma_f32_16x16x32_bf16 v[124:127], v[188:191], v[20:23], v[124:127]
    ds_read_b64_tr_b16 v[186:187], v242 offset:53248
    ds_read_b64_tr_b16 v[188:189], v242 offset:57344
    v_exp_f32 v222, v150
    v_mfma_f32_16x16x32_bf16 v[124:127], v[192:195], v[28:31], v[124:127]
    ds_read_b64_tr_b16 v[190:191], v242 offset:61440
    v_add_f32 v237, v237, v221
    v_mfma_f32_16x16x32_bf16 v[124:127], v[196:199], v[36:39], v[124:127]
    ds_read_b64_tr_b16 v[192:193], v243 offset:49152
    ds_read_b64_tr_b16 v[194:195], v243 offset:53248
    v_cvt_pk_bf16_f32 v174, v220, v221
    v_mfma_f32_16x16x32_bf16 v[128:131], v[200:203], v[8:11], v[176:179]
    ds_read_b64_tr_b16 v[196:197], v243 offset:57344
    v_add_f32 v237, v237, v222
    v_mfma_f32_16x16x32_bf16 v[128:131], v[204:207], v[16:19], v[128:131]
    ds_read_b64_tr_b16 v[198:199], v243 offset:61440
    v_exp_f32 v223, v151
    v_mfma_f32_16x16x32_bf16 v[128:131], v[208:211], v[24:27], v[128:131]
    v_add_f32 v237, v237, v223
    v_cvt_pk_bf16_f32 v175, v222, v223
    v_mfma_f32_16x16x32_bf16 v[128:131], v[212:215], v[32:35], v[128:131]
    v_max_f32 v224, v236, v237
    v_cmp_lt_f32 vcc, s39, v224
    v_mfma_f32_16x16x32_bf16 v[132:135], v[200:203], v[12:15], v[180:183]
    ds_read_b64_tr_b16 v[200:201], v244 offset:49152
    v_mfma_f32_16x16x32_bf16 v[132:135], v[204:207], v[20:23], v[132:135]
    ds_read_b64_tr_b16 v[202:203], v244 offset:53248
    ds_read_b64_tr_b16 v[204:205], v244 offset:57344
    v_mfma_f32_16x16x32_bf16 v[132:135], v[208:211], v[28:31], v[132:135]
    ds_read_b64_tr_b16 v[206:207], v244 offset:61440
    v_mfma_f32_16x16x32_bf16 v[132:135], v[212:215], v[36:39], v[132:135]
    ds_read_b64_tr_b16 v[208:209], v245 offset:49152
    ds_read_b64_tr_b16 v[210:211], v245 offset:53248
    s_cbranch_vccnz L_fb_L1_1
L_ret_L1_1:
    v_add_f32 v232, v232, v236
    v_add_f32 v233, v233, v237
    s_waitcnt lgkmcnt(10)
    v_mfma_f32_16x16x32_bf16 v[40:43], v[184:187], v[160:163], v[40:43]
    ds_read_b64_tr_b16 v[212:213], v245 offset:57344
    v_mfma_f32_16x16x32_bf16 v[40:43], v[188:191], v[168:171], v[40:43]
    ds_read_b64_tr_b16 v[214:215], v245 offset:61440
    v_exp_f32 v216, v104
    v_exp_f32 v217, v105
    v_mfma_f32_16x16x32_bf16 v[44:47], v[188:191], v[172:175], v[44:47]
    ds_read_b64_tr_b16 v[188:189], v246 offset:57344
    v_add_f32 v236, v216, v217
    v_mfma_f32_16x16x32_bf16 v[44:47], v[184:187], v[164:167], v[44:47]
    ds_read_b64_tr_b16 v[190:191], v246 offset:61440
    ds_read_b64_tr_b16 v[184:185], v246 offset:49152
    v_exp_f32 v218, v106
    s_waitcnt lgkmcnt(11)
    v_mfma_f32_16x16x32_bf16 v[48:51], v[192:195], v[160:163], v[48:51]
    ds_read_b64_tr_b16 v[186:187], v246 offset:53248
    v_cvt_pk_bf16_f32 v152, v216, v217
    v_mfma_f32_16x16x32_bf16 v[48:51], v[196:199], v[168:171], v[48:51]
    v_exp_f32 v219, v107
    v_add_f32 v236, v236, v218
    v_add_f32 v236, v236, v219
    v_cvt_pk_bf16_f32 v153, v218, v219
    v_mfma_f32_16x16x32_bf16 v[52:55], v[196:199], v[172:175], v[52:55]
    ds_read_b64_tr_b16 v[196:197], v247 offset:57344
    v_mfma_f32_16x16x32_bf16 v[52:55], v[192:195], v[164:167], v[52:55]
    ds_read_b64_tr_b16 v[198:199], v247 offset:61440
    ds_read_b64_tr_b16 v[192:193], v247 offset:49152
    v_exp_f32 v220, v112
    s_waitcnt lgkmcnt(11)
    v_mfma_f32_16x16x32_bf16 v[56:59], v[200:203], v[160:163], v[56:59]
    ds_read_b64_tr_b16 v[194:195], v247 offset:53248
    v_add_f32 v236, v236, v220
    v_mfma_f32_16x16x32_bf16 v[56:59], v[204:207], v[168:171], v[56:59]
    v_exp_f32 v221, v113
    v_exp_f32 v222, v114
    v_add_f32 v236, v236, v221
    v_mfma_f32_16x16x32_bf16 v[60:63], v[204:207], v[172:175], v[60:63]
    ds_read_b64_tr_b16 v[204:205], v248 offset:57344
    v_cvt_pk_bf16_f32 v154, v220, v221
    v_mfma_f32_16x16x32_bf16 v[60:63], v[200:203], v[164:167], v[60:63]
    ds_read_b64_tr_b16 v[206:207], v248 offset:61440
    ds_read_b64_tr_b16 v[200:201], v248 offset:49152
    v_exp_f32 v223, v115
    s_waitcnt lgkmcnt(11)
    v_mfma_f32_16x16x32_bf16 v[64:67], v[208:211], v[160:163], v[64:67]
    ds_read_b64_tr_b16 v[202:203], v248 offset:53248
    v_add_f32 v236, v236, v222
    v_mfma_f32_16x16x32_bf16 v[64:67], v[212:215], v[168:171], v[64:67]
    v_add_f32 v236, v236, v223
    v_cvt_pk_bf16_f32 v155, v222, v223
    v_exp_f32 v216, v108
    v_mfma_f32_16x16x32_bf16 v[68:71], v[212:215], v[172:175], v[68:71]
    ds_read_b64_tr_b16 v[212:213], v249 offset:57344
    v_mfma_f32_16x16x32_bf16 v[68:71], v[208:211], v[164:167], v[68:71]
    ds_read_b64_tr_b16 v[214:215], v249 offset:61440
    ds_read_b64_tr_b16 v[208:209], v249 offset:49152
    v_exp_f32 v217, v109
    s_waitcnt lgkmcnt(11)
    v_mfma_f32_16x16x32_bf16 v[72:75], v[184:187], v[160:163], v[72:75]
    ds_read_b64_tr_b16 v[210:211], v249 offset:53248
    v_add_f32 v237, v216, v217
    v_mfma_f32_16x16x32_bf16 v[72:75], v[188:191], v[168:171], v[72:75]
    v_exp_f32 v218, v110
    v_exp_f32 v219, v111
    v_cvt_pk_bf16_f32 v156, v216, v217
    v_mfma_f32_16x16x32_bf16 v[76:79], v[188:191], v[172:175], v[76:79]
    v_add_f32 v237, v237, v218
    v_add_f32 v237, v237, v219
    v_mfma_f32_16x16x32_bf16 v[76:79], v[184:187], v[164:167], v[76:79]
    v_cvt_pk_bf16_f32 v157, v218, v219
    v_exp_f32 v220, v116
    s_waitcnt lgkmcnt(8)
    v_mfma_f32_16x16x32_bf16 v[80:83], v[192:195], v[160:163], v[80:83]
    v_exp_f32 v221, v117
    v_mfma_f32_16x16x32_bf16 v[80:83], v[196:199], v[168:171], v[80:83]
    v_exp_f32 v222, v118
    v_exp_f32 v223, v119
    v_add_f32 v237, v237, v220
    v_mfma_f32_16x16x32_bf16 v[84:87], v[196:199], v[172:175], v[84:87]
    v_add_f32 v237, v237, v221
    v_cvt_pk_bf16_f32 v158, v220, v221
    v_mfma_f32_16x16x32_bf16 v[84:87], v[192:195], v[164:167], v[84:87]
    v_add_f32 v237, v237, v222
    v_add_f32 v237, v237, v223
    s_waitcnt lgkmcnt(0)
    s_barrier
    v_mfma_f32_16x16x32_bf16 v[88:91], v[200:203], v[160:163], v[88:91]
    ds_read_b128 v[184:187], v238 offset:16384
    v_cvt_pk_bf16_f32 v159, v222, v223
    v_mfma_f32_16x16x32_bf16 v[88:91], v[204:207], v[168:171], v[88:91]
    ds_read_b128 v[188:191], v239 offset:16384
    ds_read_b128 v[192:195], v240 offset:16384
    v_max_f32 v224, v236, v237
    v_cmp_lt_f32 vcc, s39, v224
    v_mfma_f32_16x16x32_bf16 v[92:95], v[204:207], v[172:175], v[92:95]
    ds_read_b128 v[196:199], v241 offset:16384
    v_mfma_f32_16x16x32_bf16 v[92:95], v[200:203], v[164:167], v[92:95]
    ds_read_b128 v[200:203], v238 offset:20480
    ds_read_b128 v[204:207], v239 offset:20480
    v_mfma_f32_16x16x32_bf16 v[96:99], v[208:211], v[160:163], v[96:99]
    v_mfma_f32_16x16x32_bf16 v[96:99], v[212:215], v[168:171], v[96:99]
    v_mfma_f32_16x16x32_bf16 v[100:103], v[212:215], v[172:175], v[100:103]
    v_mfma_f32_16x16x32_bf16 v[100:103], v[208:211], v[164:167], v[100:103]
    ds_read_b128 v[208:211], v240 offset:20480
    ds_read_b128 v[212:215], v241 offset:20480
    s_cbranch_vccnz L_fb_L2_0
L_ret_L2_0:
    v_add_f32 v232, v232, v236
    v_add_f32 v233, v233, v237
    s_waitcnt lgkmcnt(4)
    v_mfma_f32_16x16x32_bf16 v[104:107], v[184:187], v[8:11], v[176:179]
    v_exp_f32 v216, v120
    v_mfma_f32_16x16x32_bf16 v[104:107], v[188:191], v[16:19], v[104:107]
    v_exp_f32 v217, v121
    v_exp_f32 v218, v122
    v_mfma_f32_16x16x32_bf16 v[104:107], v[192:195], v[24:27], v[104:107]
    v_exp_f32 v219, v123
    v_mfma_f32_16x16x32_bf16 v[104:107], v[196:199], v[32:35], v[104:107]
    v_add_f32 v236, v216, v217
    v_cvt_pk_bf16_f32 v168, v216, v217
    v_add_f32 v236, v236, v218
    v_add_f32 v236, v236, v219
    v_mfma_f32_16x16x32_bf16 v[108:111], v[184:187], v[12:15], v[180:183]
    ds_read_b128 v[184:187], v238 offset:24576
    v_cvt_pk_bf16_f32 v169, v218, v219
    v_mfma_f32_16x16x32_bf16 v[108:111], v[188:191], v[20:23], v[108:111]
    ds_read_b128 v[188:191], v239 offset:24576
    v_exp_f32 v220, v128
    v_mfma_f32_16x16x32_bf16 v[108:111], v[192:195], v[28:31], v[108:111]
    ds_read_b128 v[192:195], v240 offset:24576
    v_add_f32 v236, v236, v220
    v_mfma_f32_16x16x32_bf16 v[108:111], v[196:199], v[36:39], v[108:111]
    ds_read_b128 v[196:199], v241 offset:24576
    v_exp_f32 v221, v129
    s_waitcnt lgkmcnt(4)
    v_mfma_f32_16x16x32_bf16 v[112:115], v[200:203], v[8:11], v[176:179]
    v_exp_f32 v222, v130
    v_mfma_f32_16x16x32_bf16 v[112:115], v[204:207], v[16:19], v[112:115]
    v_exp_f32 v223, v131
    v_add_f32 v236, v236, v221
    v_cvt_pk_bf16_f32 v170, v220, v221
    v_mfma_f32_16x16x32_bf16 v[112:115], v[208:211], v[24:27], v[112:115]
    v_add_f32 v236, v236, v222
    v_add_f32 v236, v236, v223
    v_mfma_f32_16x16x32_bf16 v[112:115], v[212:215], v[32:35], v[112:115]
    v_cvt_pk_bf16_f32 v171, v222, v223
    v_exp_f32 v216, v124
    v_mfma_f32_16x16x32_bf16 v[116:119], v[200:203], v[12:15], v[180:183]
    ds_read_b128 v[200:203], v238 offset:28672
    v_mfma_f32_16x16x32_bf16 v[116:119], v[204:207], v[20:23], v[116:119]
    ds_read_b128 v[204:207], v239 offset:28672
    v_exp_f32 v217, v125
    v_mfma_f32_16x16x32_bf16 v[116:119], v[208:211], v[28:31], v[116:119]
    ds_read_b128 v[208:211], v240 offset:28672
    v_add_f32 v237, v216, v217
    v_mfma_f32_16x16x32_bf16 v[116:119], v[212:215], v[36:39], v[116:119]
    ds_read_b128 v[212:215], v241 offset:28672
    v_exp_f32 v218, v126
    s_waitcnt lgkmcnt(4)
    v_mfma_f32_16x16x32_bf16 v[136:139], v[184:187], v[8:11], v[176:179]
    v_exp_f32 v219, v127
    v_mfma_f32_16x16x32_bf16 v[136:139], v[188:191], v[16:19], v[136:139]
    v_cvt_pk_bf16_f32 v172, v216, v217
    v_add_f32 v237, v237, v218
    v_add_f32 v237, v237, v219
    v_cvt_pk_bf16_f32 v173, v218, v219
    v_mfma_f32_16x16x32_bf16 v[136:139], v[192:195], v[24:27], v[136:139]
    v_exp_f32 v220, v132
    v_mfma_f32_16x16x32_bf16 v[136:139], v[196:199], v[32:35], v[136:139]
    v_exp_f32 v221, v133
    s_waitcnt lgkmcnt(0)
    s_barrier
    v_mfma_f32_16x16x32_bf16 v[140:143], v[184:187], v[12:15], v[180:183]
    ds_read_b64_tr_b16 v[184:185], v242 offset:32768
    v_add_f32 v237, v237, v220
    v_mfma_f32_16x16x32_bf16 v[140:143], v[188:191], v[20:23], v[140:143]
    ds_read_b64_tr_b16 v[186:187], v242 offset:36864
    ds_read_b64_tr_b16 v[188:189], v242 offset:40960
    v_exp_f32 v222, v134
    v_mfma_f32_16x16x32_bf16 v[140:143], v[192:195], v[28:31], v[140:143]
    ds_read_b64_tr_b16 v[190:191], v242 offset:45056
    v_add_f32 v237, v237, v221
    v_mfma_f32_16x16x32_bf16 v[140:143], v[196:199], v[36:39], v[140:143]
    ds_read_b64_tr_b16 v[192:193], v243 offset:32768
    ds_read_b64_tr_b16 v[194:195], v243 offset:36864
    v_cvt_pk_bf16_f32 v174, v220, v221
    v_mfma_f32_16x16x32_bf16 v[144:147], v[200:203], v[8:11], v[176:179]
    ds_read_b64_tr_b16 v[196:197], v243 offset:40960
    v_add_f32 v237, v237, v222
    v_mfma_f32_16x16x32_bf16 v[144:147], v[204:207], v[16:19], v[144:147]
    ds_read_b64_tr_b16 v[198:199], v243 offset:45056
    v_exp_f32 v223, v135
    v_mfma_f32_16x16x32_bf16 v[144:147], v[208:211], v[24:27], v[144:147]
    v_add_f32 v237, v237, v223
    v_cvt_pk_bf16_f32 v175, v222, v223
    v_mfma_f32_16x16x32_bf16 v[144:147], v[212:215], v[32:35], v[144:147]
    v_max_f32 v224, v236, v237
    v_cmp_lt_f32 vcc, s39, v224
    v_mfma_f32_16x16x32_bf16 v[148:151], v[200:203], v[12:15], v[180:183]
    ds_read_b64_tr_b16 v[200:201], v244 offset:32768
    v_mfma_f32_16x16x32_bf16 v[148:151], v[204:207], v[20:23], v[148:151]
    ds_read_b64_tr_b16 v[202:203], v244 offset:36864
    ds_read_b64_tr_b16 v[204:205], v244 offset:40960
    v_mfma_f32_16x16x32_bf16 v[148:151], v[208:211], v[28:31], v[148:151]
    ds_read_b64_tr_b16 v[206:207], v244 offset:45056
    v_mfma_f32_16x16x32_bf16 v[148:151], v[212:215], v[36:39], v[148:151]
    ds_read_b64_tr_b16 v[208:209], v245 offset:32768
    ds_read_b64_tr_b16 v[210:211], v245 offset:36864
    s_cbranch_vccnz L_fb_L2_1
L_ret_L2_1:
    v_add_f32 v232, v232, v236
    v_add_f32 v233, v233, v237
    s_waitcnt lgkmcnt(10)
    v_mfma_f32_16x16x32_bf16 v[40:43], v[184:187], v[152:155], v[40:43]
    ds_read_b64_tr_b16 v[212:213], v245 offset:40960
    v_mfma_f32_16x16x32_bf16 v[40:43], v[188:191], v[168:171], v[40:43]
    ds_read_b64_tr_b16 v[214:215], v245 offset:45056
    v_exp_f32 v216, v104
    v_exp_f32 v217, v105
    v_mfma_f32_16x16x32_bf16 v[44:47], v[188:191], v[172:175], v[44:47]
    ds_read_b64_tr_b16 v[188:189], v246 offset:40960
    v_add_f32 v236, v216, v217
    v_mfma_f32_16x16x32_bf16 v[44:47], v[184:187], v[156:159], v[44:47]
    ds_read_b64_tr_b16 v[190:191], v246 offset:45056
    ds_read_b64_tr_b16 v[184:185], v246 offset:32768
    v_exp_f32 v218, v106
    s_waitcnt lgkmcnt(11)
    v_mfma_f32_16x16x32_bf16 v[48:51], v[192:195], v[152:155], v[48:51]
    ds_read_b64_tr_b16 v[186:187], v246 offset:36864
    v_cvt_pk_bf16_f32 v160, v216, v217
    v_mfma_f32_16x16x32_bf16 v[48:51], v[196:199], v[168:171], v[48:51]
    v_exp_f32 v219, v107
    v_add_f32 v236, v236, v218
    v_add_f32 v236, v236, v219
    v_cvt_pk_bf16_f32 v161, v218, v219
    v_mfma_f32_16x16x32_bf16 v[52:55], v[196:199], v[172:175], v[52:55]
    ds_read_b64_tr_b16 v[196:197], v247 offset:40960
    v_mfma_f32_16x16x32_bf16 v[52:55], v[192:195], v[156:159], v[52:55]
    ds_read_b64_tr_b16 v[198:199], v247 offset:45056
    ds_read_b64_tr_b16 v[192:193], v247 offset:32768
    v_exp_f32 v220, v112
    s_waitcnt lgkmcnt(11)
    v_mfma_f32_16x16x32_bf16 v[56:59], v[200:203], v[152:155], v[56:59]
    ds_read_b64_tr_b16 v[194:195], v247 offset:36864
    v_add_f32 v236, v236, v220
    v_mfma_f32_16x16x32_bf16 v[56:59], v[204:207], v[168:171], v[56:59]
    v_exp_f32 v221, v113
    v_exp_f32 v222, v114
    v_add_f32 v236, v236, v221
    v_mfma_f32_16x16x32_bf16 v[60:63], v[204:207], v[172:175], v[60:63]
    ds_read_b64_tr_b16 v[204:205], v248 offset:40960
    v_cvt_pk_bf16_f32 v162, v220, v221
    v_mfma_f32_16x16x32_bf16 v[60:63], v[200:203], v[156:159], v[60:63]
    ds_read_b64_tr_b16 v[206:207], v248 offset:45056
    ds_read_b64_tr_b16 v[200:201], v248 offset:32768
    v_exp_f32 v223, v115
    s_waitcnt lgkmcnt(11)
    v_mfma_f32_16x16x32_bf16 v[64:67], v[208:211], v[152:155], v[64:67]
    ds_read_b64_tr_b16 v[202:203], v248 offset:36864
    v_add_f32 v236, v236, v222
    v_mfma_f32_16x16x32_bf16 v[64:67], v[212:215], v[168:171], v[64:67]
    v_add_f32 v236, v236, v223
    v_cvt_pk_bf16_f32 v163, v222, v223
    v_exp_f32 v216, v108
    v_mfma_f32_16x16x32_bf16 v[68:71], v[212:215], v[172:175], v[68:71]
    ds_read_b64_tr_b16 v[212:213], v249 offset:40960
    v_mfma_f32_16x16x32_bf16 v[68:71], v[208:211], v[156:159], v[68:71]
    ds_read_b64_tr_b16 v[214:215], v249 offset:45056
    ds_read_b64_tr_b16 v[208:209], v249 offset:32768
    v_exp_f32 v217, v109
    s_waitcnt lgkmcnt(11)
    v_mfma_f32_16x16x32_bf16 v[72:75], v[184:187], v[152:155], v[72:75]
    ds_read_b64_tr_b16 v[210:211], v249 offset:36864
    v_add_f32 v237, v216, v217
    v_mfma_f32_16x16x32_bf16 v[72:75], v[188:191], v[168:171], v[72:75]
    v_exp_f32 v218, v110
    v_exp_f32 v219, v111
    v_cvt_pk_bf16_f32 v164, v216, v217
    v_mfma_f32_16x16x32_bf16 v[76:79], v[188:191], v[172:175], v[76:79]
    v_add_f32 v237, v237, v218
    v_add_f32 v237, v237, v219
    v_mfma_f32_16x16x32_bf16 v[76:79], v[184:187], v[156:159], v[76:79]
    v_cvt_pk_bf16_f32 v165, v218, v219
    v_exp_f32 v220, v116
    s_waitcnt lgkmcnt(8)
    v_mfma_f32_16x16x32_bf16 v[80:83], v[192:195], v[152:155], v[80:83]
    v_exp_f32 v221, v117
    v_mfma_f32_16x16x32_bf16 v[80:83], v[196:199], v[168:171], v[80:83]
    v_exp_f32 v222, v118
    v_exp_f32 v223, v119
    v_add_f32 v237, v237, v220
    v_mfma_f32_16x16x32_bf16 v[84:87], v[196:199], v[172:175], v[84:87]
    v_add_f32 v237, v237, v221
    v_cvt_pk_bf16_f32 v166, v220, v221
    v_mfma_f32_16x16x32_bf16 v[84:87], v[192:195], v[156:159], v[84:87]
    v_add_f32 v237, v237, v222
    v_add_f32 v237, v237, v223
    s_waitcnt lgkmcnt(0)
    s_barrier
    v_mfma_f32_16x16x32_bf16 v[88:91], v[200:203], v[152:155], v[88:91]
    ds_read_b128 v[184:187], v238 offset:0
    v_cvt_pk_bf16_f32 v167, v222, v223
    v_mfma_f32_16x16x32_bf16 v[88:91], v[204:207], v[168:171], v[88:91]
    ds_read_b128 v[188:191], v239 offset:0
    ds_read_b128 v[192:195], v240 offset:0
    v_max_f32 v224, v236, v237
    v_cmp_lt_f32 vcc, s39, v224
    v_mfma_f32_16x16x32_bf16 v[92:95], v[204:207], v[172:175], v[92:95]
    ds_read_b128 v[196:199], v241 offset:0
    v_mfma_f32_16x16x32_bf16 v[92:95], v[200:203], v[156:159], v[92:95]
    ds_read_b128 v[200:203], v238 offset:4096
    ds_read_b128 v[204:207], v239 offset:4096
    v_mfma_f32_16x16x32_bf16 v[96:99], v[208:211], v[152:155], v[96:99]
    v_mfma_f32_16x16x32_bf16 v[96:99], v[212:215], v[168:171], v[96:99]
    v_mfma_f32_16x16x32_bf16 v[100:103], v[212:215], v[172:175], v[100:103]
    v_mfma_f32_16x16x32_bf16 v[100:103], v[208:211], v[156:159], v[100:103]
    ds_read_b128 v[208:211], v240 offset:4096
    ds_read_b128 v[212:215], v241 offset:4096
    s_cbranch_vccnz L_fb_L3_0
L_ret_L3_0:
    v_add_f32 v232, v232, v236
    v_add_f32 v233, v233, v237
    s_waitcnt lgkmcnt(4)
    v_mfma_f32_16x16x32_bf16 v[104:107], v[184:187], v[8:11], v[176:179]
    v_exp_f32 v216, v136
    v_mfma_f32_16x16x32_bf16 v[104:107], v[188:191], v[16:19], v[104:107]
    v_exp_f32 v217, v137
    v_exp_f32 v218, v138
    v_mfma_f32_16x16x32_bf16 v[104:107], v[192:195], v[24:27], v[104:107]
    v_exp_f32 v219, v139
    v_mfma_f32_16x16x32_bf16 v[104:107], v[196:199], v[32:35], v[104:107]
    v_add_f32 v236, v216, v217
    v_cvt_pk_bf16_f32 v168, v216, v217
    v_add_f32 v236, v236, v218
    v_add_f32 v236, v236, v219
    v_mfma_f32_16x16x32_bf16 v[108:111], v[184:187], v[12:15], v[180:183]
    ds_read_b128 v[184:187], v238 offset:8192
    v_cvt_pk_bf16_f32 v169, v218, v219
    v_mfma_f32_16x16x32_bf16 v[108:111], v[188:191], v[20:23], v[108:111]
    ds_read_b128 v[188:191], v239 offset:8192
    v_exp_f32 v220, v144
    v_mfma_f32_16x16x32_bf16 v[108:111], v[192:195], v[28:31], v[108:111]
    ds_read_b128 v[192:195], v240 offset:8192
    v_add_f32 v236, v236, v220
    v_mfma_f32_16x16x32_bf16 v[108:111], v[196:199], v[36:39], v[108:111]
    ds_read_b128 v[196:199], v241 offset:8192
    v_exp_f32 v221, v145
    s_waitcnt lgkmcnt(4)
    v_mfma_f32_16x16x32_bf16 v[112:115], v[200:203], v[8:11], v[176:179]
    v_exp_f32 v222, v146
    v_mfma_f32_16x16x32_bf16 v[112:115], v[204:207], v[16:19], v[112:115]
    v_exp_f32 v223, v147
    v_add_f32 v236, v236, v221
    v_cvt_pk_bf16_f32 v170, v220, v221
    v_mfma_f32_16x16x32_bf16 v[112:115], v[208:211], v[24:27], v[112:115]
    v_add_f32 v236, v236, v222
    v_add_f32 v236, v236, v223
    v_mfma_f32_16x16x32_bf16 v[112:115], v[212:215], v[32:35], v[112:115]
    v_cvt_pk_bf16_f32 v171, v222, v223
    v_exp_f32 v216, v140
    v_mfma_f32_16x16x32_bf16 v[116:119], v[200:203], v[12:15], v[180:183]
    ds_read_b128 v[200:203], v238 offset:12288
    v_mfma_f32_16x16x32_bf16 v[116:119], v[204:207], v[20:23], v[116:119]
    ds_read_b128 v[204:207], v239 offset:12288
    v_exp_f32 v217, v141
    v_mfma_f32_16x16x32_bf16 v[116:119], v[208:211], v[28:31], v[116:119]
    ds_read_b128 v[208:211], v240 offset:12288
    v_add_f32 v237, v216, v217
    v_mfma_f32_16x16x32_bf16 v[116:119], v[212:215], v[36:39], v[116:119]
    ds_read_b128 v[212:215], v241 offset:12288
    v_exp_f32 v218, v142
    s_waitcnt lgkmcnt(4)
    v_mfma_f32_16x16x32_bf16 v[120:123], v[184:187], v[8:11], v[176:179]
    v_exp_f32 v219, v143
    v_mfma_f32_16x16x32_bf16 v[120:123], v[188:191], v[16:19], v[120:123]
    v_cvt_pk_bf16_f32 v172, v216, v217
    v_add_f32 v237, v237, v218
    v_add_f32 v237, v237, v219
    v_cvt_pk_bf16_f32 v173, v218, v219
    v_mfma_f32_16x16x32_bf16 v[120:123], v[192:195], v[24:27], v[120:123]
    v_exp_f32 v220, v148
    v_mfma_f32_16x16x32_bf16 v[120:123], v[196:199], v[32:35], v[120:123]
    v_exp_f32 v221, v149
    s_waitcnt lgkmcnt(0)
    s_barrier
    v_mfma_f32_16x16x32_bf16 v[124:127], v[184:187], v[12:15], v[180:183]
    ds_read_b64_tr_b16 v[184:185], v242 offset:49152
    v_add_f32 v237, v237, v220
    v_mfma_f32_16x16x32_bf16 v[124:127], v[188:191], v[20:23], v[124:127]
    ds_read_b64_tr_b16 v[186:187], v242 offset:53248
    ds_read_b64_tr_b16 v[188:189], v242 offset:57344
    v_exp_f32 v222, v150
    v_mfma_f32_16x16x32_bf16 v[124:127], v[192:195], v[28:31], v[124:127]
    ds_read_b64_tr_b16 v[190:191], v242 offset:61440
    v_add_f32 v237, v237, v221
    v_mfma_f32_16x16x32_bf16 v[124:127], v[196:199], v[36:39], v[124:127]
    ds_read_b64_tr_b16 v[192:193], v243 offset:49152
    ds_read_b64_tr_b16 v[194:195], v243 offset:53248
    v_cvt_pk_bf16_f32 v174, v220, v221
    v_mfma_f32_16x16x32_bf16 v[128:131], v[200:203], v[8:11], v[176:179]
    ds_read_b64_tr_b16 v[196:197], v243 offset:57344
    v_add_f32 v237, v237, v222
    v_mfma_f32_16x16x32_bf16 v[128:131], v[204:207], v[16:19], v[128:131]
    ds_read_b64_tr_b16 v[198:199], v243 offset:61440
    v_exp_f32 v223, v151
    v_mfma_f32_16x16x32_bf16 v[128:131], v[208:211], v[24:27], v[128:131]
    v_add_f32 v237, v237, v223
    v_cvt_pk_bf16_f32 v175, v222, v223
    v_mfma_f32_16x16x32_bf16 v[128:131], v[212:215], v[32:35], v[128:131]
    v_max_f32 v224, v236, v237
    v_cmp_lt_f32 vcc, s39, v224
    v_mfma_f32_16x16x32_bf16 v[132:135], v[200:203], v[12:15], v[180:183]
    ds_read_b64_tr_b16 v[200:201], v244 offset:49152
    v_mfma_f32_16x16x32_bf16 v[132:135], v[204:207], v[20:23], v[132:135]
    ds_read_b64_tr_b16 v[202:203], v244 offset:53248
    ds_read_b64_tr_b16 v[204:205], v244 offset:57344
    v_mfma_f32_16x16x32_bf16 v[132:135], v[208:211], v[28:31], v[132:135]
    ds_read_b64_tr_b16 v[206:207], v244 offset:61440
    v_mfma_f32_16x16x32_bf16 v[132:135], v[212:215], v[36:39], v[132:135]
    ds_read_b64_tr_b16 v[208:209], v245 offset:49152
    ds_read_b64_tr_b16 v[210:211], v245 offset:53248
    s_cbranch_vccnz L_fb_L3_1
L_ret_L3_1:
    v_add_f32 v232, v232, v236
    v_add_f32 v233, v233, v237
    s_waitcnt lgkmcnt(10)
    v_mfma_f32_16x16x32_bf16 v[40:43], v[184:187], v[160:163], v[40:43]
    ds_read_b64_tr_b16 v[212:213], v245 offset:57344
    v_mfma_f32_16x16x32_bf16 v[40:43], v[188:191], v[168:171], v[40:43]
    ds_read_b64_tr_b16 v[214:215], v245 offset:61440
    v_exp_f32 v216, v104
    v_exp_f32 v217, v105
    v_mfma_f32_16x16x32_bf16 v[44:47], v[188:191], v[172:175], v[44:47]
    ds_read_b64_tr_b16 v[188:189], v246 offset:57344
    v_add_f32 v236, v216, v217
    v_mfma_f32_16x16x32_bf16 v[44:47], v[184:187], v[164:167], v[44:47]
    ds_read_b64_tr_b16 v[190:191], v246 offset:61440
    ds_read_b64_tr_b16 v[184:185], v246 offset:49152
    v_exp_f32 v218, v106
    s_waitcnt lgkmcnt(11)
    v_mfma_f32_16x16x32_bf16 v[48:51], v[192:195], v[160:163], v[48:51]
    ds_read_b64_tr_b16 v[186:187], v246 offset:53248
    v_cvt_pk_bf16_f32 v152, v216, v217
    v_mfma_f32_16x16x32_bf16 v[48:51], v[196:199], v[168:171], v[48:51]
    v_exp_f32 v219, v107
    v_add_f32 v236, v236, v218
    v_add_f32 v236, v236, v219
    v_cvt_pk_bf16_f32 v153, v218, v219
    v_mfma_f32_16x16x32_bf16 v[52:55], v[196:199], v[172:175], v[52:55]
    ds_read_b64_tr_b16 v[196:197], v247 offset:57344
    v_mfma_f32_16x16x32_bf16 v[52:55], v[192:195], v[164:167], v[52:55]
    ds_read_b64_tr_b16 v[198:199], v247 offset:61440
    ds_read_b64_tr_b16 v[192:193], v247 offset:49152
    v_exp_f32 v220, v112
    s_waitcnt lgkmcnt(11)
    v_mfma_f32_16x16x32_bf16 v[56:59], v[200:203], v[160:163], v[56:59]
    ds_read_b64_tr_b16 v[194:195], v247 offset:53248
    v_add_f32 v236, v236, v220
    v_mfma_f32_16x16x32_bf16 v[56:59], v[204:207], v[168:171], v[56:59]
    v_exp_f32 v221, v113
    v_exp_f32 v222, v114
    v_add_f32 v236, v236, v221
    v_mfma_f32_16x16x32_bf16 v[60:63], v[204:207], v[172:175], v[60:63]
    ds_read_b64_tr_b16 v[204:205], v248 offset:57344
    v_cvt_pk_bf16_f32 v154, v220, v221
    v_mfma_f32_16x16x32_bf16 v[60:63], v[200:203], v[164:167], v[60:63]
    ds_read_b64_tr_b16 v[206:207], v248 offset:61440
    ds_read_b64_tr_b16 v[200:201], v248 offset:49152
    v_exp_f32 v223, v115
    s_waitcnt lgkmcnt(11)
    v_mfma_f32_16x16x32_bf16 v[64:67], v[208:211], v[160:163], v[64:67]
    ds_read_b64_tr_b16 v[202:203], v248 offset:53248
    v_add_f32 v236, v236, v222
    v_mfma_f32_16x16x32_bf16 v[64:67], v[212:215], v[168:171], v[64:67]
    v_add_f32 v236, v236, v223
    v_cvt_pk_bf16_f32 v155, v222, v223
    v_exp_f32 v216, v108
    v_mfma_f32_16x16x32_bf16 v[68:71], v[212:215], v[172:175], v[68:71]
    ds_read_b64_tr_b16 v[212:213], v249 offset:57344
    v_mfma_f32_16x16x32_bf16 v[68:71], v[208:211], v[164:167], v[68:71]
    ds_read_b64_tr_b16 v[214:215], v249 offset:61440
    ds_read_b64_tr_b16 v[208:209], v249 offset:49152
    v_exp_f32 v217, v109
    s_waitcnt lgkmcnt(11)
    v_mfma_f32_16x16x32_bf16 v[72:75], v[184:187], v[160:163], v[72:75]
    ds_read_b64_tr_b16 v[210:211], v249 offset:53248
    v_add_f32 v237, v216, v217
    v_mfma_f32_16x16x32_bf16 v[72:75], v[188:191], v[168:171], v[72:75]
    v_exp_f32 v218, v110
    v_exp_f32 v219, v111
    v_cvt_pk_bf16_f32 v156, v216, v217
    v_mfma_f32_16x16x32_bf16 v[76:79], v[188:191], v[172:175], v[76:79]
    v_add_f32 v237, v237, v218
    v_add_f32 v237, v237, v219
    v_mfma_f32_16x16x32_bf16 v[76:79], v[184:187], v[164:167], v[76:79]
    v_cvt_pk_bf16_f32 v157, v218, v219
    v_exp_f32 v220, v116
    s_waitcnt lgkmcnt(8)
    v_mfma_f32_16x16x32_bf16 v[80:83], v[192:195], v[160:163], v[80:83]
    v_exp_f32 v221, v117
    v_mfma_f32_16x16x32_bf16 v[80:83], v[196:199], v[168:171], v[80:83]
    v_exp_f32 v222, v118
    v_exp_f32 v223, v119
    v_add_f32 v237, v237, v220
    v_mfma_f32_16x16x32_bf16 v[84:87], v[196:199], v[172:175], v[84:87]
    v_add_f32 v237, v237, v221
    v_cvt_pk_bf16_f32 v158, v220, v221
    v_mfma_f32_16x16x32_bf16 v[84:87], v[192:195], v[164:167], v[84:87]
    v_add_f32 v237, v237, v222
    v_add_f32 v237, v237, v223
    s_waitcnt lgkmcnt(0)
    s_barrier
    v_mfma_f32_16x16x32_bf16 v[88:91], v[200:203], v[160:163], v[88:91]
    ds_read_b128 v[184:187], v238 offset:16384
    v_cvt_pk_bf16_f32 v159, v222, v223
    v_mfma_f32_16x16x32_bf16 v[88:91], v[204:207], v[168:171], v[88:91]
    ds_read_b128 v[188:191], v239 offset:16384
    ds_read_b128 v[192:195], v240 offset:16384
    v_max_f32 v224, v236, v237
    v_cmp_lt_f32 vcc, s39, v224
    v_mfma_f32_16x16x32_bf16 v[92:95], v[204:207], v[172:175], v[92:95]
    ds_read_b128 v[196:199], v241 offset:16384
    v_mfma_f32_16x16x32_bf16 v[92:95], v[200:203], v[164:167], v[92:95]
    ds_read_b128 v[200:203], v238 offset:20480
    ds_read_b128 v[204:207], v239 offset:20480
    v_mfma_f32_16x16x32_bf16 v[96:99], v[208:211], v[160:163], v[96:99]
    v_mfma_f32_16x16x32_bf16 v[96:99], v[212:215], v[168:171], v[96:99]
    v_mfma_f32_16x16x32_bf16 v[100:103], v[212:215], v[172:175], v[100:103]
    v_mfma_f32_16x16x32_bf16 v[100:103], v[208:211], v[164:167], v[100:103]
    ds_read_b128 v[208:211], v240 offset:20480
    ds_read_b128 v[212:215], v241 offset:20480
    s_cbranch_vccnz L_fb_L4_0
L_ret_L4_0:
    v_add_f32 v232, v232, v236
    v_add_f32 v233, v233, v237
    s_waitcnt lgkmcnt(4)
    v_mfma_f32_16x16x32_bf16 v[104:107], v[184:187], v[8:11], v[176:179]
    v_exp_f32 v216, v120
    v_mfma_f32_16x16x32_bf16 v[104:107], v[188:191], v[16:19], v[104:107]
    v_exp_f32 v217, v121
    v_exp_f32 v218, v122
    v_mfma_f32_16x16x32_bf16 v[104:107], v[192:195], v[24:27], v[104:107]
    v_exp_f32 v219, v123
    v_mfma_f32_16x16x32_bf16 v[104:107], v[196:199], v[32:35], v[104:107]
    v_add_f32 v236, v216, v217
    v_cvt_pk_bf16_f32 v168, v216, v217
    v_add_f32 v236, v236, v218
    v_add_f32 v236, v236, v219
    v_mfma_f32_16x16x32_bf16 v[108:111], v[184:187], v[12:15], v[180:183]
    ds_read_b128 v[184:187], v238 offset:24576
    v_cvt_pk_bf16_f32 v169, v218, v219
    v_mfma_f32_16x16x32_bf16 v[108:111], v[188:191], v[20:23], v[108:111]
    ds_read_b128 v[188:191], v239 offset:24576
    v_exp_f32 v220, v128
    v_mfma_f32_16x16x32_bf16 v[108:111], v[192:195], v[28:31], v[108:111]
    ds_read_b128 v[192:195], v240 offset:24576
    v_add_f32 v236, v236, v220
    v_mfma_f32_16x16x32_bf16 v[108:111], v[196:199], v[36:39], v[108:111]
    ds_read_b128 v[196:199], v241 offset:24576
    v_exp_f32 v221, v129
    s_waitcnt lgkmcnt(4)
    v_mfma_f32_16x16x32_bf16 v[112:115], v[200:203], v[8:11], v[176:179]
    v_exp_f32 v222, v130
    v_mfma_f32_16x16x32_bf16 v[112:115], v[204:207], v[16:19], v[112:115]
    v_exp_f32 v223, v131
    v_add_f32 v236, v236, v221
    v_cvt_pk_bf16_f32 v170, v220, v221
    v_mfma_f32_16x16x32_bf16 v[112:115], v[208:211], v[24:27], v[112:115]
    v_add_f32 v236, v236, v222
    v_add_f32 v236, v236, v223
    v_mfma_f32_16x16x32_bf16 v[112:115], v[212:215], v[32:35], v[112:115]
    v_cvt_pk_bf16_f32 v171, v222, v223
    v_exp_f32 v216, v124
    v_mfma_f32_16x16x32_bf16 v[116:119], v[200:203], v[12:15], v[180:183]
    ds_read_b128 v[200:203], v238 offset:28672
    v_mfma_f32_16x16x32_bf16 v[116:119], v[204:207], v[20:23], v[116:119]
    ds_read_b128 v[204:207], v239 offset:28672
    v_exp_f32 v217, v125
    v_mfma_f32_16x16x32_bf16 v[116:119], v[208:211], v[28:31], v[116:119]
    ds_read_b128 v[208:211], v240 offset:28672
    v_add_f32 v237, v216, v217
    v_mfma_f32_16x16x32_bf16 v[116:119], v[212:215], v[36:39], v[116:119]
    ds_read_b128 v[212:215], v241 offset:28672
    v_exp_f32 v218, v126
    s_waitcnt lgkmcnt(4)
    v_mfma_f32_16x16x32_bf16 v[136:139], v[184:187], v[8:11], v[176:179]
    v_exp_f32 v219, v127
    v_mfma_f32_16x16x32_bf16 v[136:139], v[188:191], v[16:19], v[136:139]
    v_cvt_pk_bf16_f32 v172, v216, v217
    v_add_f32 v237, v237, v218
    v_add_f32 v237, v237, v219
    v_cvt_pk_bf16_f32 v173, v218, v219
    v_mfma_f32_16x16x32_bf16 v[136:139], v[192:195], v[24:27], v[136:139]
    v_exp_f32 v220, v132
    v_mfma_f32_16x16x32_bf16 v[136:139], v[196:199], v[32:35], v[136:139]
    v_exp_f32 v221, v133
    s_waitcnt lgkmcnt(0)
    s_barrier
    v_mfma_f32_16x16x32_bf16 v[140:143], v[184:187], v[12:15], v[180:183]
    ds_read_b64_tr_b16 v[184:185], v242 offset:32768
    v_add_f32 v237, v237, v220
    v_mfma_f32_16x16x32_bf16 v[140:143], v[188:191], v[20:23], v[140:143]
    ds_read_b64_tr_b16 v[186:187], v242 offset:36864
    ds_read_b64_tr_b16 v[188:189], v242 offset:40960
    v_exp_f32 v222, v134
    v_mfma_f32_16x16x32_bf16 v[140:143], v[192:195], v[28:31], v[140:143]
    ds_read_b64_tr_b16 v[190:191], v242 offset:45056
    v_add_f32 v237, v237, v221
    v_mfma_f32_16x16x32_bf16 v[140:143], v[196:199], v[36:39], v[140:143]
    ds_read_b64_tr_b16 v[192:193], v243 offset:32768
    ds_read_b64_tr_b16 v[194:195], v243 offset:36864
    v_cvt_pk_bf16_f32 v174, v220, v221
    v_mfma_f32_16x16x32_bf16 v[144:147], v[200:203], v[8:11], v[176:179]
    ds_read_b64_tr_b16 v[196:197], v243 offset:40960
    v_add_f32 v237, v237, v222
    v_mfma_f32_16x16x32_bf16 v[144:147], v[204:207], v[16:19], v[144:147]
    ds_read_b64_tr_b16 v[198:199], v243 offset:45056
    v_exp_f32 v223, v135
    v_mfma_f32_16x16x32_bf16 v[144:147], v[208:211], v[24:27], v[144:147]
    v_add_f32 v237, v237, v223
    v_cvt_pk_bf16_f32 v175, v222, v223
    v_mfma_f32_16x16x32_bf16 v[144:147], v[212:215], v[32:35], v[144:147]
    v_max_f32 v224, v236, v237
    v_cmp_lt_f32 vcc, s39, v224
    v_mfma_f32_16x16x32_bf16 v[148:151], v[200:203], v[12:15], v[180:183]
    ds_read_b64_tr_b16 v[200:201], v244 offset:32768
    v_mfma_f32_16x16x32_bf16 v[148:151], v[204:207], v[20:23], v[148:151]
    ds_read_b64_tr_b16 v[202:203], v244 offset:36864
    ds_read_b64_tr_b16 v[204:205], v244 offset:40960
    v_mfma_f32_16x16x32_bf16 v[148:151], v[208:211], v[28:31], v[148:151]
    ds_read_b64_tr_b16 v[206:207], v244 offset:45056
    v_mfma_f32_16x16x32_bf16 v[148:151], v[212:215], v[36:39], v[148:151]
    ds_read_b64_tr_b16 v[208:209], v245 offset:32768
    ds_read_b64_tr_b16 v[210:211], v245 offset:36864
    s_cbranch_vccnz L_fb_L4_1
L_ret_L4_1:
    v_add_f32 v232, v232, v236
    v_add_f32 v233, v233, v237
    s_waitcnt lgkmcnt(10)
    v_mfma_f32_16x16x32_bf16 v[40:43], v[184:187], v[152:155], v[40:43]
    ds_read_b64_tr_b16 v[212:213], v245 offset:40960
    v_mfma_f32_16x16x32_bf16 v[40:43], v[188:191], v[168:171], v[40:43]
    ds_read_b64_tr_b16 v[214:215], v245 offset:45056
    v_exp_f32 v216, v104
    v_exp_f32 v217, v105
    v_mfma_f32_16x16x32_bf16 v[44:47], v[188:191], v[172:175], v[44:47]
    ds_read_b64_tr_b16 v[188:189], v246 offset:40960
    v_add_f32 v236, v216, v217
    v_mfma_f32_16x16x32_bf16 v[44:47], v[184:187], v[156:159], v[44:47]
    ds_read_b64_tr_b16 v[190:191], v246 offset:45056
    ds_read_b64_tr_b16 v[184:185], v246 offset:32768
    v_exp_f32 v218, v106
    s_waitcnt lgkmcnt(11)
    v_mfma_f32_16x16x32_bf16 v[48:51], v[192:195], v[152:155], v[48:51]
    ds_read_b64_tr_b16 v[186:187], v246 offset:36864
    v_cvt_pk_bf16_f32 v160, v216, v217
    v_mfma_f32_16x16x32_bf16 v[48:51], v[196:199], v[168:171], v[48:51]
    v_exp_f32 v219, v107
    v_add_f32 v236, v236, v218
    v_add_f32 v236, v236, v219
    v_cvt_pk_bf16_f32 v161, v218, v219
    v_mfma_f32_16x16x32_bf16 v[52:55], v[196:199], v[172:175], v[52:55]
    ds_read_b64_tr_b16 v[196:197], v247 offset:40960
    v_mfma_f32_16x16x32_bf16 v[52:55], v[192:195], v[156:159], v[52:55]
    ds_read_b64_tr_b16 v[198:199], v247 offset:45056
    ds_read_b64_tr_b16 v[192:193], v247 offset:32768
    v_exp_f32 v220, v112
    s_waitcnt lgkmcnt(11)
    v_mfma_f32_16x16x32_bf16 v[56:59], v[200:203], v[152:155], v[56:59]
    ds_read_b64_tr_b16 v[194:195], v247 offset:36864
    v_add_f32 v236, v236, v220
    v_mfma_f32_16x16x32_bf16 v[56:59], v[204:207], v[168:171], v[56:59]
    v_exp_f32 v221, v113
    v_exp_f32 v222, v114
    v_add_f32 v236, v236, v221
    v_mfma_f32_16x16x32_bf16 v[60:63], v[204:207], v[172:175], v[60:63]
    ds_read_b64_tr_b16 v[204:205], v248 offset:40960
    v_cvt_pk_bf16_f32 v162, v220, v221
    v_mfma_f32_16x16x32_bf16 v[60:63], v[200:203], v[156:159], v[60:63]
    ds_read_b64_tr_b16 v[206:207], v248 offset:45056
    ds_read_b64_tr_b16 v[200:201], v248 offset:32768
    v_exp_f32 v223, v115
    s_waitcnt lgkmcnt(11)
    v_mfma_f32_16x16x32_bf16 v[64:67], v[208:211], v[152:155], v[64:67]
    ds_read_b64_tr_b16 v[202:203], v248 offset:36864
    v_add_f32 v236, v236, v222
    v_mfma_f32_16x16x32_bf16 v[64:67], v[212:215], v[168:171], v[64:67]
    v_add_f32 v236, v236, v223
    v_cvt_pk_bf16_f32 v163, v222, v223
    v_exp_f32 v216, v108
    v_mfma_f32_16x16x32_bf16 v[68:71], v[212:215], v[172:175], v[68:71]
    ds_read_b64_tr_b16 v[212:213], v249 offset:40960
    v_mfma_f32_16x16x32_bf16 v[68:71], v[208:211], v[156:159], v[68:71]
    ds_read_b64_tr_b16 v[214:215], v249 offset:45056
    ds_read_b64_tr_b16 v[208:209], v249 offset:32768
    v_exp_f32 v217, v109
    s_waitcnt lgkmcnt(11)
    v_mfma_f32_16x16x32_bf16 v[72:75], v[184:187], v[152:155], v[72:75]
    ds_read_b64_tr_b16 v[210:211], v249 offset:36864
    v_add_f32 v237, v216, v217
    v_mfma_f32_16x16x32_bf16 v[72:75], v[188:191], v[168:171], v[72:75]
    v_exp_f32 v218, v110
    v_exp_f32 v219, v111
    v_cvt_pk_bf16_f32 v164, v216, v217
    v_mfma_f32_16x16x32_bf16 v[76:79], v[188:191], v[172:175], v[76:79]
    v_add_f32 v237, v237, v218
    v_add_f32 v237, v237, v219
    v_mfma_f32_16x16x32_bf16 v[76:79], v[184:187], v[156:159], v[76:79]
    v_cvt_pk_bf16_f32 v165, v218, v219
    v_exp_f32 v220, v116
    s_waitcnt lgkmcnt(8)
    v_mfma_f32_16x16x32_bf16 v[80:83], v[192:195], v[152:155], v[80:83]
    v_exp_f32 v221, v117
    v_mfma_f32_16x16x32_bf16 v[80:83], v[196:199], v[168:171], v[80:83]
    v_exp_f32 v222, v118
    v_exp_f32 v223, v119
    v_add_f32 v237, v237, v220
    v_mfma_f32_16x16x32_bf16 v[84:87], v[196:199], v[172:175], v[84:87]
    v_add_f32 v237, v237, v221
    v_cvt_pk_bf16_f32 v166, v220, v221
    v_mfma_f32_16x16x32_bf16 v[84:87], v[192:195], v[156:159], v[84:87]
    v_add_f32 v237, v237, v222
    v_add_f32 v237, v237, v223
    s_waitcnt lgkmcnt(0)
    s_barrier
    v_mfma_f32_16x16x32_bf16 v[88:91], v[200:203], v[152:155], v[88:91]
    ds_read_b128 v[184:187], v238 offset:0
    v_cvt_pk_bf16_f32 v167, v222, v223
    v_mfma_f32_16x16x32_bf16 v[88:91], v[204:207], v[168:171], v[88:91]
    ds_read_b128 v[188:191], v239 offset:0
    ds_read_b128 v[192:195], v240 offset:0
    v_max_f32 v224, v236, v237
    v_cmp_lt_f32 vcc, s39, v224
    v_mfma_f32_16x16x32_bf16 v[92:95], v[204:207], v[172:175], v[92:95]
    ds_read_b128 v[196:199], v241 offset:0
    v_mfma_f32_16x16x32_bf16 v[92:95], v[200:203], v[156:159], v[92:95]
    ds_read_b128 v[200:203], v238 offset:4096
    ds_read_b128 v[204:207], v239 offset:4096
    v_mfma_f32_16x16x32_bf16 v[96:99], v[208:211], v[152:155], v[96:99]
    v_mfma_f32_16x16x32_bf16 v[96:99], v[212:215], v[168:171], v[96:99]
    v_mfma_f32_16x16x32_bf16 v[100:103], v[212:215], v[172:175], v[100:103]
    v_mfma_f32_16x16x32_bf16 v[100:103], v[208:211], v[156:159], v[100:103]
    ds_read_b128 v[208:211], v240 offset:4096
    ds_read_b128 v[212:215], v241 offset:4096
    s_cbranch_vccnz L_fb_L5_0
L_ret_L5_0:
    v_add_f32 v232, v232, v236
    v_add_f32 v233, v233, v237
    s_waitcnt lgkmcnt(4)
    v_mfma_f32_16x16x32_bf16 v[104:107], v[184:187], v[8:11], v[176:179]
    v_exp_f32 v216, v136
    v_mfma_f32_16x16x32_bf16 v[104:107], v[188:191], v[16:19], v[104:107]
    v_exp_f32 v217, v137
    v_exp_f32 v218, v138
    v_mfma_f32_16x16x32_bf16 v[104:107], v[192:195], v[24:27], v[104:107]
    v_exp_f32 v219, v139
    v_mfma_f32_16x16x32_bf16 v[104:107], v[196:199], v[32:35], v[104:107]
    v_add_f32 v236, v216, v217
    v_cvt_pk_bf16_f32 v168, v216, v217
    v_add_f32 v236, v236, v218
    v_add_f32 v236, v236, v219
    v_mfma_f32_16x16x32_bf16 v[108:111], v[184:187], v[12:15], v[180:183]
    ds_read_b128 v[184:187], v238 offset:8192
    v_cvt_pk_bf16_f32 v169, v218, v219
    v_mfma_f32_16x16x32_bf16 v[108:111], v[188:191], v[20:23], v[108:111]
    ds_read_b128 v[188:191], v239 offset:8192
    v_exp_f32 v220, v144
    v_mfma_f32_16x16x32_bf16 v[108:111], v[192:195], v[28:31], v[108:111]
    ds_read_b128 v[192:195], v240 offset:8192
    v_add_f32 v236, v236, v220
    v_mfma_f32_16x16x32_bf16 v[108:111], v[196:199], v[36:39], v[108:111]
    ds_read_b128 v[196:199], v241 offset:8192
    v_exp_f32 v221, v145
    s_waitcnt lgkmcnt(4)
    v_mfma_f32_16x16x32_bf16 v[112:115], v[200:203], v[8:11], v[176:179]
    v_exp_f32 v222, v146
    v_mfma_f32_16x16x32_bf16 v[112:115], v[204:207], v[16:19], v[112:115]
    v_exp_f32 v223, v147
    v_add_f32 v236, v236, v221
    v_cvt_pk_bf16_f32 v170, v220, v221
    v_mfma_f32_16x16x32_bf16 v[112:115], v[208:211], v[24:27], v[112:115]
    v_add_f32 v236, v236, v222
    v_add_f32 v236, v236, v223
    v_mfma_f32_16x16x32_bf16 v[112:115], v[212:215], v[32:35], v[112:115]
    v_cvt_pk_bf16_f32 v171, v222, v223
    v_exp_f32 v216, v140
    v_mfma_f32_16x16x32_bf16 v[116:119], v[200:203], v[12:15], v[180:183]
    ds_read_b128 v[200:203], v238 offset:12288
    v_mfma_f32_16x16x32_bf16 v[116:119], v[204:207], v[20:23], v[116:119]
    ds_read_b128 v[204:207], v239 offset:12288
    v_exp_f32 v217, v141
    v_mfma_f32_16x16x32_bf16 v[116:119], v[208:211], v[28:31], v[116:119]
    ds_read_b128 v[208:211], v240 offset:12288
    v_add_f32 v237, v216, v217
    v_mfma_f32_16x16x32_bf16 v[116:119], v[212:215], v[36:39], v[116:119]
    ds_read_b128 v[212:215], v241 offset:12288
    v_exp_f32 v218, v142
    s_waitcnt lgkmcnt(4)
    v_mfma_f32_16x16x32_bf16 v[120:123], v[184:187], v[8:11], v[176:179]
    v_exp_f32 v219, v143
    v_mfma_f32_16x16x32_bf16 v[120:123], v[188:191], v[16:19], v[120:123]
    v_cvt_pk_bf16_f32 v172, v216, v217
    v_add_f32 v237, v237, v218
    v_add_f32 v237, v237, v219
    v_cvt_pk_bf16_f32 v173, v218, v219
    v_mfma_f32_16x16x32_bf16 v[120:123], v[192:195], v[24:27], v[120:123]
    v_exp_f32 v220, v148
    v_mfma_f32_16x16x32_bf16 v[120:123], v[196:199], v[32:35], v[120:123]
    v_exp_f32 v221, v149
    s_waitcnt lgkmcnt(0)
    s_barrier
    v_mfma_f32_16x16x32_bf16 v[124:127], v[184:187], v[12:15], v[180:183]
    ds_read_b64_tr_b16 v[184:185], v242 offset:49152
    v_add_f32 v237, v237, v220
    v_mfma_f32_16x16x32_bf16 v[124:127], v[188:191], v[20:23], v[124:127]
    ds_read_b64_tr_b16 v[186:187], v242 offset:53248
    ds_read_b64_tr_b16 v[188:189], v242 offset:57344
    v_exp_f32 v222, v150
    v_mfma_f32_16x16x32_bf16 v[124:127], v[192:195], v[28:31], v[124:127]
    ds_read_b64_tr_b16 v[190:191], v242 offset:61440
    v_add_f32 v237, v237, v221
    v_mfma_f32_16x16x32_bf16 v[124:127], v[196:199], v[36:39], v[124:127]
    ds_read_b64_tr_b16 v[192:193], v243 offset:49152
    ds_read_b64_tr_b16 v[194:195], v243 offset:53248
    v_cvt_pk_bf16_f32 v174, v220, v221
    v_mfma_f32_16x16x32_bf16 v[128:131], v[200:203], v[8:11], v[176:179]
    ds_read_b64_tr_b16 v[196:197], v243 offset:57344
    v_add_f32 v237, v237, v222
    v_mfma_f32_16x16x32_bf16 v[128:131], v[204:207], v[16:19], v[128:131]
    ds_read_b64_tr_b16 v[198:199], v243 offset:61440
    v_exp_f32 v223, v151
    v_mfma_f32_16x16x32_bf16 v[128:131], v[208:211], v[24:27], v[128:131]
    v_add_f32 v237, v237, v223
    v_cvt_pk_bf16_f32 v175, v222, v223
    v_mfma_f32_16x16x32_bf16 v[128:131], v[212:215], v[32:35], v[128:131]
    v_max_f32 v224, v236, v237
    v_cmp_lt_f32 vcc, s39, v224
    v_mfma_f32_16x16x32_bf16 v[132:135], v[200:203], v[12:15], v[180:183]
    ds_read_b64_tr_b16 v[200:201], v244 offset:49152
    v_mfma_f32_16x16x32_bf16 v[132:135], v[204:207], v[20:23], v[132:135]
    ds_read_b64_tr_b16 v[202:203], v244 offset:53248
    ds_read_b64_tr_b16 v[204:205], v244 offset:57344
    v_mfma_f32_16x16x32_bf16 v[132:135], v[208:211], v[28:31], v[132:135]
    ds_read_b64_tr_b16 v[206:207], v244 offset:61440
    v_mfma_f32_16x16x32_bf16 v[132:135], v[212:215], v[36:39], v[132:135]
    ds_read_b64_tr_b16 v[208:209], v245 offset:49152
    ds_read_b64_tr_b16 v[210:211], v245 offset:53248
    s_cbranch_vccnz L_fb_L5_1
L_ret_L5_1:
    v_add_f32 v232, v232, v236
    v_add_f32 v233, v233, v237
    s_waitcnt lgkmcnt(10)
    v_mfma_f32_16x16x32_bf16 v[40:43], v[184:187], v[160:163], v[40:43]
    ds_read_b64_tr_b16 v[212:213], v245 offset:57344
    v_mfma_f32_16x16x32_bf16 v[40:43], v[188:191], v[168:171], v[40:43]
    ds_read_b64_tr_b16 v[214:215], v245 offset:61440
    v_exp_f32 v216, v104
    v_exp_f32 v217, v105
    v_mfma_f32_16x16x32_bf16 v[44:47], v[188:191], v[172:175], v[44:47]
    ds_read_b64_tr_b16 v[188:189], v246 offset:57344
    v_add_f32 v236, v216, v217
    v_mfma_f32_16x16x32_bf16 v[44:47], v[184:187], v[164:167], v[44:47]
    ds_read_b64_tr_b16 v[190:191], v246 offset:61440
    ds_read_b64_tr_b16 v[184:185], v246 offset:49152
    v_exp_f32 v218, v106
    s_waitcnt lgkmcnt(11)
    v_mfma_f32_16x16x32_bf16 v[48:51], v[192:195], v[160:163], v[48:51]
    ds_read_b64_tr_b16 v[186:187], v246 offset:53248
    v_cvt_pk_bf16_f32 v152, v216, v217
    v_mfma_f32_16x16x32_bf16 v[48:51], v[196:199], v[168:171], v[48:51]
    v_exp_f32 v219, v107
    v_add_f32 v236, v236, v218
    v_add_f32 v236, v236, v219
    v_cvt_pk_bf16_f32 v153, v218, v219
    v_mfma_f32_16x16x32_bf16 v[52:55], v[196:199], v[172:175], v[52:55]
    ds_read_b64_tr_b16 v[196:197], v247 offset:57344
    v_mfma_f32_16x16x32_bf16 v[52:55], v[192:195], v[164:167], v[52:55]
    ds_read_b64_tr_b16 v[198:199], v247 offset:61440
    ds_read_b64_tr_b16 v[192:193], v247 offset:49152
    v_exp_f32 v220, v112
    s_waitcnt lgkmcnt(11)
    v_mfma_f32_16x16x32_bf16 v[56:59], v[200:203], v[160:163], v[56:59]
    ds_read_b64_tr_b16 v[194:195], v247 offset:53248
    v_add_f32 v236, v236, v220
    v_mfma_f32_16x16x32_bf16 v[56:59], v[204:207], v[168:171], v[56:59]
    v_exp_f32 v221, v113
    v_exp_f32 v222, v114
    v_add_f32 v236, v236, v221
    v_mfma_f32_16x16x32_bf16 v[60:63], v[204:207], v[172:175], v[60:63]
    ds_read_b64_tr_b16 v[204:205], v248 offset:57344
    v_cvt_pk_bf16_f32 v154, v220, v221
    v_mfma_f32_16x16x32_bf16 v[60:63], v[200:203], v[164:167], v[60:63]
    ds_read_b64_tr_b16 v[206:207], v248 offset:61440
    ds_read_b64_tr_b16 v[200:201], v248 offset:49152
    v_exp_f32 v223, v115
    s_waitcnt lgkmcnt(11)
    v_mfma_f32_16x16x32_bf16 v[64:67], v[208:211], v[160:163], v[64:67]
    ds_read_b64_tr_b16 v[202:203], v248 offset:53248
    v_add_f32 v236, v236, v222
    v_mfma_f32_16x16x32_bf16 v[64:67], v[212:215], v[168:171], v[64:67]
    v_add_f32 v236, v236, v223
    v_cvt_pk_bf16_f32 v155, v222, v223
    v_exp_f32 v216, v108
    v_mfma_f32_16x16x32_bf16 v[68:71], v[212:215], v[172:175], v[68:71]
    ds_read_b64_tr_b16 v[212:213], v249 offset:57344
    v_mfma_f32_16x16x32_bf16 v[68:71], v[208:211], v[164:167], v[68:71]
    ds_read_b64_tr_b16 v[214:215], v249 offset:61440
    ds_read_b64_tr_b16 v[208:209], v249 offset:49152
    v_exp_f32 v217, v109
    s_waitcnt lgkmcnt(11)
    v_mfma_f32_16x16x32_bf16 v[72:75], v[184:187], v[160:163], v[72:75]
    ds_read_b64_tr_b16 v[210:211], v249 offset:53248
    v_add_f32 v237, v216, v217
    v_mfma_f32_16x16x32_bf16 v[72:75], v[188:191], v[168:171], v[72:75]
    v_exp_f32 v218, v110
    v_exp_f32 v219, v111
    v_cvt_pk_bf16_f32 v156, v216, v217
    v_mfma_f32_16x16x32_bf16 v[76:79], v[188:191], v[172:175], v[76:79]
    v_add_f32 v237, v237, v218
    v_add_f32 v237, v237, v219
    v_mfma_f32_16x16x32_bf16 v[76:79], v[184:187], v[164:167], v[76:79]
    v_cvt_pk_bf16_f32 v157, v218, v219
    v_exp_f32 v220, v116
    s_waitcnt lgkmcnt(8)
    v_mfma_f32_16x16x32_bf16 v[80:83], v[192:195], v[160:163], v[80:83]
    v_exp_f32 v221, v117
    v_mfma_f32_16x16x32_bf16 v[80:83], v[196:199], v[168:171], v[80:83]
    v_exp_f32 v222, v118
    v_exp_f32 v223, v119
    v_add_f32 v237, v237, v220
    v_mfma_f32_16x16x32_bf16 v[84:87], v[196:199], v[172:175], v[84:87]
    v_add_f32 v237, v237, v221
    v_cvt_pk_bf16_f32 v158, v220, v221
    v_mfma_f32_16x16x32_bf16 v[84:87], v[192:195], v[164:167], v[84:87]
    v_add_f32 v237, v237, v222
    v_add_f32 v237, v237, v223
    s_waitcnt lgkmcnt(0)
    s_barrier
    v_mfma_f32_16x16x32_bf16 v[88:91], v[200:203], v[160:163], v[88:91]
    ds_read_b128 v[184:187], v238 offset:16384
    v_cvt_pk_bf16_f32 v159, v222, v223
    v_mfma_f32_16x16x32_bf16 v[88:91], v[204:207], v[168:171], v[88:91]
    ds_read_b128 v[188:191], v239 offset:16384
    ds_read_b128 v[192:195], v240 offset:16384
    v_max_f32 v224, v236, v237
    v_cmp_lt_f32 vcc, s39, v224
    v_mfma_f32_16x16x32_bf16 v[92:95], v[204:207], v[172:175], v[92:95]
    ds_read_b128 v[196:199], v241 offset:16384
    v_mfma_f32_16x16x32_bf16 v[92:95], v[200:203], v[164:167], v[92:95]
    ds_read_b128 v[200:203], v238 offset:20480
    ds_read_b128 v[204:207], v239 offset:20480
    v_mfma_f32_16x16x32_bf16 v[96:99], v[208:211], v[160:163], v[96:99]
    v_mfma_f32_16x16x32_bf16 v[96:99], v[212:215], v[168:171], v[96:99]
    v_mfma_f32_16x16x32_bf16 v[100:103], v[212:215], v[172:175], v[100:103]
    v_mfma_f32_16x16x32_bf16 v[100:103], v[208:211], v[164:167], v[100:103]
    ds_read_b128 v[208:211], v240 offset:20480
    ds_read_b128 v[212:215], v241 offset:20480
    s_cbranch_vccnz L_fb_L6_0
L_ret_L6_0:
    v_add_f32 v232, v232, v236
    v_add_f32 v233, v233, v237
    s_waitcnt lgkmcnt(4)
    v_mfma_f32_16x16x32_bf16 v[104:107], v[184:187], v[8:11], v[176:179]
    v_exp_f32 v216, v120
    v_mfma_f32_16x16x32_bf16 v[104:107], v[188:191], v[16:19], v[104:107]
    v_exp_f32 v217, v121
    v_exp_f32 v218, v122
    v_mfma_f32_16x16x32_bf16 v[104:107], v[192:195], v[24:27], v[104:107]
    v_exp_f32 v219, v123
    v_mfma_f32_16x16x32_bf16 v[104:107], v[196:199], v[32:35], v[104:107]
    v_add_f32 v236, v216, v217
    v_cvt_pk_bf16_f32 v168, v216, v217
    v_add_f32 v236, v236, v218
    v_add_f32 v236, v236, v219
    v_mfma_f32_16x16x32_bf16 v[108:111], v[184:187], v[12:15], v[180:183]
    ds_read_b128 v[184:187], v238 offset:24576
    v_cvt_pk_bf16_f32 v169, v218, v219
    v_mfma_f32_16x16x32_bf16 v[108:111], v[188:191], v[20:23], v[108:111]
    ds_read_b128 v[188:191], v239 offset:24576
    v_exp_f32 v220, v128
    v_mfma_f32_16x16x32_bf16 v[108:111], v[192:195], v[28:31], v[108:111]
    ds_read_b128 v[192:195], v240 offset:24576
    v_add_f32 v236, v236, v220
    v_mfma_f32_16x16x32_bf16 v[108:111], v[196:199], v[36:39], v[108:111]
    ds_read_b128 v[196:199], v241 offset:24576
    v_exp_f32 v221, v129
    s_waitcnt lgkmcnt(4)
    v_mfma_f32_16x16x32_bf16 v[112:115], v[200:203], v[8:11], v[176:179]
    v_exp_f32 v222, v130
    v_mfma_f32_16x16x32_bf16 v[112:115], v[204:207], v[16:19], v[112:115]
    v_exp_f32 v223, v131
    v_add_f32 v236, v236, v221
    v_cvt_pk_bf16_f32 v170, v220, v221
    v_mfma_f32_16x16x32_bf16 v[112:115], v[208:211], v[24:27], v[112:115]
    v_add_f32 v236, v236, v222
    v_add_f32 v236, v236, v223
    v_mfma_f32_16x16x32_bf16 v[112:115], v[212:215], v[32:35], v[112:115]
    v_cvt_pk_bf16_f32 v171, v222, v223
    v_exp_f32 v216, v124
    v_mfma_f32_16x16x32_bf16 v[116:119], v[200:203], v[12:15], v[180:183]
    ds_read_b128 v[200:203], v238 offset:28672
    v_mfma_f32_16x16x32_bf16 v[116:119], v[204:207], v[20:23], v[116:119]
    ds_read_b128 v[204:207], v239 offset:28672
    v_exp_f32 v217, v125
    v_mfma_f32_16x16x32_bf16 v[116:119], v[208:211], v[28:31], v[116:119]
    ds_read_b128 v[208:211], v240 offset:28672
    v_add_f32 v237, v216, v217
    v_mfma_f32_16x16x32_bf16 v[116:119], v[212:215], v[36:39], v[116:119]
    ds_read_b128 v[212:215], v241 offset:28672
    v_exp_f32 v218, v126
    s_waitcnt lgkmcnt(4)
    v_mfma_f32_16x16x32_bf16 v[136:139], v[184:187], v[8:11], v[176:179]
    v_exp_f32 v219, v127
    v_mfma_f32_16x16x32_bf16 v[136:139], v[188:191], v[16:19], v[136:139]
    v_cvt_pk_bf16_f32 v172, v216, v217
    v_add_f32 v237, v237, v218
    v_add_f32 v237, v237, v219
    v_cvt_pk_bf16_f32 v173, v218, v219
    v_mfma_f32_16x16x32_bf16 v[136:139], v[192:195], v[24:27], v[136:139]
    v_exp_f32 v220, v132
    v_mfma_f32_16x16x32_bf16 v[136:139], v[196:199], v[32:35], v[136:139]
    v_exp_f32 v221, v133
    s_waitcnt lgkmcnt(0)
    s_barrier
    v_mfma_f32_16x16x32_bf16 v[140:143], v[184:187], v[12:15], v[180:183]
    ds_read_b64_tr_b16 v[184:185], v242 offset:32768
    v_add_f32 v237, v237, v220
    v_mfma_f32_16x16x32_bf16 v[140:143], v[188:191], v[20:23], v[140:143]
    ds_read_b64_tr_b16 v[186:187], v242 offset:36864
    ds_read_b64_tr_b16 v[188:189], v242 offset:40960
    v_exp_f32 v222, v134
    v_mfma_f32_16x16x32_bf16 v[140:143], v[192:195], v[28:31], v[140:143]
    ds_read_b64_tr_b16 v[190:191], v242 offset:45056
    v_add_f32 v237, v237, v221
    v_mfma_f32_16x16x32_bf16 v[140:143], v[196:199], v[36:39], v[140:143]
    ds_read_b64_tr_b16 v[192:193], v243 offset:32768
    ds_read_b64_tr_b16 v[194:195], v243 offset:36864
    v_cvt_pk_bf16_f32 v174, v220, v221
    v_mfma_f32_16x16x32_bf16 v[144:147], v[200:203], v[8:11], v[176:179]
    ds_read_b64_tr_b16 v[196:197], v243 offset:40960
    v_add_f32 v237, v237, v222
    v_mfma_f32_16x16x32_bf16 v[144:147], v[204:207], v[16:19], v[144:147]
    ds_read_b64_tr_b16 v[198:199], v243 offset:45056
    v_exp_f32 v223, v135
    v_mfma_f32_16x16x32_bf16 v[144:147], v[208:211], v[24:27], v[144:147]
    v_add_f32 v237, v237, v223
    v_cvt_pk_bf16_f32 v175, v222, v223
    v_mfma_f32_16x16x32_bf16 v[144:147], v[212:215], v[32:35], v[144:147]
    v_max_f32 v224, v236, v237
    v_cmp_lt_f32 vcc, s39, v224
    v_mfma_f32_16x16x32_bf16 v[148:151], v[200:203], v[12:15], v[180:183]
    ds_read_b64_tr_b16 v[200:201], v244 offset:32768
    v_mfma_f32_16x16x32_bf16 v[148:151], v[204:207], v[20:23], v[148:151]
    ds_read_b64_tr_b16 v[202:203], v244 offset:36864
    ds_read_b64_tr_b16 v[204:205], v244 offset:40960
    v_mfma_f32_16x16x32_bf16 v[148:151], v[208:211], v[28:31], v[148:151]
    ds_read_b64_tr_b16 v[206:207], v244 offset:45056
    v_mfma_f32_16x16x32_bf16 v[148:151], v[212:215], v[36:39], v[148:151]
    ds_read_b64_tr_b16 v[208:209], v245 offset:32768
    ds_read_b64_tr_b16 v[210:211], v245 offset:36864
    s_cbranch_vccnz L_fb_L6_1
L_ret_L6_1:
    v_add_f32 v232, v232, v236
    v_add_f32 v233, v233, v237
    s_waitcnt lgkmcnt(10)
    v_mfma_f32_16x16x32_bf16 v[40:43], v[184:187], v[152:155], v[40:43]
    ds_read_b64_tr_b16 v[212:213], v245 offset:40960
    v_mfma_f32_16x16x32_bf16 v[40:43], v[188:191], v[168:171], v[40:43]
    ds_read_b64_tr_b16 v[214:215], v245 offset:45056
    v_exp_f32 v216, v104
    v_exp_f32 v217, v105
    v_mfma_f32_16x16x32_bf16 v[44:47], v[188:191], v[172:175], v[44:47]
    ds_read_b64_tr_b16 v[188:189], v246 offset:40960
    v_add_f32 v236, v216, v217
    v_mfma_f32_16x16x32_bf16 v[44:47], v[184:187], v[156:159], v[44:47]
    ds_read_b64_tr_b16 v[190:191], v246 offset:45056
    ds_read_b64_tr_b16 v[184:185], v246 offset:32768
    v_exp_f32 v218, v106
    s_waitcnt lgkmcnt(11)
    v_mfma_f32_16x16x32_bf16 v[48:51], v[192:195], v[152:155], v[48:51]
    ds_read_b64_tr_b16 v[186:187], v246 offset:36864
    v_cvt_pk_bf16_f32 v160, v216, v217
    v_mfma_f32_16x16x32_bf16 v[48:51], v[196:199], v[168:171], v[48:51]
    ds_read_b128 v[8:11], v250 offset:0
    ds_read_b128 v[12:15], v250 offset:1024
    v_exp_f32 v219, v107
    v_add_f32 v236, v236, v218
    v_mfma_f32_16x16x32_bf16 v[52:55], v[196:199], v[172:175], v[52:55]
    ds_read_b64_tr_b16 v[196:197], v247 offset:40960
    v_add_f32 v236, v236, v219
    v_mfma_f32_16x16x32_bf16 v[52:55], v[192:195], v[156:159], v[52:55]
    ds_read_b64_tr_b16 v[198:199], v247 offset:45056
    ds_read_b64_tr_b16 v[192:193], v247 offset:32768
    v_cvt_pk_bf16_f32 v161, v218, v219
    s_waitcnt lgkmcnt(13)
    v_mfma_f32_16x16x32_bf16 v[56:59], v[200:203], v[152:155], v[56:59]
    ds_read_b64_tr_b16 v[194:195], v247 offset:36864
    v_mfma_f32_16x16x32_bf16 v[56:59], v[204:207], v[168:171], v[56:59]
    ds_read_b128 v[16:19], v250 offset:2048
    ds_read_b128 v[20:23], v250 offset:3072
    v_exp_f32 v220, v112
    v_mfma_f32_16x16x32_bf16 v[60:63], v[204:207], v[172:175], v[60:63]
    ds_read_b64_tr_b16 v[204:205], v248 offset:40960
    v_add_f32 v236, v236, v220
    v_mfma_f32_16x16x32_bf16 v[60:63], v[200:203], v[156:159], v[60:63]
    ds_read_b64_tr_b16 v[206:207], v248 offset:45056
    ds_read_b64_tr_b16 v[200:201], v248 offset:32768
    v_exp_f32 v221, v113
    s_waitcnt lgkmcnt(15)
    v_mfma_f32_16x16x32_bf16 v[64:67], v[208:211], v[152:155], v[64:67]
    ds_read_b64_tr_b16 v[202:203], v248 offset:36864
    v_add_f32 v236, v236, v221
    v_mfma_f32_16x16x32_bf16 v[64:67], v[212:215], v[168:171], v[64:67]
    ds_read_b128 v[24:27], v250 offset:4096
    ds_read_b128 v[28:31], v250 offset:5120
    v_exp_f32 v222, v114
    v_cvt_pk_bf16_f32 v162, v220, v221
    v_mfma_f32_16x16x32_bf16 v[68:71], v[212:215], v[172:175], v[68:71]
    ds_read_b64_tr_b16 v[212:213], v249 offset:40960
    v_add_f32 v236, v236, v222
    v_mfma_f32_16x16x32_bf16 v[68:71], v[208:211], v[156:159], v[68:71]
    ds_read_b64_tr_b16 v[214:215], v249 offset:45056
    ds_read_b64_tr_b16 v[208:209], v249 offset:32768
    v_exp_f32 v223, v115
    s_waitcnt lgkmcnt(15)
    v_mfma_f32_16x16x32_bf16 v[72:75], v[184:187], v[152:155], v[72:75]
    ds_read_b64_tr_b16 v[210:211], v249 offset:36864
    v_add_f32 v236, v236, v223
    v_mfma_f32_16x16x32_bf16 v[72:75], v[188:191], v[168:171], v[72:75]
    ds_read_b128 v[32:35], v250 offset:6144
    ds_read_b128 v[36:39], v250 offset:7168
    v_cvt_pk_bf16_f32 v163, v222, v223
    v_exp_f32 v216, v108
    v_mfma_f32_16x16x32_bf16 v[76:79], v[188:191], v[172:175], v[76:79]
    v_exp_f32 v217, v109
    v_mfma_f32_16x16x32_bf16 v[76:79], v[184:187], v[156:159], v[76:79]
    v_exp_f32 v218, v110
    v_exp_f32 v219, v111
    s_waitcnt lgkmcnt(14)
    v_mfma_f32_16x16x32_bf16 v[80:83], v[192:195], v[152:155], v[80:83]
    v_add_f32 v237, v216, v217
    v_cvt_pk_bf16_f32 v164, v216, v217
    v_mfma_f32_16x16x32_bf16 v[80:83], v[196:199], v[168:171], v[80:83]
    v_add_f32 v237, v237, v218
    v_add_f32 v237, v237, v219
    v_cvt_pk_bf16_f32 v165, v218, v219
    v_exp_f32 v220, v116
    v_mfma_f32_16x16x32_bf16 v[84:87], v[196:199], v[172:175], v[84:87]
    v_exp_f32 v221, v117
    v_mfma_f32_16x16x32_bf16 v[84:87], v[192:195], v[156:159], v[84:87]
    v_exp_f32 v222, v118
    s_waitcnt lgkmcnt(0)
    s_barrier
    s_cmp_eq_u32 s38, 3
    s_cbranch_scc1 L_Atail
    v_mfma_f32_16x16x32_bf16 v[88:91], v[200:203], v[152:155], v[88:91]
    ds_read_b128 v[184:187], v238 offset:0
    v_add_f32 v237, v237, v220
    v_mfma_f32_16x16x32_bf16 v[88:91], v[204:207], v[168:171], v[88:91]
    ds_read_b128 v[188:191], v239 offset:0
    ds_read_b128 v[192:195], v240 offset:0
    v_exp_f32 v223, v119
    v_add_f32 v237, v237, v221
    v_mfma_f32_16x16x32_bf16 v[92:95], v[204:207], v[172:175], v[92:95]
    ds_read_b128 v[196:199], v241 offset:0
    v_cvt_pk_bf16_f32 v166, v220, v221
    v_mfma_f32_16x16x32_bf16 v[92:95], v[200:203], v[156:159], v[92:95]
    ds_read_b128 v[200:203], v238 offset:4096
    ds_read_b128 v[204:207], v239 offset:4096
    v_add_f32 v237, v237, v222
    v_add_f32 v237, v237, v223
    v_mfma_f32_16x16x32_bf16 v[96:99], v[208:211], v[152:155], v[96:99]
    v_cvt_pk_bf16_f32 v167, v222, v223
    v_max_f32 v224, v236, v237
    v_mfma_f32_16x16x32_bf16 v[96:99], v[212:215], v[168:171], v[96:99]
    v_cmp_lt_f32 vcc, s39, v224
    v_mfma_f32_16x16x32_bf16 v[100:103], v[212:215], v[172:175], v[100:103]
    v_mfma_f32_16x16x32_bf16 v[100:103], v[208:211], v[156:159], v[100:103]
    ds_read_b128 v[208:211], v240 offset:4096
    ds_read_b128 v[212:215], v241 offset:4096
    s_cbranch_vccnz L_fb_L7_0
L_ret_L7_0:
    v_add_f32 v232, v232, v236
    v_add_f32 v233, v233, v237
    s_waitcnt lgkmcnt(4)
    v_mfma_f32_16x16x32_bf16 v[104:107], v[184:187], v[8:11], 0
    v_exp_f32 v216, v136
    v_mfma_f32_16x16x32_bf16 v[104:107], v[188:191], v[16:19], v[104:107]
    v_exp_f32 v217, v137
    v_exp_f32 v218, v138
    v_mfma_f32_16x16x32_bf16 v[104:107], v[192:195], v[24:27], v[104:107]
    v_exp_f32 v219, v139
    v_mfma_f32_16x16x32_bf16 v[104:107], v[196:199], v[32:35], v[104:107]
    v_add_f32 v236, v216, v217
    v_cvt_pk_bf16_f32 v168, v216, v217
    v_add_f32 v236, v236, v218
    v_add_f32 v236, v236, v219
    v_mfma_f32_16x16x32_bf16 v[108:111], v[184:187], v[12:15], 0
    ds_read_b128 v[184:187], v238 offset:8192
    v_cvt_pk_bf16_f32 v169, v218, v219
    v_mfma_f32_16x16x32_bf16 v[108:111], v[188:191], v[20:23], v[108:111]
    ds_read_b128 v[188:191], v239 offset:8192
    v_exp_f32 v220, v144
    v_mfma_f32_16x16x32_bf16 v[108:111], v[192:195], v[28:31], v[108:111]
    ds_read_b128 v[192:195], v240 offset:8192
    v_add_f32 v236, v236, v220
    v_mfma_f32_16x16x32_bf16 v[108:111], v[196:199], v[36:39], v[108:111]
    ds_read_b128 v[196:199], v241 offset:8192
    v_exp_f32 v221, v145
    s_waitcnt lgkmcnt(4)
    v_mfma_f32_16x16x32_bf16 v[112:115], v[200:203], v[8:11], 0
    v_exp_f32 v222, v146
    v_mfma_f32_16x16x32_bf16 v[112:115], v[204:207], v[16:19], v[112:115]
    v_exp_f32 v223, v147
    v_add_f32 v236, v236, v221
    v_cvt_pk_bf16_f32 v170, v220, v221
    v_mfma_f32_16x16x32_bf16 v[112:115], v[208:211], v[24:27], v[112:115]
    v_add_f32 v236, v236, v222
    v_add_f32 v236, v236, v223
    v_mfma_f32_16x16x32_bf16 v[112:115], v[212:215], v[32:35], v[112:115]
    v_cvt_pk_bf16_f32 v171, v222, v223
    v_exp_f32 v216, v140
    v_mfma_f32_16x16x32_bf16 v[116:119], v[200:203], v[12:15], 0
    ds_read_b128 v[200:203], v238 offset:12288
    v_mfma_f32_16x16x32_bf16 v[116:119], v[204:207], v[20:23], v[116:119]
    ds_read_b128 v[204:207], v239 offset:12288
    v_exp_f32 v217, v141
    v_mfma_f32_16x16x32_bf16 v[116:119], v[208:211], v[28:31], v[116:119]
    ds_read_b128 v[208:211], v240 offset:12288
    v_add_f32 v237, v216, v217
    v_mfma_f32_16x16x32_bf16 v[116:119], v[212:215], v[36:39], v[116:119]
    ds_read_b128 v[212:215], v241 offset:12288
    v_exp_f32 v218, v142
    s_waitcnt lgkmcnt(4)
    v_mfma_f32_16x16x32_bf16 v[120:123], v[184:187], v[8:11], 0
    v_exp_f32 v219, v143
    v_mfma_f32_16x16x32_bf16 v[120:123], v[188:191], v[16:19], v[120:123]
    v_cvt_pk_bf16_f32 v172, v216, v217
    v_add_f32 v237, v237, v218
    v_add_f32 v237, v237, v219
    v_cvt_pk_bf16_f32 v173, v218, v219
    v_mfma_f32_16x16x32_bf16 v[120:123], v[192:195], v[24:27], v[120:123]
    v_exp_f32 v220, v148
    v_mfma_f32_16x16x32_bf16 v[120:123], v[196:199], v[32:35], v[120:123]
    v_exp_f32 v221, v149
    s_waitcnt lgkmcnt(0)
    s_barrier
    v_mfma_f32_16x16x32_bf16 v[124:127], v[184:187], v[12:15], 0
    ds_read_b64_tr_b16 v[184:185], v242 offset:49152
    v_add_f32 v237, v237, v220
    v_mfma_f32_16x16x32_bf16 v[124:127], v[188:191], v[20:23], v[124:127]
    ds_read_b64_tr_b16 v[186:187], v242 offset:53248
    ds_read_b64_tr_b16 v[188:189], v242 offset:57344
    v_exp_f32 v222, v150
    v_mfma_f32_16x16x32_bf16 v[124:127], v[192:195], v[28:31], v[124:127]
    ds_read_b64_tr_b16 v[190:191], v242 offset:61440
    v_add_f32 v237, v237, v221
    v_mfma_f32_16x16x32_bf16 v[124:127], v[196:199], v[36:39], v[124:127]
    ds_read_b64_tr_b16 v[192:193], v243 offset:49152
    ds_read_b64_tr_b16 v[194:195], v243 offset:53248
    v_cvt_pk_bf16_f32 v174, v220, v221
    v_mfma_f32_16x16x32_bf16 v[128:131], v[200:203], v[8:11], 0
    ds_read_b64_tr_b16 v[196:197], v243 offset:57344
    v_add_f32 v237, v237, v222
    v_mfma_f32_16x16x32_bf16 v[128:131], v[204:207], v[16:19], v[128:131]
    ds_read_b64_tr_b16 v[198:199], v243 offset:61440
    v_exp_f32 v223, v151
    v_mfma_f32_16x16x32_bf16 v[128:131], v[208:211], v[24:27], v[128:131]
    v_add_f32 v237, v237, v223
    v_cvt_pk_bf16_f32 v175, v222, v223
    v_mfma_f32_16x16x32_bf16 v[128:131], v[212:215], v[32:35], v[128:131]
    v_max_f32 v224, v236, v237
    v_cmp_lt_f32 vcc, s39, v224
    v_mfma_f32_16x16x32_bf16 v[132:135], v[200:203], v[12:15], 0
    ds_read_b64_tr_b16 v[200:201], v244 offset:49152
    v_mfma_f32_16x16x32_bf16 v[132:135], v[204:207], v[20:23], v[132:135]
    ds_read_b64_tr_b16 v[202:203], v244 offset:53248
    ds_read_b64_tr_b16 v[204:205], v244 offset:57344
    v_mfma_f32_16x16x32_bf16 v[132:135], v[208:211], v[28:31], v[132:135]
    ds_read_b64_tr_b16 v[206:207], v244 offset:61440
    v_mfma_f32_16x16x32_bf16 v[132:135], v[212:215], v[36:39], v[132:135]
    ds_read_b64_tr_b16 v[208:209], v245 offset:49152
    ds_read_b64_tr_b16 v[210:211], v245 offset:53248
    s_cbranch_vccnz L_fb_L7_1
L_ret_L7_1:
    v_add_f32 v234, v232, v236
    v_add_f32 v235, v233, v237
    s_waitcnt lgkmcnt(10)
    v_mfma_f32_16x16x32_bf16 v[40:43], v[184:187], v[160:163], v[40:43]
    ds_read_b64_tr_b16 v[212:213], v245 offset:57344
    v_mfma_f32_16x16x32_bf16 v[40:43], v[188:191], v[168:171], v[40:43]
    ds_read_b64_tr_b16 v[214:215], v245 offset:61440
    v_mfma_f32_16x16x32_bf16 v[44:47], v[188:191], v[172:175], v[44:47]
    ds_read_b64_tr_b16 v[188:189], v246 offset:57344
    v_max3_f32 v224, v104, v105, v106
    v_mfma_f32_16x16x32_bf16 v[44:47], v[184:187], v[164:167], v[44:47]
    ds_read_b64_tr_b16 v[190:191], v246 offset:61440
    ds_read_b64_tr_b16 v[184:185], v246 offset:49152
    v_max3_f32 v225, v108, v109, v110
    v_max3_f32 v224, v224, v107, v112
    v_max3_f32 v225, v225, v111, v116
    v_max3_f32 v224, v224, v113, v114
    v_max3_f32 v225, v225, v117, v118
    v_max3_f32 v224, v224, v115, v120
    s_waitcnt lgkmcnt(11)
    v_mfma_f32_16x16x32_bf16 v[48:51], v[192:195], v[160:163], v[48:51]
    ds_read_b64_tr_b16 v[186:187], v246 offset:53248
    v_max3_f32 v225, v225, v119, v124
    v_mfma_f32_16x16x32_bf16 v[48:51], v[196:199], v[168:171], v[48:51]
    v_max3_f32 v224, v224, v121, v122
    v_max3_f32 v225, v225, v125, v126
    v_max3_f32 v224, v224, v123, v128
    v_max3_f32 v225, v225, v127, v132
    v_max3_f32 v224, v224, v129, v130
    v_max3_f32 v225, v225, v133, v134
    v_max_f32 v224, v224, v131
    v_max_f32 v225, v225, v135
    v_mov_b32 v226, v224
    v_mfma_f32_16x16x32_bf16 v[52:55], v[196:199], v[172:175], v[52:55]
    ds_read_b64_tr_b16 v[196:197], v247 offset:57344
    v_mov_b32 v227, v225
    v_mfma_f32_16x16x32_bf16 v[52:55], v[192:195], v[164:167], v[52:55]
    ds_read_b64_tr_b16 v[198:199], v247 offset:61440
    ds_read_b64_tr_b16 v[192:193], v247 offset:49152
    v_permlane32_swap_b32 v226, v224
    v_permlane32_swap_b32 v227, v225
    v_max_f32 v224, v224, v226
    v_max_f32 v225, v225, v227
    v_mov_b32 v226, v224
    v_mov_b32 v227, v225
    s_waitcnt lgkmcnt(11)
    v_mfma_f32_16x16x32_bf16 v[56:59], v[200:203], v[160:163], v[56:59]
    ds_read_b64_tr_b16 v[194:195], v247 offset:53248
    v_permlane16_swap_b32 v226, v224
    v_mfma_f32_16x16x32_bf16 v[56:59], v[204:207], v[168:171], v[56:59]
    v_permlane16_swap_b32 v227, v225
    v_max_f32 v224, v224, v226
    v_max_f32 v225, v225, v227
    v_sub_f32 v104, v104, v224
    v_sub_f32 v108, v108, v225
    v_sub_f32 v105, v105, v224
    v_sub_f32 v109, v109, v225
    v_sub_f32 v106, v106, v224
    v_sub_f32 v110, v110, v225
    v_mfma_f32_16x16x32_bf16 v[60:63], v[204:207], v[172:175], v[60:63]
    ds_read_b64_tr_b16 v[204:205], v248 offset:57344
    v_sub_f32 v107, v107, v224
    v_mfma_f32_16x16x32_bf16 v[60:63], v[200:203], v[164:167], v[60:63]
    ds_read_b64_tr_b16 v[206:207], v248 offset:61440
    ds_read_b64_tr_b16 v[200:201], v248 offset:49152
    v_sub_f32 v111, v111, v225
    v_sub_f32 v112, v112, v224
    v_sub_f32 v116, v116, v225
    v_sub_f32 v113, v113, v224
    v_sub_f32 v117, v117, v225
    v_sub_f32 v114, v114, v224
    s_waitcnt lgkmcnt(11)
    v_mfma_f32_16x16x32_bf16 v[64:67], v[208:211], v[160:163], v[64:67]
    ds_read_b64_tr_b16 v[202:203], v248 offset:53248
    v_sub_f32 v118, v118, v225
    v_mfma_f32_16x16x32_bf16 v[64:67], v[212:215], v[168:171], v[64:67]
    v_sub_f32 v115, v115, v224
    v_sub_f32 v119, v119, v225
    v_exp_f32 v216, v104
    v_exp_f32 v217, v105
    v_exp_f32 v218, v106
    v_add_f32 v236, v216, v217
    v_mfma_f32_16x16x32_bf16 v[68:71], v[212:215], v[172:175], v[68:71]
    ds_read_b64_tr_b16 v[212:213], v249 offset:57344
    v_cvt_pk_bf16_f32 v152, v216, v217
    v_mfma_f32_16x16x32_bf16 v[68:71], v[208:211], v[164:167], v[68:71]
    ds_read_b64_tr_b16 v[214:215], v249 offset:61440
    ds_read_b64_tr_b16 v[208:209], v249 offset:49152
    v_exp_f32 v219, v107
    v_add_f32 v236, v236, v218
    v_add_f32 v236, v236, v219
    v_cvt_pk_bf16_f32 v153, v218, v219
    s_waitcnt lgkmcnt(11)
    v_mfma_f32_16x16x32_bf16 v[72:75], v[184:187], v[160:163], v[72:75]
    ds_read_b64_tr_b16 v[210:211], v249 offset:53248
    v_mfma_f32_16x16x32_bf16 v[72:75], v[188:191], v[168:171], v[72:75]
    v_exp_f32 v220, v112
    v_exp_f32 v221, v113
    v_exp_f32 v222, v114
    v_exp_f32 v223, v115
    v_add_f32 v236, v236, v220
    v_mfma_f32_16x16x32_bf16 v[76:79], v[188:191], v[172:175], v[76:79]
    v_add_f32 v236, v236, v221
    v_cvt_pk_bf16_f32 v154, v220, v221
    v_mfma_f32_16x16x32_bf16 v[76:79], v[184:187], v[164:167], v[76:79]
    v_add_f32 v236, v236, v222
    v_add_f32 v236, v236, v223
    v_cvt_pk_bf16_f32 v155, v222, v223
    v_exp_f32 v216, v108
    v_exp_f32 v217, v109
    s_waitcnt lgkmcnt(8)
    v_mfma_f32_16x16x32_bf16 v[80:83], v[192:195], v[160:163], v[80:83]
    v_exp_f32 v218, v110
    v_mfma_f32_16x16x32_bf16 v[80:83], v[196:199], v[168:171], v[80:83]
    v_exp_f32 v219, v111
    v_add_f32 v237, v216, v217
    v_cvt_pk_bf16_f32 v156, v216, v217
    v_add_f32 v237, v237, v218
    v_add_f32 v237, v237, v219
    v_cvt_pk_bf16_f32 v157, v218, v219
    v_exp_f32 v220, v116
    v_mfma_f32_16x16x32_bf16 v[84:87], v[196:199], v[172:175], v[84:87]
    v_exp_f32 v221, v117
    v_mfma_f32_16x16x32_bf16 v[84:87], v[192:195], v[164:167], v[84:87]
    v_exp_f32 v222, v118
    v_exp_f32 v223, v119
    v_add_f32 v237, v237, v220
    v_add_f32 v237, v237, v221
    s_waitcnt lgkmcnt(0)
    s_barrier
    v_mfma_f32_16x16x32_bf16 v[88:91], v[200:203], v[160:163], v[88:91]
    ds_read_b128 v[184:187], v238 offset:16384
    v_cvt_pk_bf16_f32 v158, v220, v221
    v_mfma_f32_16x16x32_bf16 v[88:91], v[204:207], v[168:171], v[88:91]
    ds_read_b128 v[188:191], v239 offset:16384
    ds_read_b128 v[192:195], v240 offset:16384
    v_add_f32 v237, v237, v222
    v_add_f32 v237, v237, v223
    v_cvt_pk_bf16_f32 v159, v222, v223
    v_sub_f32 v176, 0, v224
    v_sub_f32 v177, 0, v224
    v_sub_f32 v178, 0, v224
    v_sub_f32 v179, 0, v224
    v_mfma_f32_16x16x32_bf16 v[92:95], v[204:207], v[172:175], v[92:95]
    ds_read_b128 v[196:199], v241 offset:16384
    v_sub_f32 v120, v120, v224
    v_mfma_f32_16x16x32_bf16 v[92:95], v[200:203], v[164:167], v[92:95]
    ds_read_b128 v[200:203], v238 offset:20480
    ds_read_b128 v[204:207], v239 offset:20480
    v_sub_f32 v121, v121, v224
    v_sub_f32 v122, v122, v224
    v_sub_f32 v123, v123, v224
    v_sub_f32 v128, v128, v224
    v_sub_f32 v129, v129, v224
    v_sub_f32 v130, v130, v224
    v_mfma_f32_16x16x32_bf16 v[96:99], v[208:211], v[160:163], v[96:99]
    v_sub_f32 v131, v131, v224
    v_sub_f32 v180, 0, v225
    v_mfma_f32_16x16x32_bf16 v[96:99], v[212:215], v[168:171], v[96:99]
    v_sub_f32 v181, 0, v225
    v_sub_f32 v182, 0, v225
    v_sub_f32 v183, 0, v225
    v_sub_f32 v124, v124, v225
    v_sub_f32 v125, v125, v225
    v_sub_f32 v126, v126, v225
    v_sub_f32 v127, v127, v225
    v_sub_f32 v132, v132, v225
    v_sub_f32 v133, v133, v225
    v_mfma_f32_16x16x32_bf16 v[100:103], v[212:215], v[172:175], v[100:103]
    v_sub_f32 v134, v134, v225
    v_sub_f32 v135, v135, v225
    v_mfma_f32_16x16x32_bf16 v[100:103], v[208:211], v[164:167], v[100:103]
    ds_read_b128 v[208:211], v240 offset:20480
    ds_read_b128 v[212:215], v241 offset:20480
    v_mov_b32 v232, v236
    v_mov_b32 v233, v237
    s_waitcnt lgkmcnt(4)
    v_mfma_f32_16x16x32_bf16 v[104:107], v[184:187], v[8:11], v[176:179]
    v_exp_f32 v216, v120
    v_mfma_f32_16x16x32_bf16 v[104:107], v[188:191], v[16:19], v[104:107]
    v_exp_f32 v217, v121
    v_exp_f32 v218, v122
    v_exp_f32 v219, v123
    v_add_f32 v236, v216, v217
    v_cvt_pk_bf16_f32 v168, v216, v217
    v_add_f32 v236, v236, v218
    v_add_f32 v236, v236, v219
    v_cvt_pk_bf16_f32 v169, v218, v219
    v_mov_b32 v228, v234
    v_mfma_f32_16x16x32_bf16 v[104:107], v[192:195], v[24:27], v[104:107]
    v_exp_f32 v220, v128
    v_mfma_f32_16x16x32_bf16 v[104:107], v[196:199], v[32:35], v[104:107]
    v_exp_f32 v221, v129
    v_exp_f32 v222, v130
    v_exp_f32 v223, v131
    v_mov_b32 v229, v235
    v_add_f32 v236, v236, v220
    v_permlane32_swap_b32 v228, v234
    v_add_f32 v236, v236, v221
    v_permlane32_swap_b32 v229, v235
    v_cvt_pk_bf16_f32 v170, v220, v221
    v_mfma_f32_16x16x32_bf16 v[108:111], v[184:187], v[12:15], v[180:183]
    ds_read_b128 v[184:187], v238 offset:24576
    v_add_f32 v234, v234, v228
    v_mfma_f32_16x16x32_bf16 v[108:111], v[188:191], v[20:23], v[108:111]
    ds_read_b128 v[188:191], v239 offset:24576
    v_add_f32 v236, v236, v222
    v_add_f32 v235, v235, v229
    v_add_f32 v236, v236, v223
    v_mov_b32 v228, v234
    v_cvt_pk_bf16_f32 v171, v222, v223
    v_mov_b32 v229, v235
    v_exp_f32 v216, v124
    v_permlane16_swap_b32 v228, v234
    v_exp_f32 v217, v125
    v_mfma_f32_16x16x32_bf16 v[108:111], v[192:195], v[28:31], v[108:111]
    ds_read_b128 v[192:195], v240 offset:24576
    v_permlane16_swap_b32 v229, v235
    v_mfma_f32_16x16x32_bf16 v[108:111], v[196:199], v[36:39], v[108:111]
    ds_read_b128 v[196:199], v241 offset:24576
    v_exp_f32 v218, v126
    v_add_f32 v234, v234, v228
    v_exp_f32 v219, v127
    v_add_f32 v235, v235, v229
    v_add_f32 v237, v216, v217
    v_rcp_f32 v234, v234
    v_cvt_pk_bf16_f32 v172, v216, v217
    s_waitcnt lgkmcnt(4)
    v_mfma_f32_16x16x32_bf16 v[112:115], v[200:203], v[8:11], v[176:179]
    v_rcp_f32 v235, v235
    v_mfma_f32_16x16x32_bf16 v[112:115], v[204:207], v[16:19], v[112:115]
    v_add_f32 v237, v237, v218
    v_mul_f32 v40, v40, v234
    v_add_f32 v237, v237, v219
    v_mul_f32 v41, v41, v234
    v_cvt_pk_bf16_f32 v173, v218, v219
    v_mul_f32 v42, v42, v234
    v_exp_f32 v220, v132
    v_mul_f32 v43, v43, v234
    v_exp_f32 v221, v133
    v_cvt_pk_bf16_f32 v224, v40, v41
    v_mfma_f32_16x16x32_bf16 v[112:115], v[208:211], v[24:27], v[112:115]
    v_exp_f32 v222, v134
    v_mfma_f32_16x16x32_bf16 v[112:115], v[212:215], v[32:35], v[112:115]
    v_cvt_pk_bf16_f32 v225, v42, v43
    v_exp_f32 v223, v135
    v_mul_f32 v48, v48, v234
    v_add_f32 v237, v237, v220
    v_mul_f32 v49, v49, v234
    v_add_f32 v237, v237, v221
    v_mul_f32 v50, v50, v234
    v_cvt_pk_bf16_f32 v174, v220, v221
    v_mul_f32 v51, v51, v234
    v_add_f32 v237, v237, v222
    v_cvt_pk_bf16_f32 v226, v48, v49
    v_mfma_f32_16x16x32_bf16 v[116:119], v[200:203], v[12:15], v[180:183]
    ds_read_b128 v[200:203], v238 offset:28672
    v_add_f32 v237, v237, v223
    v_mfma_f32_16x16x32_bf16 v[116:119], v[204:207], v[20:23], v[116:119]
    ds_read_b128 v[204:207], v239 offset:28672
    v_cvt_pk_bf16_f32 v227, v50, v51
    v_cvt_pk_bf16_f32 v175, v222, v223
    ds_write_b128 v251, v[224:227] offset:0
    v_mul_f32 v44, v44, v235
    v_mul_f32 v45, v45, v235
    v_mul_f32 v46, v46, v235
    v_mul_f32 v47, v47, v235
    v_cvt_pk_bf16_f32 v228, v44, v45
    v_cvt_pk_bf16_f32 v229, v46, v47
    v_mul_f32 v52, v52, v235
    v_mul_f32 v53, v53, v235
    v_mfma_f32_16x16x32_bf16 v[116:119], v[208:211], v[28:31], v[116:119]
    ds_read_b128 v[208:211], v240 offset:28672
    v_mul_f32 v54, v54, v235
    v_mfma_f32_16x16x32_bf16 v[116:119], v[212:215], v[36:39], v[116:119]
    ds_read_b128 v[212:215], v241 offset:28672
    v_mul_f32 v55, v55, v235
    v_cvt_pk_bf16_f32 v230, v52, v53
    v_cvt_pk_bf16_f32 v231, v54, v55
    ds_write_b128 v251, v[228:231] offset:1024
    v_mul_f32 v56, v56, v234
    v_mul_f32 v57, v57, v234
    v_mul_f32 v58, v58, v234
    v_mul_f32 v59, v59, v234
    v_cvt_pk_bf16_f32 v224, v56, v57
    v_cvt_pk_bf16_f32 v225, v58, v59
    s_waitcnt lgkmcnt(6)
    v_mfma_f32_16x16x32_bf16 v[136:139], v[184:187], v[8:11], v[176:179]
    v_mul_f32 v64, v64, v234
    v_mul_f32 v65, v65, v234
    v_mfma_f32_16x16x32_bf16 v[136:139], v[188:191], v[16:19], v[136:139]
    v_mul_f32 v66, v66, v234
    v_mul_f32 v67, v67, v234
    v_cvt_pk_bf16_f32 v226, v64, v65
    v_cvt_pk_bf16_f32 v227, v66, v67
    ds_write_b128 v251, v[224:227] offset:2048
    v_mul_f32 v60, v60, v235
    v_mul_f32 v61, v61, v235
    v_mul_f32 v62, v62, v235
    v_mul_f32 v63, v63, v235
    v_cvt_pk_bf16_f32 v228, v60, v61
    v_cvt_pk_bf16_f32 v229, v62, v63
    v_mul_f32 v68, v68, v235
    v_mfma_f32_16x16x32_bf16 v[136:139], v[192:195], v[24:27], v[136:139]
    v_mul_f32 v69, v69, v235
    v_mul_f32 v70, v70, v235
    v_mfma_f32_16x16x32_bf16 v[136:139], v[196:199], v[32:35], v[136:139]
    v_mul_f32 v71, v71, v235
    v_cvt_pk_bf16_f32 v230, v68, v69
    v_cvt_pk_bf16_f32 v231, v70, v71
    ds_write_b128 v251, v[228:231] offset:3072
    v_mul_f32 v72, v72, v234
    v_mul_f32 v73, v73, v234
    v_mul_f32 v74, v74, v234
    v_mul_f32 v75, v75, v234
    v_cvt_pk_bf16_f32 v224, v72, v73
    v_cvt_pk_bf16_f32 v225, v74, v75
    s_waitcnt lgkmcnt(0)
    s_barrier
    v_mfma_f32_16x16x32_bf16 v[140:143], v[184:187], v[12:15], v[180:183]
    ds_read_b64_tr_b16 v[184:185], v242 offset:32768
    v_mul_f32 v80, v80, v234
    v_mfma_f32_16x16x32_bf16 v[140:143], v[188:191], v[20:23], v[140:143]
    ds_read_b64_tr_b16 v[186:187], v242 offset:36864
    ds_read_b64_tr_b16 v[188:189], v242 offset:40960
    v_mul_f32 v81, v81, v234
    v_mul_f32 v82, v82, v234
    v_mul_f32 v83, v83, v234
    v_cvt_pk_bf16_f32 v226, v80, v81
    v_cvt_pk_bf16_f32 v227, v82, v83
    ds_write_b128 v251, v[224:227] offset:4096
    v_mul_f32 v76, v76, v235
    v_mul_f32 v77, v77, v235
    v_mul_f32 v78, v78, v235
    v_mul_f32 v79, v79, v235
    v_mfma_f32_16x16x32_bf16 v[140:143], v[192:195], v[28:31], v[140:143]
    ds_read_b64_tr_b16 v[190:191], v242 offset:45056
    v_cvt_pk_bf16_f32 v228, v76, v77
    v_mfma_f32_16x16x32_bf16 v[140:143], v[196:199], v[36:39], v[140:143]
    ds_read_b64_tr_b16 v[192:193], v243 offset:32768
    ds_read_b64_tr_b16 v[194:195], v243 offset:36864
    v_cvt_pk_bf16_f32 v229, v78, v79
    v_mul_f32 v84, v84, v235
    v_mul_f32 v85, v85, v235
    v_mul_f32 v86, v86, v235
    v_mul_f32 v87, v87, v235
    v_cvt_pk_bf16_f32 v230, v84, v85
    v_cvt_pk_bf16_f32 v231, v86, v87
    ds_write_b128 v251, v[228:231] offset:5120
    v_mul_f32 v88, v88, v234
    v_mfma_f32_16x16x32_bf16 v[144:147], v[200:203], v[8:11], v[176:179]
    ds_read_b64_tr_b16 v[196:197], v243 offset:40960
    v_mul_f32 v89, v89, v234
    v_mfma_f32_16x16x32_bf16 v[144:147], v[204:207], v[16:19], v[144:147]
    ds_read_b64_tr_b16 v[198:199], v243 offset:45056
    v_mul_f32 v90, v90, v234
    v_mul_f32 v91, v91, v234
    v_cvt_pk_bf16_f32 v224, v88, v89
    v_cvt_pk_bf16_f32 v225, v90, v91
    v_mul_f32 v96, v96, v234
    v_mul_f32 v97, v97, v234
    v_mul_f32 v98, v98, v234
    v_mul_f32 v99, v99, v234
    v_cvt_pk_bf16_f32 v226, v96, v97
    v_cvt_pk_bf16_f32 v227, v98, v99
    ds_write_b128 v251, v[224:227] offset:6144
    v_mfma_f32_16x16x32_bf16 v[144:147], v[208:211], v[24:27], v[144:147]
    v_mul_f32 v92, v92, v235
    v_mul_f32 v93, v93, v235
    v_mfma_f32_16x16x32_bf16 v[144:147], v[212:215], v[32:35], v[144:147]
    v_mul_f32 v94, v94, v235
    v_mul_f32 v95, v95, v235
    v_cvt_pk_bf16_f32 v228, v92, v93
    v_cvt_pk_bf16_f32 v229, v94, v95
    v_mul_f32 v100, v100, v235
    v_mul_f32 v101, v101, v235
    v_mul_f32 v102, v102, v235
    v_mul_f32 v103, v103, v235
    v_cvt_pk_bf16_f32 v230, v100, v101
    v_cvt_pk_bf16_f32 v231, v102, v103
    ds_write_b128 v251, v[228:231] offset:7168
    v_mfma_f32_16x16x32_bf16 v[148:151], v[200:203], v[12:15], v[180:183]
    ds_read_b64_tr_b16 v[200:201], v244 offset:32768
    v_mfma_f32_16x16x32_bf16 v[148:151], v[204:207], v[20:23], v[148:151]
    ds_read_b64_tr_b16 v[202:203], v244 offset:36864
    ds_read_b64_tr_b16 v[204:205], v244 offset:40960
    v_mfma_f32_16x16x32_bf16 v[148:151], v[208:211], v[28:31], v[148:151]
    ds_read_b64_tr_b16 v[206:207], v244 offset:45056
    v_mfma_f32_16x16x32_bf16 v[148:151], v[212:215], v[36:39], v[148:151]
    ds_read_b64_tr_b16 v[208:209], v245 offset:32768
    ds_read_b64_tr_b16 v[210:211], v245 offset:36864
    v_add_f32 v232, v232, v236
    v_add_f32 v233, v233, v237
    s_waitcnt lgkmcnt(13)
    v_mfma_f32_16x16x32_bf16 v[40:43], v[184:187], v[152:155], 0
    ds_read_b64_tr_b16 v[212:213], v245 offset:40960
    v_mfma_f32_16x16x32_bf16 v[40:43], v[188:191], v[168:171], v[40:43]
    ds_read_b64_tr_b16 v[214:215], v245 offset:45056
    v_exp_f32 v216, v104
    v_exp_f32 v217, v105
    v_mfma_f32_16x16x32_bf16 v[44:47], v[188:191], v[172:175], 0
    ds_read_b64_tr_b16 v[188:189], v246 offset:40960
    v_add_f32 v236, v216, v217
    v_mfma_f32_16x16x32_bf16 v[44:47], v[184:187], v[156:159], v[44:47]
    ds_read_b64_tr_b16 v[190:191], v246 offset:45056
    ds_read_b64_tr_b16 v[184:185], v246 offset:32768
    v_exp_f32 v218, v106
    s_waitcnt lgkmcnt(13)
    v_mfma_f32_16x16x32_bf16 v[48:51], v[192:195], v[152:155], 0
    ds_read_b64_tr_b16 v[186:187], v246 offset:36864
    v_cvt_pk_bf16_f32 v160, v216, v217
    v_mfma_f32_16x16x32_bf16 v[48:51], v[196:199], v[168:171], v[48:51]
    v_exp_f32 v219, v107
    v_add_f32 v236, v236, v218
    v_add_f32 v236, v236, v219
    v_cvt_pk_bf16_f32 v161, v218, v219
    v_mfma_f32_16x16x32_bf16 v[52:55], v[196:199], v[172:175], 0
    ds_read_b64_tr_b16 v[196:197], v247 offset:40960
    v_mfma_f32_16x16x32_bf16 v[52:55], v[192:195], v[156:159], v[52:55]
    ds_read_b64_tr_b16 v[198:199], v247 offset:45056
    ds_read_b64_tr_b16 v[192:193], v247 offset:32768
    v_exp_f32 v220, v112
    s_waitcnt lgkmcnt(11)
    v_mfma_f32_16x16x32_bf16 v[56:59], v[200:203], v[152:155], 0
    ds_read_b64_tr_b16 v[194:195], v247 offset:36864
    v_add_f32 v236, v236, v220
    v_mfma_f32_16x16x32_bf16 v[56:59], v[204:207], v[168:171], v[56:59]
    v_exp_f32 v221, v113
    v_exp_f32 v222, v114
    v_add_f32 v236, v236, v221
    v_mfma_f32_16x16x32_bf16 v[60:63], v[204:207], v[172:175], 0
    ds_read_b64_tr_b16 v[204:205], v248 offset:40960
    v_cvt_pk_bf16_f32 v162, v220, v221
    v_mfma_f32_16x16x32_bf16 v[60:63], v[200:203], v[156:159], v[60:63]
    ds_read_b64_tr_b16 v[206:207], v248 offset:45056
    ds_read_b64_tr_b16 v[200:201], v248 offset:32768
    v_exp_f32 v223, v115
    s_waitcnt lgkmcnt(11)
    v_mfma_f32_16x16x32_bf16 v[64:67], v[208:211], v[152:155], 0
    ds_read_b64_tr_b16 v[202:203], v248 offset:36864
    v_add_f32 v236, v236, v222
    v_mfma_f32_16x16x32_bf16 v[64:67], v[212:215], v[168:171], v[64:67]
    v_add_f32 v236, v236, v223
    v_cvt_pk_bf16_f32 v163, v222, v223
    v_exp_f32 v216, v108
    v_mfma_f32_16x16x32_bf16 v[68:71], v[212:215], v[172:175], 0
    ds_read_b64_tr_b16 v[212:213], v249 offset:40960
    v_mfma_f32_16x16x32_bf16 v[68:71], v[208:211], v[156:159], v[68:71]
    ds_read_b64_tr_b16 v[214:215], v249 offset:45056
    ds_read_b64_tr_b16 v[208:209], v249 offset:32768
    v_exp_f32 v217, v109
    s_waitcnt lgkmcnt(11)
    v_mfma_f32_16x16x32_bf16 v[72:75], v[184:187], v[152:155], 0
    ds_read_b64_tr_b16 v[210:211], v249 offset:36864
    v_add_f32 v237, v216, v217
    v_mfma_f32_16x16x32_bf16 v[72:75], v[188:191], v[168:171], v[72:75]
    v_exp_f32 v218, v110
    v_exp_f32 v219, v111
    v_cvt_pk_bf16_f32 v164, v216, v217
    v_mfma_f32_16x16x32_bf16 v[76:79], v[188:191], v[172:175], 0
    v_add_f32 v237, v237, v218
    v_add_f32 v237, v237, v219
    v_mfma_f32_16x16x32_bf16 v[76:79], v[184:187], v[156:159], v[76:79]
    v_cvt_pk_bf16_f32 v165, v218, v219
    v_exp_f32 v220, v116
    s_waitcnt lgkmcnt(8)
    v_mfma_f32_16x16x32_bf16 v[80:83], v[192:195], v[152:155], 0
    v_exp_f32 v221, v117
    v_mfma_f32_16x16x32_bf16 v[80:83], v[196:199], v[168:171], v[80:83]
    v_exp_f32 v222, v118
    v_exp_f32 v223, v119
    v_add_f32 v237, v237, v220
    v_mfma_f32_16x16x32_bf16 v[84:87], v[196:199], v[172:175], 0
    v_add_f32 v237, v237, v221
    v_cvt_pk_bf16_f32 v166, v220, v221
    v_mfma_f32_16x16x32_bf16 v[84:87], v[192:195], v[156:159], v[84:87]
    v_add_f32 v237, v237, v222
    v_add_f32 v237, v237, v223
    s_waitcnt lgkmcnt(0)
    s_barrier
    s_add_u32 s38, s38, 1
    s_branch L_Aloop
L_Atail:
    v_add_u32 v251, -32768, v251
    v_mfma_f32_16x16x32_bf16 v[88:91], v[200:203], v[152:155], v[88:91]
    v_exp_f32 v223, v119
    v_mfma_f32_16x16x32_bf16 v[88:91], v[204:207], v[168:171], v[88:91]
    v_add_f32 v237, v237, v220
    v_add_f32 v237, v237, v221
    v_cvt_pk_bf16_f32 v166, v220, v221
    v_add_f32 v237, v237, v222
    v_add_f32 v237, v237, v223
    v_mfma_f32_16x16x32_bf16 v[92:95], v[204:207], v[172:175], v[92:95]
    v_cvt_pk_bf16_f32 v167, v222, v223
    v_max_f32 v224, v236, v237
    v_mfma_f32_16x16x32_bf16 v[92:95], v[200:203], v[156:159], v[92:95]
    v_cmp_lt_f32 vcc, s39, v224
    v_mfma_f32_16x16x32_bf16 v[96:99], v[208:211], v[152:155], v[96:99]
    v_mfma_f32_16x16x32_bf16 v[96:99], v[212:215], v[168:171], v[96:99]
    v_mfma_f32_16x16x32_bf16 v[100:103], v[212:215], v[172:175], v[100:103]
    v_mfma_f32_16x16x32_bf16 v[100:103], v[208:211], v[156:159], v[100:103]
    s_cbranch_vccnz L_fb_T7_0
L_ret_T7_0:
    v_add_f32 v232, v232, v236
    v_add_f32 v233, v233, v237
    v_exp_f32 v216, v136
    v_exp_f32 v217, v137
    v_exp_f32 v218, v138
    v_exp_f32 v219, v139
    v_add_f32 v236, v216, v217
    v_cvt_pk_bf16_f32 v168, v216, v217
    v_add_f32 v236, v236, v218
    v_add_f32 v236, v236, v219
    v_cvt_pk_bf16_f32 v169, v218, v219
    v_exp_f32 v220, v144
    v_exp_f32 v221, v145
    v_exp_f32 v222, v146
    v_exp_f32 v223, v147
    v_add_f32 v236, v236, v220
    v_add_f32 v236, v236, v221
    v_cvt_pk_bf16_f32 v170, v220, v221
    v_add_f32 v236, v236, v222
    v_add_f32 v236, v236, v223
    v_cvt_pk_bf16_f32 v171, v222, v223
    v_exp_f32 v216, v140
    v_exp_f32 v217, v141
    v_exp_f32 v218, v142
    v_exp_f32 v219, v143
    v_add_f32 v237, v216, v217
    v_cvt_pk_bf16_f32 v172, v216, v217
    v_add_f32 v237, v237, v218
    v_add_f32 v237, v237, v219
    v_cvt_pk_bf16_f32 v173, v218, v219
    v_exp_f32 v220, v148
    v_exp_f32 v221, v149
    v_exp_f32 v222, v150
    v_exp_f32 v223, v151
    v_add_f32 v237, v237, v220
    v_add_f32 v237, v237, v221
    v_cvt_pk_bf16_f32 v174, v220, v221
    v_add_f32 v237, v237, v222
    v_add_f32 v237, v237, v223
    v_cvt_pk_bf16_f32 v175, v222, v223
    v_max_f32 v224, v236, v237
    v_cmp_lt_f32 vcc, s39, v224
    s_waitcnt lgkmcnt(0)
    s_barrier
    ds_read_b64_tr_b16 v[184:185], v242 offset:49152
    ds_read_b64_tr_b16 v[186:187], v242 offset:53248
    ds_read_b64_tr_b16 v[188:189], v242 offset:57344
    ds_read_b64_tr_b16 v[190:191], v242 offset:61440
    ds_read_b64_tr_b16 v[192:193], v243 offset:49152
    ds_read_b64_tr_b16 v[194:195], v243 offset:53248
    ds_read_b64_tr_b16 v[196:197], v243 offset:57344
    ds_read_b64_tr_b16 v[198:199], v243 offset:61440
    ds_read_b64_tr_b16 v[200:201], v244 offset:49152
    ds_read_b64_tr_b16 v[202:203], v244 offset:53248
    ds_read_b64_tr_b16 v[204:205], v244 offset:57344
    ds_read_b64_tr_b16 v[206:207], v244 offset:61440
    ds_read_b64_tr_b16 v[208:209], v245 offset:49152
    ds_read_b64_tr_b16 v[210:211], v245 offset:53248
    ds_read_b64_tr_b16 v[212:213], v245 offset:57344
    ds_read_b64_tr_b16 v[214:215], v245 offset:61440
    s_cbranch_vccnz L_fb_T7_1
L_ret_T7_1:
    v_add_f32 v234, v232, v236
    v_add_f32 v235, v233, v237
    s_waitcnt lgkmcnt(12)
    v_mfma_f32_16x16x32_bf16 v[40:43], v[184:187], v[160:163], v[40:43]
    v_mov_b32 v228, v234
    v_mov_b32 v229, v235
    v_mfma_f32_16x16x32_bf16 v[40:43], v[188:191], v[168:171], v[40:43]
    v_permlane32_swap_b32 v228, v234
    v_permlane32_swap_b32 v229, v235
    v_add_f32 v234, v234, v228
    v_add_f32 v235, v235, v229
    v_mov_b32 v228, v234
    v_mfma_f32_16x16x32_bf16 v[44:47], v[188:191], v[172:175], v[44:47]
    ds_read_b64_tr_b16 v[188:189], v246 offset:57344
    v_mov_b32 v229, v235
    v_mfma_f32_16x16x32_bf16 v[44:47], v[184:187], v[164:167], v[44:47]
    ds_read_b64_tr_b16 v[190:191], v246 offset:61440
    ds_read_b64_tr_b16 v[184:185], v246 offset:49152
    v_permlane16_swap_b32 v228, v234
    v_permlane16_swap_b32 v229, v235
    s_waitcnt lgkmcnt(11)
    v_mfma_f32_16x16x32_bf16 v[48:51], v[192:195], v[160:163], v[48:51]
    ds_read_b64_tr_b16 v[186:187], v246 offset:53248
    v_add_f32 v234, v234, v228
    v_mfma_f32_16x16x32_bf16 v[48:51], v[196:199], v[168:171], v[48:51]
    v_add_f32 v235, v235, v229
    v_rcp_f32 v234, v234
    v_rcp_f32 v235, v235
    v_mfma_f32_16x16x32_bf16 v[52:55], v[196:199], v[172:175], v[52:55]
    ds_read_b64_tr_b16 v[196:197], v247 offset:57344
    v_mfma_f32_16x16x32_bf16 v[52:55], v[192:195], v[164:167], v[52:55]
    ds_read_b64_tr_b16 v[198:199], v247 offset:61440
    ds_read_b64_tr_b16 v[192:193], v247 offset:49152
    s_waitcnt lgkmcnt(11)
    v_mfma_f32_16x16x32_bf16 v[56:59], v[200:203], v[160:163], v[56:59]
    ds_read_b64_tr_b16 v[194:195], v247 offset:53248
    v_mfma_f32_16x16x32_bf16 v[56:59], v[204:207], v[168:171], v[56:59]
    v_mfma_f32_16x16x32_bf16 v[60:63], v[204:207], v[172:175], v[60:63]
    ds_read_b64_tr_b16 v[204:205], v248 offset:57344
    v_mul_f32 v40, v40, v234
    v_mfma_f32_16x16x32_bf16 v[60:63], v[200:203], v[164:167], v[60:63]
    ds_read_b64_tr_b16 v[206:207], v248 offset:61440
    ds_read_b64_tr_b16 v[200:201], v248 offset:49152
    v_mul_f32 v41, v41, v234
    v_mul_f32 v42, v42, v234
    v_mul_f32 v43, v43, v234
    v_cvt_pk_bf16_f32 v104, v40, v41
    s_waitcnt lgkmcnt(11)
    v_mfma_f32_16x16x32_bf16 v[64:67], v[208:211], v[160:163], v[64:67]
    ds_read_b64_tr_b16 v[202:203], v248 offset:53248
    v_cvt_pk_bf16_f32 v105, v42, v43
    v_mfma_f32_16x16x32_bf16 v[64:67], v[212:215], v[168:171], v[64:67]
    v_mul_f32 v48, v48, v234
    v_mul_f32 v49, v49, v234
    v_mul_f32 v50, v50, v234
    v_mul_f32 v51, v51, v234
    v_cvt_pk_bf16_f32 v106, v48, v49
    v_cvt_pk_bf16_f32 v107, v50, v51
    v_mul_f32 v44, v44, v235
    v_mfma_f32_16x16x32_bf16 v[68:71], v[212:215], v[172:175], v[68:71]
    ds_read_b64_tr_b16 v[212:213], v249 offset:57344
    v_mul_f32 v45, v45, v235
    v_mfma_f32_16x16x32_bf16 v[68:71], v[208:211], v[164:167], v[68:71]
    ds_read_b64_tr_b16 v[214:215], v249 offset:61440
    ds_read_b64_tr_b16 v[208:209], v249 offset:49152
    v_mul_f32 v46, v46, v235
    v_mul_f32 v47, v47, v235
    v_cvt_pk_bf16_f32 v108, v44, v45
    v_cvt_pk_bf16_f32 v109, v46, v47
    s_waitcnt lgkmcnt(11)
    v_mfma_f32_16x16x32_bf16 v[72:75], v[184:187], v[160:163], v[72:75]
    ds_read_b64_tr_b16 v[210:211], v249 offset:53248
    v_mul_f32 v52, v52, v235
    v_mfma_f32_16x16x32_bf16 v[72:75], v[188:191], v[168:171], v[72:75]
    v_mul_f32 v53, v53, v235
    v_mul_f32 v54, v54, v235
    v_mul_f32 v55, v55, v235
    v_cvt_pk_bf16_f32 v110, v52, v53
    v_cvt_pk_bf16_f32 v111, v54, v55
    v_mfma_f32_16x16x32_bf16 v[76:79], v[188:191], v[172:175], v[76:79]
    v_mul_f32 v56, v56, v234
    v_mul_f32 v57, v57, v234
    v_mfma_f32_16x16x32_bf16 v[76:79], v[184:187], v[164:167], v[76:79]
    v_mul_f32 v58, v58, v234
    v_mul_f32 v59, v59, v234
    v_cvt_pk_bf16_f32 v112, v56, v57
    v_cvt_pk_bf16_f32 v113, v58, v59
    v_mul_f32 v64, v64, v234
    s_waitcnt lgkmcnt(8)
    v_mfma_f32_16x16x32_bf16 v[80:83], v[192:195], v[160:163], v[80:83]
    v_mul_f32 v65, v65, v234
    v_mul_f32 v66, v66, v234
    v_mfma_f32_16x16x32_bf16 v[80:83], v[196:199], v[168:171], v[80:83]
    v_mul_f32 v67, v67, v234
    v_cvt_pk_bf16_f32 v114, v64, v65
    v_cvt_pk_bf16_f32 v115, v66, v67
    v_mul_f32 v60, v60, v235
    v_mul_f32 v61, v61, v235
    v_mul_f32 v62, v62, v235
    v_mfma_f32_16x16x32_bf16 v[84:87], v[196:199], v[172:175], v[84:87]
    v_mul_f32 v63, v63, v235
    v_cvt_pk_bf16_f32 v116, v60, v61
    v_mfma_f32_16x16x32_bf16 v[84:87], v[192:195], v[164:167], v[84:87]
    v_cvt_pk_bf16_f32 v117, v62, v63
    v_mul_f32 v68, v68, v235
    v_mul_f32 v69, v69, v235
    s_waitcnt lgkmcnt(0)
    s_barrier
    v_mfma_f32_16x16x32_bf16 v[88:91], v[200:203], v[160:163], v[88:91]
    v_mul_f32 v70, v70, v235
    v_mul_f32 v71, v71, v235
    v_mfma_f32_16x16x32_bf16 v[88:91], v[204:207], v[168:171], v[88:91]
    v_cvt_pk_bf16_f32 v118, v68, v69
    v_cvt_pk_bf16_f32 v119, v70, v71
    ds_write_b128 v251, v[104:107] offset:0
    v_mfma_f32_16x16x32_bf16 v[92:95], v[204:207], v[172:175], v[92:95]
    v_mul_f32 v72, v72, v234
    ds_write_b128 v251, v[108:111] offset:1024
    v_mfma_f32_16x16x32_bf16 v[92:95], v[200:203], v[164:167], v[92:95]
    v_mul_f32 v73, v73, v234
    v_mul_f32 v74, v74, v234
    v_mul_f32 v75, v75, v234
    v_cvt_pk_bf16_f32 v120, v72, v73
    v_cvt_pk_bf16_f32 v121, v74, v75
    v_mul_f32 v80, v80, v234
    ds_write_b128 v251, v[112:115] offset:2048
    v_mfma_f32_16x16x32_bf16 v[96:99], v[208:211], v[160:163], v[96:99]
    v_mul_f32 v81, v81, v234
    ds_write_b128 v251, v[116:119] offset:3072
    v_mfma_f32_16x16x32_bf16 v[96:99], v[212:215], v[168:171], v[96:99]
    v_mul_f32 v82, v82, v234
    v_mul_f32 v83, v83, v234
    v_cvt_pk_bf16_f32 v122, v80, v81
    v_cvt_pk_bf16_f32 v123, v82, v83
    v_mul_f32 v76, v76, v235
    v_mul_f32 v77, v77, v235
    v_mul_f32 v78, v78, v235
    v_mul_f32 v79, v79, v235
    v_mfma_f32_16x16x32_bf16 v[100:103], v[212:215], v[172:175], v[100:103]
    v_cvt_pk_bf16_f32 v124, v76, v77
    v_cvt_pk_bf16_f32 v125, v78, v79
    v_mfma_f32_16x16x32_bf16 v[100:103], v[208:211], v[164:167], v[100:103]
    v_mul_f32 v84, v84, v235
    v_mul_f32 v85, v85, v235
    v_mul_f32 v86, v86, v235
    v_mul_f32 v87, v87, v235
    v_cvt_pk_bf16_f32 v126, v84, v85
    v_cvt_pk_bf16_f32 v127, v86, v87
    ds_write_b128 v251, v[120:123] offset:4096
    ds_write_b128 v251, v[124:127] offset:5120
    v_mul_f32 v88, v88, v234
    v_mul_f32 v89, v89, v234
    v_mul_f32 v90, v90, v234
    v_mul_f32 v91, v91, v234
    v_cvt_pk_bf16_f32 v128, v88, v89
    v_cvt_pk_bf16_f32 v129, v90, v91
    v_mul_f32 v96, v96, v234
    v_mul_f32 v97, v97, v234
    v_mul_f32 v98, v98, v234
    v_mul_f32 v99, v99, v234
    v_cvt_pk_bf16_f32 v130, v96, v97
    v_cvt_pk_bf16_f32 v131, v98, v99
    ds_write_b128 v251, v[128:131] offset:6144
    v_mul_f32 v92, v92, v235
    v_mul_f32 v93, v93, v235
    v_mul_f32 v94, v94, v235
    v_mul_f32 v95, v95, v235
    v_cvt_pk_bf16_f32 v132, v92, v93
    v_cvt_pk_bf16_f32 v133, v94, v95
    v_mul_f32 v100, v100, v235
    v_mul_f32 v101, v101, v235
    v_mul_f32 v102, v102, v235
    v_mul_f32 v103, v103, v235
    v_cvt_pk_bf16_f32 v134, v100, v101
    v_cvt_pk_bf16_f32 v135, v102, v103
    ds_write_b128 v251, v[132:135] offset:7168
    s_waitcnt lgkmcnt(0)
    s_barrier
    buffer_load_dword v241, v252, s[76:79], 0 offen sc1
    s_barrier
    s_barrier
    s_add_u32 m0, s45, 98304
    s_add_u32 s44, s51, 512
    s_and_b32 s44, s44, 0x7ffff
    buffer_load_dwordx4 v253, s[20:23], s44 offen lds
    s_add_u32 m0, s45, 102400
    s_add_u32 s44, s51, 33280
    s_and_b32 s44, s44, 0x7ffff
    buffer_load_dwordx4 v253, s[20:23], s44 offen lds
    s_add_u32 m0, s45, 106496
    s_add_u32 s44, s51, 66048
    s_and_b32 s44, s44, 0x7ffff
    buffer_load_dwordx4 v253, s[20:23], s44 offen lds
    s_add_u32 m0, s45, 110592
    s_add_u32 s44, s51, 98816
    s_and_b32 s44, s44, 0x7ffff
    buffer_load_dwordx4 v253, s[20:23], s44 offen lds
    s_add_u32 m0, s45, 114688
    s_add_u32 s44, s51, 131584
    s_and_b32 s44, s44, 0x7ffff
    buffer_load_dwordx4 v253, s[20:23], s44 offen lds
    s_add_u32 m0, s45, 118784
    s_add_u32 s44, s51, 164352
    s_and_b32 s44, s44, 0x7ffff
    buffer_load_dwordx4 v253, s[20:23], s44 offen lds
    s_add_u32 m0, s45, 122880
    s_add_u32 s44, s51, 197120
    s_and_b32 s44, s44, 0x7ffff
    buffer_load_dwordx4 v253, s[20:23], s44 offen lds
    s_add_u32 m0, s45, 126976
    s_add_u32 s44, s51, 229888
    s_and_b32 s44, s44, 0x7ffff
    buffer_load_dwordx4 v253, s[20:23], s44 offen lds
    s_barrier
    s_add_u32 m0, s45, 32768
    s_add_u32 s44, s51, 262656
    s_and_b32 s44, s44, 0x7ffff
    buffer_load_dwordx4 v253, s[20:23], s44 offen lds
    s_add_u32 m0, s45, 36864
    s_add_u32 s44, s51, 295424
    s_and_b32 s44, s44, 0x7ffff
    buffer_load_dwordx4 v253, s[20:23], s44 offen lds
    s_add_u32 m0, s45, 40960
    s_add_u32 s44, s51, 328192
    s_and_b32 s44, s44, 0x7ffff
    buffer_load_dwordx4 v253, s[20:23], s44 offen lds
    s_add_u32 m0, s45, 45056
    s_add_u32 s44, s51, 360960
    s_and_b32 s44, s44, 0x7ffff
    buffer_load_dwordx4 v253, s[20:23], s44 offen lds
    s_add_u32 m0, s45, 49152
    s_add_u32 s44, s51, 393728
    s_and_b32 s44, s44, 0x7ffff
    buffer_load_dwordx4 v253, s[20:23], s44 offen lds
    s_add_u32 m0, s45, 53248
    s_add_u32 s44, s51, 426496
    s_and_b32 s44, s44, 0x7ffff
    buffer_load_dwordx4 v253, s[20:23], s44 offen lds
    s_add_u32 m0, s45, 57344
    s_add_u32 s44, s51, 459264
    s_and_b32 s44, s44, 0x7ffff
    buffer_load_dwordx4 v253, s[20:23], s44 offen lds
    s_add_u32 m0, s45, 61440
    s_add_u32 s44, s51, 492032
    s_and_b32 s44, s44, 0x7ffff
    buffer_load_dwordx4 v253, s[20:23], s44 offen lds
    s_barrier
    s_barrier
    s_waitcnt vmcnt(12)
    s_barrier
    s_waitcnt vmcnt(8)
    s_barrier
    s_waitcnt vmcnt(4)
    s_barrier
    s_add_u32 m0, s45, 131072
    s_add_u32 s44, s51, 640
    s_and_b32 s44, s44, 0x7ffff
    buffer_load_dwordx4 v253, s[20:23], s44 offen lds
    s_add_u32 m0, s45, 135168
    s_add_u32 s44, s51, 33408
    s_and_b32 s44, s44, 0x7ffff
    buffer_load_dwordx4 v253, s[20:23], s44 offen lds
    s_add_u32 m0, s45, 139264
    s_add_u32 s44, s51, 66176
    s_and_b32 s44, s44, 0x7ffff
    buffer_load_dwordx4 v253, s[20:23], s44 offen lds
    s_add_u32 m0, s45, 143360
    s_add_u32 s44, s51, 98944
    s_and_b32 s44, s44, 0x7ffff
    buffer_load_dwordx4 v253, s[20:23], s44 offen lds
    s_add_u32 m0, s45, 147456
    s_add_u32 s44, s51, 131712
    s_and_b32 s44, s44, 0x7ffff
    buffer_load_dwordx4 v253, s[20:23], s44 offen lds
    s_add_u32 m0, s45, 151552
    s_add_u32 s44, s51, 164480
    s_and_b32 s44, s44, 0x7ffff
    buffer_load_dwordx4 v253, s[20:23], s44 offen lds
    s_add_u32 m0, s45, 155648
    s_add_u32 s44, s51, 197248
    s_and_b32 s44, s44, 0x7ffff
    buffer_load_dwordx4 v253, s[20:23], s44 offen lds
    s_add_u32 m0, s45, 159744
    s_add_u32 s44, s51, 230016
    s_and_b32 s44, s44, 0x7ffff
    buffer_load_dwordx4 v253, s[20:23], s44 offen lds
    s_waitcnt vmcnt(8)
    s_barrier
    s_add_u32 m0, s45, 0
    s_add_u32 s44, s51, 262784
    s_and_b32 s44, s44, 0x7ffff
    buffer_load_dwordx4 v253, s[20:23], s44 offen lds
    s_add_u32 m0, s45, 4096
    s_add_u32 s44, s51, 295552
    s_and_b32 s44, s44, 0x7ffff
    buffer_load_dwordx4 v253, s[20:23], s44 offen lds
    s_add_u32 m0, s45, 8192
    s_add_u32 s44, s51, 328320
    s_and_b32 s44, s44, 0x7ffff
    buffer_load_dwordx4 v253, s[20:23], s44 offen lds
    s_add_u32 m0, s45, 12288
    s_add_u32 s44, s51, 361088
    s_and_b32 s44, s44, 0x7ffff
    buffer_load_dwordx4 v253, s[20:23], s44 offen lds
    s_add_u32 m0, s45, 16384
    s_add_u32 s44, s51, 393856
    s_and_b32 s44, s44, 0x7ffff
    buffer_load_dwordx4 v253, s[20:23], s44 offen lds
    s_add_u32 m0, s45, 20480
    s_add_u32 s44, s51, 426624
    s_and_b32 s44, s44, 0x7ffff
    buffer_load_dwordx4 v253, s[20:23], s44 offen lds
    s_add_u32 m0, s45, 24576
    s_add_u32 s44, s51, 459392
    s_and_b32 s44, s44, 0x7ffff
    buffer_load_dwordx4 v253, s[20:23], s44 offen lds
    s_add_u32 m0, s45, 28672
    s_add_u32 s44, s51, 492160
    s_and_b32 s44, s44, 0x7ffff
    buffer_load_dwordx4 v253, s[20:23], s44 offen lds
    s_waitcnt vmcnt(12)
    s_barrier
    s_waitcnt vmcnt(8)
    s_barrier
    s_waitcnt vmcnt(4)
    s_barrier
    s_add_u32 m0, s45, 65536
    s_add_u32 s44, s51, 768
    s_and_b32 s44, s44, 0x7ffff
    buffer_load_dwordx4 v253, s[20:23], s44 offen lds
    s_add_u32 m0, s45, 69632
    s_add_u32 s44, s51, 33536
    s_and_b32 s44, s44, 0x7ffff
    buffer_load_dwordx4 v253, s[20:23], s44 offen lds
    s_add_u32 m0, s45, 73728
    s_add_u32 s44, s51, 66304
    s_and_b32 s44, s44, 0x7ffff
    buffer_load_dwordx4 v253, s[20:23], s44 offen lds
    s_add_u32 m0, s45, 77824
    s_add_u32 s44, s51, 99072
    s_and_b32 s44, s44, 0x7ffff
    buffer_load_dwordx4 v253, s[20:23], s44 offen lds
    s_add_u32 m0, s45, 81920
    s_add_u32 s44, s51, 131840
    s_and_b32 s44, s44, 0x7ffff
    buffer_load_dwordx4 v253, s[20:23], s44 offen lds
    s_add_u32 m0, s45, 86016
    s_add_u32 s44, s51, 164608
    s_and_b32 s44, s44, 0x7ffff
    buffer_load_dwordx4 v253, s[20:23], s44 offen lds
    s_add_u32 m0, s45, 90112
    s_add_u32 s44, s51, 197376
    s_and_b32 s44, s44, 0x7ffff
    buffer_load_dwordx4 v253, s[20:23], s44 offen lds
    s_add_u32 m0, s45, 94208
    s_add_u32 s44, s51, 230144
    s_and_b32 s44, s44, 0x7ffff
    buffer_load_dwordx4 v253, s[20:23], s44 offen lds
    s_waitcnt vmcnt(8)
    s_barrier
    s_add_u32 m0, s45, 98304
    s_add_u32 s44, s51, 262912
    s_and_b32 s44, s44, 0x7ffff
    buffer_load_dwordx4 v253, s[20:23], s44 offen lds
    s_add_u32 m0, s45, 102400
    s_add_u32 s44, s51, 295680
    s_and_b32 s44, s44, 0x7ffff
    buffer_load_dwordx4 v253, s[20:23], s44 offen lds
    s_add_u32 m0, s45, 106496
    s_add_u32 s44, s51, 328448
    s_and_b32 s44, s44, 0x7ffff
    buffer_load_dwordx4 v253, s[20:23], s44 offen lds
    s_add_u32 m0, s45, 110592
    s_add_u32 s44, s51, 361216
    s_and_b32 s44, s44, 0x7ffff
    buffer_load_dwordx4 v253, s[20:23], s44 offen lds
    s_add_u32 m0, s45, 114688
    s_add_u32 s44, s51, 393984
    s_and_b32 s44, s44, 0x7ffff
    buffer_load_dwordx4 v253, s[20:23], s44 offen lds
    s_add_u32 m0, s45, 118784
    s_add_u32 s44, s51, 426752
    s_and_b32 s44, s44, 0x7ffff
    buffer_load_dwordx4 v253, s[20:23], s44 offen lds
    s_add_u32 m0, s45, 122880
    s_add_u32 s44, s51, 459520
    s_and_b32 s44, s44, 0x7ffff
    buffer_load_dwordx4 v253, s[20:23], s44 offen lds
    s_add_u32 m0, s45, 126976
    s_add_u32 s44, s51, 492288
    s_and_b32 s44, s44, 0x7ffff
    buffer_load_dwordx4 v253, s[20:23], s44 offen lds
    s_waitcnt vmcnt(12)
    s_barrier
    s_waitcnt vmcnt(8)
    s_barrier
    s_add_u32 m0, s45, 32768
    s_add_u32 s44, s51, 896
    s_and_b32 s44, s44, 0x7ffff
    buffer_load_dwordx4 v253, s[20:23], s44 offen lds
    s_add_u32 m0, s45, 36864
    s_add_u32 s44, s51, 33664
    s_and_b32 s44, s44, 0x7ffff
    buffer_load_dwordx4 v253, s[20:23], s44 offen lds
    s_add_u32 m0, s45, 40960
    s_add_u32 s44, s51, 66432
    s_and_b32 s44, s44, 0x7ffff
    buffer_load_dwordx4 v253, s[20:23], s44 offen lds
    s_add_u32 m0, s45, 45056
    s_add_u32 s44, s51, 99200
    s_and_b32 s44, s44, 0x7ffff
    buffer_load_dwordx4 v253, s[20:23], s44 offen lds
    s_add_u32 m0, s45, 49152
    s_add_u32 s44, s51, 131968
    s_and_b32 s44, s44, 0x7ffff
    buffer_load_dwordx4 v253, s[20:23], s44 offen lds
    s_add_u32 m0, s45, 53248
    s_add_u32 s44, s51, 164736
    s_and_b32 s44, s44, 0x7ffff
    buffer_load_dwordx4 v253, s[20:23], s44 offen lds
    s_add_u32 m0, s45, 57344
    s_add_u32 s44, s51, 197504
    s_and_b32 s44, s44, 0x7ffff
    buffer_load_dwordx4 v253, s[20:23], s44 offen lds
    s_add_u32 m0, s45, 61440
    s_add_u32 s44, s51, 230272
    s_and_b32 s44, s44, 0x7ffff
    buffer_load_dwordx4 v253, s[20:23], s44 offen lds
    s_waitcnt vmcnt(12)
    s_barrier
    s_add_u32 m0, s45, 131072
    s_add_u32 s44, s51, 263040
    s_and_b32 s44, s44, 0x7ffff
    buffer_load_dwordx4 v253, s[20:23], s44 offen lds
    s_add_u32 m0, s45, 135168
    s_add_u32 s44, s51, 295808
    s_and_b32 s44, s44, 0x7ffff
    buffer_load_dwordx4 v253, s[20:23], s44 offen lds
    s_add_u32 m0, s45, 139264
    s_add_u32 s44, s51, 328576
    s_and_b32 s44, s44, 0x7ffff
    buffer_load_dwordx4 v253, s[20:23], s44 offen lds
    s_add_u32 m0, s45, 143360
    s_add_u32 s44, s51, 361344
    s_and_b32 s44, s44, 0x7ffff
    buffer_load_dwordx4 v253, s[20:23], s44 offen lds
    s_add_u32 m0, s45, 147456
    s_add_u32 s44, s51, 394112
    s_and_b32 s44, s44, 0x7ffff
    buffer_load_dwordx4 v253, s[20:23], s44 offen lds
    s_add_u32 m0, s45, 151552
    s_add_u32 s44, s51, 426880
    s_and_b32 s44, s44, 0x7ffff
    buffer_load_dwordx4 v253, s[20:23], s44 offen lds
    s_add_u32 m0, s45, 155648
    s_add_u32 s44, s51, 459648
    s_and_b32 s44, s44, 0x7ffff
    buffer_load_dwordx4 v253, s[20:23], s44 offen lds
    s_add_u32 m0, s45, 159744
    s_add_u32 s44, s51, 492416
    s_and_b32 s44, s44, 0x7ffff
    buffer_load_dwordx4 v253, s[20:23], s44 offen lds
    s_waitcnt vmcnt(0)
    s_barrier
    s_mov_b32 s84, 0
L_red:
    v_lshlrev_b32 v1, 7, v0
    v_and_b32 v4, 15, v0
    v_lshlrev_b32 v4, 11, v4
    v_bfe_u32 v5, v0, 4, 1
    v_lshl_add_u32 v4, v5, 5, v4
    v_lshrrev_b32 v5, 5, v0
    v_lshl_add_u32 v4, v5, 4, v4
    s_mov_b32 s85, 0
L_hs:
    v_cmp_le_u32 vcc, 8, v241
    s_cbranch_vccnz L_hs_ok
    buffer_load_dword v241, v252, s[76:79], 0 offen sc1
    s_add_u32 s85, s85, 1
    s_waitcnt vmcnt(0)
    s_cmp_lt_u32 s85, 0x80000
    s_cbranch_scc1 L_hs
L_hs_ok:
    s_add_u32 s87, s37, s84
    s_mov_b32 s85, 0
L_poll:
    buffer_load_dword v6, v1, s[72:75], 0 offen sc1
    s_add_u32 s85, s85, 1
    s_waitcnt vmcnt(0)
    v_cmp_lt_u32 vcc, s87, v6
    s_cmp_eq_u32 vcc_lo, 0xff
    s_cbranch_scc1 L_got
    s_cmp_lt_u32 s85, 0x80000
    s_cbranch_scc1 L_poll
L_got:
    s_lshl_b32 s88, s87, 17
    s_lshl_b32 s89, s6, 11
    s_add_u32 s88, s88, s89
    buffer_load_dwordx4 v[16:19], v252, s[32:35], s88 offen offset:0 sc1
    buffer_load_dwordx4 v[20:23], v252, s[32:35], s88 offen offset:1024 sc1
    s_add_u32 s88, s88, 16384
    buffer_load_dwordx4 v[24:27], v252, s[32:35], s88 offen offset:0 sc1
    buffer_load_dwordx4 v[28:31], v252, s[32:35], s88 offen offset:1024 sc1
    s_add_u32 s88, s88, 16384
    s_cmp_lg_u32 s84, 0
    s_cbranch_scc1 L_rb4
    s_waitcnt vmcnt(1)
L_rb4:
    buffer_load_dwordx4 v[32:35], v252, s[32:35], s88 offen offset:0 sc1
    buffer_load_dwordx4 v[36:39], v252, s[32:35], s88 offen offset:1024 sc1
    s_add_u32 s88, s88, 16384
    buffer_load_dwordx4 v[40:43], v252, s[32:35], s88 offen offset:0 sc1
    buffer_load_dwordx4 v[44:47], v252, s[32:35], s88 offen offset:1024 sc1
    s_add_u32 s88, s88, 16384
    s_cmp_lg_u32 s84, 0
    s_cbranch_scc1 L_rb8
    s_waitcnt vmcnt(1)
L_rb8:
    buffer_load_dwordx4 v[48:51], v252, s[32:35], s88 offen offset:0 sc1
    buffer_load_dwordx4 v[52:55], v252, s[32:35], s88 offen offset:1024 sc1
    s_add_u32 s88, s88, 16384
    buffer_load_dwordx4 v[56:59], v252, s[32:35], s88 offen offset:0 sc1
    buffer_load_dwordx4 v[60:63], v252, s[32:35], s88 offen offset:1024 sc1
    s_add_u32 s88, s88, 16384
    s_cmp_lg_u32 s84, 0
    s_cbranch_scc1 L_rb12
    s_waitcnt vmcnt(1)
L_rb12:
    buffer_load_dwordx4 v[64:67], v252, s[32:35], s88 offen offset:0 sc1
    buffer_load_dwordx4 v[68:71], v252, s[32:35], s88 offen offset:1024 sc1
    s_add_u32 s88, s88, 16384
    buffer_load_dwordx4 v[72:75], v252, s[32:35], s88 offen offset:0 sc1
    buffer_load_dwordx4 v[76:79], v252, s[32:35], s88 offen offset:1024 sc1
    s_lshl_b32 s89, s87, 7
    s_waitcnt vmcnt(15)
    v_lshlrev_b32 v80, 16, v16
    v_and_b32 v81, 0xffff0000, v16
    v_lshlrev_b32 v82, 16, v17
    v_and_b32 v83, 0xffff0000, v17
    v_lshlrev_b32 v84, 16, v18
    v_and_b32 v85, 0xffff0000, v18
    v_lshlrev_b32 v86, 16, v19
    v_and_b32 v87, 0xffff0000, v19
    s_waitcnt vmcnt(14)
    v_lshlrev_b32 v88, 16, v20
    v_and_b32 v89, 0xffff0000, v20
    v_lshlrev_b32 v90, 16, v21
    v_and_b32 v91, 0xffff0000, v21
    v_lshlrev_b32 v92, 16, v22
    v_and_b32 v93, 0xffff0000, v22
    v_lshlrev_b32 v94, 16, v23
    v_and_b32 v95, 0xffff0000, v23
    s_waitcnt vmcnt(13)
    v_lshlrev_b32 v6, 16, v24
    v_and_b32 v7, 0xffff0000, v24
    v_add_f32 v80, v80, v6
    v_add_f32 v81, v81, v7
    v_lshlrev_b32 v6, 16, v25
    v_and_b32 v7, 0xffff0000, v25
    v_add_f32 v82, v82, v6
    v_add_f32 v83, v83, v7
    v_lshlrev_b32 v6, 16, v26
    v_and_b32 v7, 0xffff0000, v26
    v_add_f32 v84, v84, v6
    v_add_f32 v85, v85, v7
    v_lshlrev_b32 v6, 16, v27
    v_and_b32 v7, 0xffff0000, v27
    v_add_f32 v86, v86, v6
    v_add_f32 v87, v87, v7
    s_waitcnt vmcnt(12)
    v_lshlrev_b32 v6, 16, v28
    v_and_b32 v7, 0xffff0000, v28
    v_add_f32 v88, v88, v6
    v_add_f32 v89, v89, v7
    v_lshlrev_b32 v6, 16, v29
    v_and_b32 v7, 0xffff0000, v29
    v_add_f32 v90, v90, v6
    v_add_f32 v91, v91, v7
    v_lshlrev_b32 v6, 16, v30
    v_and_b32 v7, 0xffff0000, v30
    v_add_f32 v92, v92, v6
    v_add_f32 v93, v93, v7
    v_lshlrev_b32 v6, 16, v31
    v_and_b32 v7, 0xffff0000, v31
    v_add_f32 v94, v94, v6
    v_add_f32 v95, v95, v7
    s_waitcnt vmcnt(11)
    v_lshlrev_b32 v6, 16, v32
    v_and_b32 v7, 0xffff0000, v32
    v_add_f32 v80, v80, v6
    v_add_f32 v81, v81, v7
    v_lshlrev_b32 v6, 16, v33
    v_and_b32 v7, 0xffff0000, v33
    v_add_f32 v82, v82, v6
    v_add_f32 v83, v83, v7
    v_lshlrev_b32 v6, 16, v34
    v_and_b32 v7, 0xffff0000, v34
    v_add_f32 v84, v84, v6
    v_add_f32 v85, v85, v7
    v_lshlrev_b32 v6, 16, v35
    v_and_b32 v7, 0xffff0000, v35
    v_add_f32 v86, v86, v6
    v_add_f32 v87, v87, v7
    s_waitcnt vmcnt(10)
    v_lshlrev_b32 v6, 16, v36
    v_and_b32 v7, 0xffff0000, v36
    v_add_f32 v88, v88, v6
    v_add_f32 v89, v89, v7
    v_lshlrev_b32 v6, 16, v37
    v_and_b32 v7, 0xffff0000, v37
    v_add_f32 v90, v90, v6
    v_add_f32 v91, v91, v7
    v_lshlrev_b32 v6, 16, v38
    v_and_b32 v7, 0xffff0000, v38
    v_add_f32 v92, v92, v6
    v_add_f32 v93, v93, v7
    v_lshlrev_b32 v6, 16, v39
    v_and_b32 v7, 0xffff0000, v39
    v_add_f32 v94, v94, v6
    v_add_f32 v95, v95, v7
    s_waitcnt vmcnt(9)
    v_lshlrev_b32 v6, 16, v40
    v_and_b32 v7, 0xffff0000, v40
    v_add_f32 v80, v80, v6
    v_add_f32 v81, v81, v7
    v_lshlrev_b32 v6, 16, v41
    v_and_b32 v7, 0xffff0000, v41
    v_add_f32 v82, v82, v6
    v_add_f32 v83, v83, v7
    v_lshlrev_b32 v6, 16, v42
    v_and_b32 v7, 0xffff0000, v42
    v_add_f32 v84, v84, v6
    v_add_f32 v85, v85, v7
    v_lshlrev_b32 v6, 16, v43
    v_and_b32 v7, 0xffff0000, v43
    v_add_f32 v86, v86, v6
    v_add_f32 v87, v87, v7
    s_waitcnt vmcnt(8)
    v_lshlrev_b32 v6, 16, v44
    v_and_b32 v7, 0xffff0000, v44
    v_add_f32 v88, v88, v6
    v_add_f32 v89, v89, v7
    v_lshlrev_b32 v6, 16, v45
    v_and_b32 v7, 0xffff0000, v45
    v_add_f32 v90, v90, v6
    v_add_f32 v91, v91, v7
    v_lshlrev_b32 v6, 16, v46
    v_and_b32 v7, 0xffff0000, v46
    v_add_f32 v92, v92, v6
    v_add_f32 v93, v93, v7
    v_lshlrev_b32 v6, 16, v47
    v_and_b32 v7, 0xffff0000, v47
    v_add_f32 v94, v94, v6
    v_add_f32 v95, v95, v7
    s_waitcnt vmcnt(7)
    v_lshlrev_b32 v6, 16, v48
    v_and_b32 v7, 0xffff0000, v48
    v_add_f32 v80, v80, v6
    v_add_f32 v81, v81, v7
    v_lshlrev_b32 v6, 16, v49
    v_and_b32 v7, 0xffff0000, v49
    v_add_f32 v82, v82, v6
    v_add_f32 v83, v83, v7
    v_lshlrev_b32 v6, 16, v50
    v_and_b32 v7, 0xffff0000, v50
    v_add_f32 v84, v84, v6
    v_add_f32 v85, v85, v7
    v_lshlrev_b32 v6, 16, v51
    v_and_b32 v7, 0xffff0000, v51
    v_add_f32 v86, v86, v6
    v_add_f32 v87, v87, v7
    s_waitcnt vmcnt(6)
    v_lshlrev_b32 v6, 16, v52
    v_and_b32 v7, 0xffff0000, v52
    v_add_f32 v88, v88, v6
    v_add_f32 v89, v89, v7
    v_lshlrev_b32 v6, 16, v53
    v_and_b32 v7, 0xffff0000, v53
    v_add_f32 v90, v90, v6
    v_add_f32 v91, v91, v7
    v_lshlrev_b32 v6, 16, v54
    v_and_b32 v7, 0xffff0000, v54
    v_add_f32 v92, v92, v6
    v_add_f32 v93, v93, v7
    v_lshlrev_b32 v6, 16, v55
    v_and_b32 v7, 0xffff0000, v55
    v_add_f32 v94, v94, v6
    v_add_f32 v95, v95, v7
    s_waitcnt vmcnt(5)
    v_lshlrev_b32 v6, 16, v56
    v_and_b32 v7, 0xffff0000, v56
    v_add_f32 v80, v80, v6
    v_add_f32 v81, v81, v7
    v_lshlrev_b32 v6, 16, v57
    v_and_b32 v7, 0xffff0000, v57
    v_add_f32 v82, v82, v6
    v_add_f32 v83, v83, v7
    v_lshlrev_b32 v6, 16, v58
    v_and_b32 v7, 0xffff0000, v58
    v_add_f32 v84, v84, v6
    v_add_f32 v85, v85, v7
    v_lshlrev_b32 v6, 16, v59
    v_and_b32 v7, 0xffff0000, v59
    v_add_f32 v86, v86, v6
    v_add_f32 v87, v87, v7
    s_waitcnt vmcnt(4)
    v_lshlrev_b32 v6, 16, v60
    v_and_b32 v7, 0xffff0000, v60
    v_add_f32 v88, v88, v6
    v_add_f32 v89, v89, v7
    v_lshlrev_b32 v6, 16, v61
    v_and_b32 v7, 0xffff0000, v61
    v_add_f32 v90, v90, v6
    v_add_f32 v91, v91, v7
    v_lshlrev_b32 v6, 16, v62
    v_and_b32 v7, 0xffff0000, v62
    v_add_f32 v92, v92, v6
    v_add_f32 v93, v93, v7
    v_lshlrev_b32 v6, 16, v63
    v_and_b32 v7, 0xffff0000, v63
    v_add_f32 v94, v94, v6
    v_add_f32 v95, v95, v7
    s_waitcnt vmcnt(3)
    v_lshlrev_b32 v6, 16, v64
    v_and_b32 v7, 0xffff0000, v64
    v_add_f32 v80, v80, v6
    v_add_f32 v81, v81, v7
    v_lshlrev_b32 v6, 16, v65
    v_and_b32 v7, 0xffff0000, v65
    v_add_f32 v82, v82, v6
    v_add_f32 v83, v83, v7
    v_lshlrev_b32 v6, 16, v66
    v_and_b32 v7, 0xffff0000, v66
    v_add_f32 v84, v84, v6
    v_add_f32 v85, v85, v7
    v_lshlrev_b32 v6, 16, v67
    v_and_b32 v7, 0xffff0000, v67
    v_add_f32 v86, v86, v6
    v_add_f32 v87, v87, v7
    s_waitcnt vmcnt(2)
    v_lshlrev_b32 v6, 16, v68
    v_and_b32 v7, 0xffff0000, v68
    v_add_f32 v88, v88, v6
    v_add_f32 v89, v89, v7
    v_lshlrev_b32 v6, 16, v69
    v_and_b32 v7, 0xffff0000, v69
    v_add_f32 v90, v90, v6
    v_add_f32 v91, v91, v7
    v_lshlrev_b32 v6, 16, v70
    v_and_b32 v7, 0xffff0000, v70
    v_add_f32 v92, v92, v6
    v_add_f32 v93, v93, v7
    v_lshlrev_b32 v6, 16, v71
    v_and_b32 v7, 0xffff0000, v71
    v_add_f32 v94, v94, v6
    v_add_f32 v95, v95, v7
    s_waitcnt vmcnt(1)
    v_lshlrev_b32 v6, 16, v72
    v_and_b32 v7, 0xffff0000, v72
    v_add_f32 v80, v80, v6
    v_add_f32 v81, v81, v7
    v_lshlrev_b32 v6, 16, v73
    v_and_b32 v7, 0xffff0000, v73
    v_add_f32 v82, v82, v6
    v_add_f32 v83, v83, v7
    v_lshlrev_b32 v6, 16, v74
    v_and_b32 v7, 0xffff0000, v74
    v_add_f32 v84, v84, v6
    v_add_f32 v85, v85, v7
    v_lshlrev_b32 v6, 16, v75
    v_and_b32 v7, 0xffff0000, v75
    v_add_f32 v86, v86, v6
    v_add_f32 v87, v87, v7
    s_waitcnt vmcnt(0)
    v_lshlrev_b32 v6, 16, v76
    v_and_b32 v7, 0xffff0000, v76
    v_add_f32 v88, v88, v6
    v_add_f32 v89, v89, v7
    v_lshlrev_b32 v6, 16, v77
    v_and_b32 v7, 0xffff0000, v77
    v_add_f32 v90, v90, v6
    v_add_f32 v91, v91, v7
    v_lshlrev_b32 v6, 16, v78
    v_and_b32 v7, 0xffff0000, v78
    v_add_f32 v92, v92, v6
    v_add_f32 v93, v93, v7
    v_lshlrev_b32 v6, 16, v79
    v_and_b32 v7, 0xffff0000, v79
    v_add_f32 v94, v94, v6
    v_add_f32 v95, v95, v7
    v_cvt_pk_bf16_f32 v8, v80, v81
    v_cvt_pk_bf16_f32 v9, v82, v83
    v_cvt_pk_bf16_f32 v10, v84, v85
    v_cvt_pk_bf16_f32 v11, v86, v87
    v_cvt_pk_bf16_f32 v12, v88, v89
    v_cvt_pk_bf16_f32 v13, v90, v91
    v_cvt_pk_bf16_f32 v14, v92, v93
    v_cvt_pk_bf16_f32 v15, v94, v95
    s_nop 1
    v_permlane16_swap_b32 v8, v10
    v_permlane16_swap_b32 v9, v11
    buffer_store_dwordx4 v[8:11], v4, s[80:83], s89 offen offset:0
    v_permlane16_swap_b32 v12, v14
    v_permlane16_swap_b32 v13, v15
    buffer_store_dwordx4 v[12:15], v4, s[80:83], s89 offen offset:64
    s_endpgm
L_P:
    s_cmp_ge_u32 s5, 16
    s_cselect_b32 s74, s84, s74
    s_cselect_b32 s75, s85, s75
    s_cselect_b32 s76, s86, s76
    s_cselect_b32 s77, s87, s77
    s_cselect_b32 s80, s90, s80
    s_cselect_b32 s81, s91, s81
    s_lshl_b32 s56, s7, 22
    s_lshl_b32 s57, s6, 19
    s_add_u32 s56, s56, s57
    s_add_u32 s8, s74, s56
    s_addc_u32 s9, s75, 0
    s_mov_b32 s10, 524288
    s_mov_b32 s11, 0x20000
    s_add_u32 s12, s76, s56
    s_addc_u32 s13, s77, 0
    s_mov_b32 s14, 524288
    s_mov_b32 s15, 0x20000
    s_add_u32 s20, s80, s57
    s_addc_u32 s21, s81, 0
    s_mov_b32 s22, 524288
    s_mov_b32 s23, 0x20000
    s_lshl_b32 s56, s5, 21
    s_add_u32 s56, s56, 0x100000
    s_add_u32 s32, s92, s56
    s_addc_u32 s33, s93, 0
    s_mov_b32 s34, 1048576
    s_mov_b32 s35, 0x20000
    s_lshl_b32 s56, s5, 3
    s_add_u32 s76, s98, s56
    s_addc_u32 s77, s99, 0
    s_mov_b32 s78, 4
    s_mov_b32 s79, 0x20000
    s_lshl_b32 s56, s7, 18
    s_lshl_b32 s57, s6, 15
    s_add_u32 s56, s56, s57
    s_lshr_b32 s57, s5, 4
    s_lshl_b32 s57, s57, 10
    s_add_u32 s56, s56, s57
    s_add_u32 s80, s96, s56
    s_addc_u32 s81, s97, 0
    s_mov_b32 s82, 0
    s_mov_b32 s83, 0x20000
    s_sub_u32 s82, 0x400000, s56
    s_lshl_b32 s56, s5, 12
    s_lshl_b32 s57, s6, 7
    s_add_u32 s56, s56, s57
    s_add_u32 s56, s56, 75497472
    s_add_u32 s72, s92, s56
    s_addc_u32 s73, s93, 0
    s_mov_b32 s74, 3076
    s_mov_b32 s75, 0x20000
    s_cmp_lg_u32 s37, 3
    s_cbranch_scc1 L_norst
    v_mov_b32 v5, 0
    v_lshlrev_b32 v6, 10, v0
    buffer_store_dword v5, v6, s[72:75], 0 offen sc1
L_norst:
    v_bfe_u32 v5, v1, 1, 2
    v_xor_b32 v5, v5, v2
    v_lshlrev_b32 v5, 4, v5
    v_lshl_add_u32 v5, v1, 7, v5
    v_add_u32 v253, s53, v5
    v_add_u32 v254, 65536, v253
    v_add_u32 v255, 131072, v253
    s_add_u32 s43, s43, 256
    s_and_b32 s43, s43, 0x3803ff
    s_add_u32 s46, s45, 65536
    s_mov_b32 s30, 2
    v_lshrrev_b32 v5, 1, v3
    v_and_b32 v6, 1, v2
    v_lshl_add_u32 v5, v6, 1, v5
    v_lshl_add_u32 v6, v2, 3, v3
    v_lshlrev_b32 v6, 7, v6
    v_lshl_add_u32 v6, v4, 3, v6
    v_xor_b32 v7, 0, v5
    v_lshl_add_u32 v236, v7, 5, v6
    v_add_u32 v232, 65536, v236
    v_add_u32 v248, 131072, v236
    v_xor_b32 v7, 1, v5
    v_lshl_add_u32 v237, v7, 5, v6
    v_add_u32 v233, 65536, v237
    v_add_u32 v249, 131072, v237
    v_xor_b32 v7, 2, v5
    v_lshl_add_u32 v238, v7, 5, v6
    v_add_u32 v234, 65536, v238
    v_add_u32 v250, 131072, v238
    v_xor_b32 v7, 3, v5
    v_lshl_add_u32 v239, v7, 5, v6
    v_add_u32 v235, 65536, v239
    v_add_u32 v251, 131072, v239
    s_lshl_b32 s44, s37, 2
    v_add_u32 v5, s44, v2
    v_xor_b32 v6, v5, v1
    v_lshlrev_b32 v6, 4, v6
    s_lshl_b32 s44, s37, 4
    v_add_u32 v7, s44, v2
    v_lshlrev_b32 v7, 8, v7
    v_add_u32 v242, v7, v6
    v_and_b32 v5, 7, v5
    v_lshlrev_b32 v5, 1, v5
    v_xor_b32 v6, v5, v1
    v_lshlrev_b32 v6, 4, v6
    v_add_u32 v243, v7, v6
    v_lshrrev_b32 v5, 1, v2
    v_lshlrev_b32 v5, 8, v5
    v_lshl_add_u32 v5, v1, 4, v5
    v_and_b32 v6, 1, v2
    v_lshl_add_u32 v5, v6, 3, v5
    s_lshl_b32 s44, s37, 13
    s_add_u32 s44, s44, 131072
    v_add_u32 v246, s44, v5
    v_lshrrev_b32 v5, 3, v0
    v_bfe_u32 v6, v0, 4, 1
    s_and_b32 s44, s37, 1
    s_lshl_b32 s44, s44, 1
    v_or_b32 v6, s44, v6
    v_lshlrev_b32 v6, 1, v6
    v_and_b32 v7, 7, v0
    v_xor_b32 v6, v6, v7
    v_lshlrev_b32 v6, 4, v6
    v_and_b32 v7, 3, v5
    v_lshrrev_b32 v5, 2, v5
    v_lshl_add_u32 v7, v5, 4, v7
    s_lshl_b32 s44, s37, 2
    v_add_u32 v7, s44, v7
    v_lshl_add_u32 v245, v7, 10, v6
    s_mov_b32 s40, 0x3e0293ee
    s_mov_b32 s28, -1
    s_mov_b32 s29, -2
    s_add_u32 s41, s51, 16384
    s_mov_b32 s42, s51
    s_mov_b32 s38, 2
    s_waitcnt vmcnt(0)
    s_bfe_u32 s85, s2, 0x20003
    s_add_u32 s85, s85, 3
    s_cmp_eq_u32 s37, 3
    s_cselect_b32 s85, s85, 99
    s_lshl_b32 s56, s37, 10
    s_add_u32 s72, s72, s56
    s_addc_u32 s73, s73, 0
    s_mov_b32 s74, 4
    s_barrier
    ds_read_b128 v[8:11], v255 offset:16384
    ds_read_b128 v[12:15], v255 offset:18432
    ds_read_b128 v[16:19], v255 offset:16448
    ds_read_b128 v[20:23], v255 offset:18496
    ds_read_b64_tr_b16 v[184:185], v248 offset:0
    ds_read_b64_tr_b16 v[186:187], v248 offset:512
    ds_read_b64_tr_b16 v[188:189], v248 offset:4096
    ds_read_b64_tr_b16 v[190:191], v248 offset:4608
    ds_read_b64_tr_b16 v[192:193], v249 offset:0
    ds_read_b64_tr_b16 v[194:195], v249 offset:512
    ds_read_b64_tr_b16 v[196:197], v249 offset:4096
    ds_read_b64_tr_b16 v[198:199], v249 offset:4608
    ds_read_b64_tr_b16 v[200:201], v250 offset:0
    ds_read_b64_tr_b16 v[202:203], v250 offset:512
    ds_read_b64_tr_b16 v[204:205], v250 offset:4096
    ds_read_b64_tr_b16 v[206:207], v250 offset:4608
    ds_read_b64_tr_b16 v[208:209], v251 offset:0
    ds_read_b64_tr_b16 v[210:211], v251 offset:512
    ds_read_b64_tr_b16 v[212:213], v251 offset:4096
    ds_read_b64_tr_b16 v[214:215], v251 offset:4608
    s_waitcnt lgkmcnt(12)
    v_mfma_f32_16x16x32_bf16 v[168:171], v[184:187], v[8:11], 0
    v_mfma_f32_16x16x32_bf16 v[168:171], v[188:191], v[16:19], v[168:171]
    v_mfma_f32_16x16x32_bf16 v[172:175], v[188:191], v[20:23], 0
    ds_read_b64_tr_b16 v[188:189], v248 offset:12288
    v_mfma_f32_16x16x32_bf16 v[172:175], v[184:187], v[12:15], v[172:175]
    ds_read_b64_tr_b16 v[190:191], v248 offset:12800
    s_waitcnt lgkmcnt(10)
    v_mfma_f32_16x16x32_bf16 v[176:179], v[192:195], v[8:11], 0
    ds_read_b64_tr_b16 v[184:185], v248 offset:8192
    v_mfma_f32_16x16x32_bf16 v[176:179], v[196:199], v[16:19], v[176:179]
    ds_read_b64_tr_b16 v[186:187], v248 offset:8704
    v_mfma_f32_16x16x32_bf16 v[180:183], v[196:199], v[20:23], 0
    ds_read_b64_tr_b16 v[196:197], v249 offset:12288
    v_mfma_f32_16x16x32_bf16 v[180:183], v[192:195], v[12:15], v[180:183]
    ds_read_b64_tr_b16 v[198:199], v249 offset:12800
    s_waitcnt lgkmcnt(10)
    v_mfma_f32_16x16x32_bf16 v[216:219], v[200:203], v[8:11], 0
    ds_read_b64_tr_b16 v[192:193], v249 offset:8192
    v_mfma_f32_16x16x32_bf16 v[216:219], v[204:207], v[16:19], v[216:219]
    ds_read_b64_tr_b16 v[194:195], v249 offset:8704
    v_mfma_f32_16x16x32_bf16 v[220:223], v[204:207], v[20:23], 0
    ds_read_b64_tr_b16 v[204:205], v250 offset:12288
    v_mfma_f32_16x16x32_bf16 v[220:223], v[200:203], v[12:15], v[220:223]
    ds_read_b64_tr_b16 v[206:207], v250 offset:12800
    s_waitcnt lgkmcnt(10)
    v_mfma_f32_16x16x32_bf16 v[224:227], v[208:211], v[8:11], 0
    ds_read_b64_tr_b16 v[200:201], v250 offset:8192
    v_mfma_f32_16x16x32_bf16 v[224:227], v[212:215], v[16:19], v[224:227]
    ds_read_b64_tr_b16 v[202:203], v250 offset:8704
    v_mfma_f32_16x16x32_bf16 v[228:231], v[212:215], v[20:23], 0
    ds_read_b64_tr_b16 v[212:213], v251 offset:12288
    v_mfma_f32_16x16x32_bf16 v[228:231], v[208:211], v[12:15], v[228:231]
    ds_read_b64_tr_b16 v[214:215], v251 offset:12800
    s_waitcnt lgkmcnt(10)
    v_mfma_f32_16x16x32_bf16 v[136:139], v[184:187], v[8:11], 0
    ds_read_b64_tr_b16 v[208:209], v251 offset:8192
    v_mfma_f32_16x16x32_bf16 v[136:139], v[188:191], v[16:19], v[136:139]
    ds_read_b64_tr_b16 v[210:211], v251 offset:8704
    s_barrier
    ds_read_b128 v[24:27], v253 offset:49152
    v_mfma_f32_16x16x32_bf16 v[140:143], v[188:191], v[20:23], 0
    ds_read_b64_tr_b16 v[188:189], v236 offset:36864
    v_mfma_f32_16x16x32_bf16 v[140:143], v[184:187], v[12:15], v[140:143]
    ds_read_b128 v[28:31], v253 offset:51200
    ds_read_b64_tr_b16 v[190:191], v236 offset:37376
    s_waitcnt lgkmcnt(12)
    v_mfma_f32_16x16x32_bf16 v[144:147], v[192:195], v[8:11], 0
    ds_read_b64_tr_b16 v[184:185], v236 offset:32768
    v_mfma_f32_16x16x32_bf16 v[144:147], v[196:199], v[16:19], v[144:147]
    ds_read_b128 v[32:35], v253 offset:49216
    ds_read_b64_tr_b16 v[186:187], v236 offset:33280
    v_mfma_f32_16x16x32_bf16 v[148:151], v[196:199], v[20:23], 0
    ds_read_b64_tr_b16 v[196:197], v237 offset:36864
    v_mfma_f32_16x16x32_bf16 v[148:151], v[192:195], v[12:15], v[148:151]
    ds_read_b128 v[36:39], v253 offset:51264
    ds_read_b64_tr_b16 v[198:199], v237 offset:37376
    s_waitcnt lgkmcnt(14)
    v_mfma_f32_16x16x32_bf16 v[152:155], v[200:203], v[8:11], 0
    ds_read_b64_tr_b16 v[192:193], v237 offset:32768
    v_mfma_f32_16x16x32_bf16 v[152:155], v[204:207], v[16:19], v[152:155]
    ds_read_b64_tr_b16 v[194:195], v237 offset:33280
    v_mfma_f32_16x16x32_bf16 v[156:159], v[204:207], v[20:23], 0
    ds_read_b64_tr_b16 v[204:205], v238 offset:36864
    v_mfma_f32_16x16x32_bf16 v[156:159], v[200:203], v[12:15], v[156:159]
    ds_read_b64_tr_b16 v[206:207], v238 offset:37376
    s_waitcnt lgkmcnt(14)
    v_mfma_f32_16x16x32_bf16 v[160:163], v[208:211], v[8:11], 0
    ds_read_b64_tr_b16 v[200:201], v238 offset:32768
    v_mfma_f32_16x16x32_bf16 v[160:163], v[212:215], v[16:19], v[160:163]
    ds_read_b64_tr_b16 v[202:203], v238 offset:33280
    v_mfma_f32_16x16x32_bf16 v[164:167], v[212:215], v[20:23], 0
    ds_read_b64_tr_b16 v[212:213], v239 offset:36864
    v_mfma_f32_16x16x32_bf16 v[164:167], v[208:211], v[12:15], v[164:167]
    ds_read_b64_tr_b16 v[214:215], v239 offset:37376
    s_waitcnt lgkmcnt(11)
    v_mfma_f32_16x16x32_bf16 v[168:171], v[184:187], v[24:27], v[168:171]
    ds_read_b64_tr_b16 v[208:209], v239 offset:32768
    v_mfma_f32_16x16x32_bf16 v[168:171], v[188:191], v[32:35], v[168:171]
    ds_read_b64_tr_b16 v[210:211], v239 offset:33280
    s_waitcnt lgkmcnt(11)
    v_mfma_f32_16x16x32_bf16 v[172:175], v[188:191], v[36:39], v[172:175]
    ds_read_b64_tr_b16 v[188:189], v236 offset:45056
    v_mfma_f32_16x16x32_bf16 v[172:175], v[184:187], v[28:31], v[172:175]
    ds_read_b64_tr_b16 v[190:191], v236 offset:45568
    s_waitcnt lgkmcnt(10)
    v_mfma_f32_16x16x32_bf16 v[176:179], v[192:195], v[24:27], v[176:179]
    ds_read_b64_tr_b16 v[184:185], v236 offset:40960
    v_mfma_f32_16x16x32_bf16 v[176:179], v[196:199], v[32:35], v[176:179]
    ds_read_b64_tr_b16 v[186:187], v236 offset:41472
    v_mfma_f32_16x16x32_bf16 v[180:183], v[196:199], v[36:39], v[180:183]
    ds_read_b64_tr_b16 v[196:197], v237 offset:45056
    v_mfma_f32_16x16x32_bf16 v[180:183], v[192:195], v[28:31], v[180:183]
    ds_read_b64_tr_b16 v[198:199], v237 offset:45568
    s_waitcnt lgkmcnt(10)
    v_mfma_f32_16x16x32_bf16 v[216:219], v[200:203], v[24:27], v[216:219]
    ds_read_b64_tr_b16 v[192:193], v237 offset:40960
    v_mfma_f32_16x16x32_bf16 v[216:219], v[204:207], v[32:35], v[216:219]
    ds_read_b64_tr_b16 v[194:195], v237 offset:41472
    v_mfma_f32_16x16x32_bf16 v[220:223], v[204:207], v[36:39], v[220:223]
    ds_read_b64_tr_b16 v[204:205], v238 offset:45056
    v_mfma_f32_16x16x32_bf16 v[220:223], v[200:203], v[28:31], v[220:223]
    ds_read_b64_tr_b16 v[206:207], v238 offset:45568
    s_waitcnt lgkmcnt(10)
    v_mfma_f32_16x16x32_bf16 v[224:227], v[208:211], v[24:27], v[224:227]
    ds_read_b64_tr_b16 v[200:201], v238 offset:40960
    v_mfma_f32_16x16x32_bf16 v[224:227], v[212:215], v[32:35], v[224:227]
    ds_read_b64_tr_b16 v[202:203], v238 offset:41472
    v_mfma_f32_16x16x32_bf16 v[228:231], v[212:215], v[36:39], v[228:231]
    ds_read_b64_tr_b16 v[212:213], v239 offset:45056
    v_mfma_f32_16x16x32_bf16 v[228:231], v[208:211], v[28:31], v[228:231]
    ds_read_b64_tr_b16 v[214:215], v239 offset:45568
    s_waitcnt lgkmcnt(10)
    v_mfma_f32_16x16x32_bf16 v[136:139], v[184:187], v[24:27], v[136:139]
    ds_read_b64_tr_b16 v[208:209], v239 offset:40960
    v_mfma_f32_16x16x32_bf16 v[136:139], v[188:191], v[32:35], v[136:139]
    ds_read_b64_tr_b16 v[210:211], v239 offset:41472
    s_barrier
    ds_read_b128 v[40:43], v254 offset:49152
    v_mfma_f32_16x16x32_bf16 v[140:143], v[188:191], v[36:39], v[140:143]
    ds_read_b64_tr_b16 v[188:189], v232 offset:36864
    v_mfma_f32_16x16x32_bf16 v[140:143], v[184:187], v[28:31], v[140:143]
    ds_read_b128 v[44:47], v254 offset:51200
    ds_read_b64_tr_b16 v[190:191], v232 offset:37376
    s_waitcnt lgkmcnt(12)
    v_mfma_f32_16x16x32_bf16 v[144:147], v[192:195], v[24:27], v[144:147]
    ds_read_b64_tr_b16 v[184:185], v232 offset:32768
    v_mfma_f32_16x16x32_bf16 v[144:147], v[196:199], v[32:35], v[144:147]
    ds_read_b128 v[48:51], v254 offset:49216
    ds_read_b64_tr_b16 v[186:187], v232 offset:33280
    v_mfma_f32_16x16x32_bf16 v[148:151], v[196:199], v[36:39], v[148:151]
    ds_read_b64_tr_b16 v[196:197], v233 offset:36864
    v_mfma_f32_16x16x32_bf16 v[148:151], v[192:195], v[28:31], v[148:151]
    ds_read_b128 v[52:55], v254 offset:51264
    ds_read_b64_tr_b16 v[198:199], v233 offset:37376
    s_waitcnt lgkmcnt(14)
    v_mfma_f32_16x16x32_bf16 v[152:155], v[200:203], v[24:27], v[152:155]
    ds_read_b64_tr_b16 v[192:193], v233 offset:32768
    v_mfma_f32_16x16x32_bf16 v[152:155], v[204:207], v[32:35], v[152:155]
    ds_read_b64_tr_b16 v[194:195], v233 offset:33280
    v_mfma_f32_16x16x32_bf16 v[156:159], v[204:207], v[36:39], v[156:159]
    ds_read_b64_tr_b16 v[204:205], v234 offset:36864
    v_mfma_f32_16x16x32_bf16 v[156:159], v[200:203], v[28:31], v[156:159]
    ds_read_b64_tr_b16 v[206:207], v234 offset:37376
    s_waitcnt lgkmcnt(14)
    v_mfma_f32_16x16x32_bf16 v[160:163], v[208:211], v[24:27], v[160:163]
    ds_read_b64_tr_b16 v[200:201], v234 offset:32768
    v_mfma_f32_16x16x32_bf16 v[160:163], v[212:215], v[32:35], v[160:163]
    ds_read_b64_tr_b16 v[202:203], v234 offset:33280
    v_mfma_f32_16x16x32_bf16 v[164:167], v[212:215], v[36:39], v[164:167]
    ds_read_b64_tr_b16 v[212:213], v235 offset:36864
    v_mfma_f32_16x16x32_bf16 v[164:167], v[208:211], v[28:31], v[164:167]
    ds_read_b64_tr_b16 v[214:215], v235 offset:37376
    s_waitcnt lgkmcnt(11)
    v_mfma_f32_16x16x32_bf16 v[168:171], v[184:187], v[40:43], v[168:171]
    ds_read_b64_tr_b16 v[208:209], v235 offset:32768
    v_mfma_f32_16x16x32_bf16 v[168:171], v[188:191], v[48:51], v[168:171]
    ds_read_b64_tr_b16 v[210:211], v235 offset:33280
    s_waitcnt lgkmcnt(11)
    v_mfma_f32_16x16x32_bf16 v[172:175], v[188:191], v[52:55], v[172:175]
    ds_read_b64_tr_b16 v[188:189], v232 offset:45056
    v_mfma_f32_16x16x32_bf16 v[172:175], v[184:187], v[44:47], v[172:175]
    ds_read_b64_tr_b16 v[190:191], v232 offset:45568
    s_waitcnt lgkmcnt(10)
    v_mfma_f32_16x16x32_bf16 v[176:179], v[192:195], v[40:43], v[176:179]
    ds_read_b64_tr_b16 v[184:185], v232 offset:40960
    v_mfma_f32_16x16x32_bf16 v[176:179], v[196:199], v[48:51], v[176:179]
    ds_read_b64_tr_b16 v[186:187], v232 offset:41472
    v_mfma_f32_16x16x32_bf16 v[180:183], v[196:199], v[52:55], v[180:183]
    ds_read_b64_tr_b16 v[196:197], v233 offset:45056
    v_mfma_f32_16x16x32_bf16 v[180:183], v[192:195], v[44:47], v[180:183]
    ds_read_b64_tr_b16 v[198:199], v233 offset:45568
    s_waitcnt lgkmcnt(10)
    v_mfma_f32_16x16x32_bf16 v[216:219], v[200:203], v[40:43], v[216:219]
    ds_read_b64_tr_b16 v[192:193], v233 offset:40960
    v_mfma_f32_16x16x32_bf16 v[216:219], v[204:207], v[48:51], v[216:219]
    ds_read_b64_tr_b16 v[194:195], v233 offset:41472
    v_mfma_f32_16x16x32_bf16 v[220:223], v[204:207], v[52:55], v[220:223]
    ds_read_b64_tr_b16 v[204:205], v234 offset:45056
    v_mfma_f32_16x16x32_bf16 v[220:223], v[200:203], v[44:47], v[220:223]
    ds_read_b64_tr_b16 v[206:207], v234 offset:45568
    s_waitcnt lgkmcnt(10)
    v_mfma_f32_16x16x32_bf16 v[224:227], v[208:211], v[40:43], v[224:227]
    ds_read_b64_tr_b16 v[200:201], v234 offset:40960
    v_mfma_f32_16x16x32_bf16 v[224:227], v[212:215], v[48:51], v[224:227]
    ds_read_b64_tr_b16 v[202:203], v234 offset:41472
    v_mfma_f32_16x16x32_bf16 v[228:231], v[212:215], v[52:55], v[228:231]
    ds_read_b64_tr_b16 v[212:213], v235 offset:45056
    v_mfma_f32_16x16x32_bf16 v[228:231], v[208:211], v[44:47], v[228:231]
    ds_read_b64_tr_b16 v[214:215], v235 offset:45568
    s_waitcnt lgkmcnt(10)
    v_mfma_f32_16x16x32_bf16 v[136:139], v[184:187], v[40:43], v[136:139]
    ds_read_b64_tr_b16 v[208:209], v235 offset:40960
    v_mfma_f32_16x16x32_bf16 v[136:139], v[188:191], v[48:51], v[136:139]
    ds_read_b64_tr_b16 v[210:211], v235 offset:41472
    s_barrier
    ds_read_b128 v[56:59], v254 offset:16384
    v_mfma_f32_16x16x32_bf16 v[140:143], v[188:191], v[52:55], v[140:143]
    ds_read_b64_tr_b16 v[188:189], v232 offset:4096
    v_mfma_f32_16x16x32_bf16 v[140:143], v[184:187], v[44:47], v[140:143]
    ds_read_b128 v[60:63], v254 offset:18432
    ds_read_b64_tr_b16 v[190:191], v232 offset:4608
    s_waitcnt lgkmcnt(12)
    v_mfma_f32_16x16x32_bf16 v[144:147], v[192:195], v[40:43], v[144:147]
    ds_read_b64_tr_b16 v[184:185], v232 offset:0
    v_mfma_f32_16x16x32_bf16 v[144:147], v[196:199], v[48:51], v[144:147]
    ds_read_b128 v[64:67], v254 offset:16448
    ds_read_b64_tr_b16 v[186:187], v232 offset:512
    v_mfma_f32_16x16x32_bf16 v[148:151], v[196:199], v[52:55], v[148:151]
    ds_read_b64_tr_b16 v[196:197], v233 offset:4096
    v_mfma_f32_16x16x32_bf16 v[148:151], v[192:195], v[44:47], v[148:151]
    ds_read_b128 v[68:71], v254 offset:18496
    ds_read_b64_tr_b16 v[198:199], v233 offset:4608
    s_waitcnt lgkmcnt(14)
    v_mfma_f32_16x16x32_bf16 v[152:155], v[200:203], v[40:43], v[152:155]
    ds_read_b64_tr_b16 v[192:193], v233 offset:0
    v_mfma_f32_16x16x32_bf16 v[152:155], v[204:207], v[48:51], v[152:155]
    ds_read_b64_tr_b16 v[194:195], v233 offset:512
    v_mfma_f32_16x16x32_bf16 v[156:159], v[204:207], v[52:55], v[156:159]
    ds_read_b64_tr_b16 v[204:205], v234 offset:4096
    v_mfma_f32_16x16x32_bf16 v[156:159], v[200:203], v[44:47], v[156:159]
    ds_read_b64_tr_b16 v[206:207], v234 offset:4608
    s_waitcnt lgkmcnt(14)
    v_mfma_f32_16x16x32_bf16 v[160:163], v[208:211], v[40:43], v[160:163]
    ds_read_b64_tr_b16 v[200:201], v234 offset:0
    v_mfma_f32_16x16x32_bf16 v[160:163], v[212:215], v[48:51], v[160:163]
    ds_read_b64_tr_b16 v[202:203], v234 offset:512
    v_mfma_f32_16x16x32_bf16 v[164:167], v[212:215], v[52:55], v[164:167]
    ds_read_b64_tr_b16 v[212:213], v235 offset:4096
    v_mfma_f32_16x16x32_bf16 v[164:167], v[208:211], v[44:47], v[164:167]
    ds_read_b64_tr_b16 v[214:215], v235 offset:4608
    s_waitcnt lgkmcnt(11)
    v_mfma_f32_16x16x32_bf16 v[168:171], v[184:187], v[56:59], v[168:171]
    ds_read_b64_tr_b16 v[208:209], v235 offset:0
    v_mfma_f32_16x16x32_bf16 v[168:171], v[188:191], v[64:67], v[168:171]
    ds_read_b64_tr_b16 v[210:211], v235 offset:512
    s_waitcnt lgkmcnt(11)
    v_mfma_f32_16x16x32_bf16 v[172:175], v[188:191], v[68:71], v[172:175]
    ds_read_b64_tr_b16 v[188:189], v232 offset:12288
    v_mfma_f32_16x16x32_bf16 v[172:175], v[184:187], v[60:63], v[172:175]
    ds_read_b64_tr_b16 v[190:191], v232 offset:12800
    s_waitcnt lgkmcnt(10)
    v_mfma_f32_16x16x32_bf16 v[176:179], v[192:195], v[56:59], v[176:179]
    ds_read_b64_tr_b16 v[184:185], v232 offset:8192
    v_mfma_f32_16x16x32_bf16 v[176:179], v[196:199], v[64:67], v[176:179]
    ds_read_b64_tr_b16 v[186:187], v232 offset:8704
    v_mfma_f32_16x16x32_bf16 v[180:183], v[196:199], v[68:71], v[180:183]
    ds_read_b64_tr_b16 v[196:197], v233 offset:12288
    v_mfma_f32_16x16x32_bf16 v[180:183], v[192:195], v[60:63], v[180:183]
    ds_read_b64_tr_b16 v[198:199], v233 offset:12800
    s_waitcnt lgkmcnt(10)
    v_mfma_f32_16x16x32_bf16 v[216:219], v[200:203], v[56:59], v[216:219]
    ds_read_b64_tr_b16 v[192:193], v233 offset:8192
    v_mfma_f32_16x16x32_bf16 v[216:219], v[204:207], v[64:67], v[216:219]
    ds_read_b64_tr_b16 v[194:195], v233 offset:8704
    v_mfma_f32_16x16x32_bf16 v[220:223], v[204:207], v[68:71], v[220:223]
    ds_read_b64_tr_b16 v[204:205], v234 offset:12288
    v_mfma_f32_16x16x32_bf16 v[220:223], v[200:203], v[60:63], v[220:223]
    ds_read_b64_tr_b16 v[206:207], v234 offset:12800
    s_waitcnt lgkmcnt(10)
    v_mfma_f32_16x16x32_bf16 v[224:227], v[208:211], v[56:59], v[224:227]
    ds_read_b64_tr_b16 v[200:201], v234 offset:8192
    v_mfma_f32_16x16x32_bf16 v[224:227], v[212:215], v[64:67], v[224:227]
    ds_read_b64_tr_b16 v[202:203], v234 offset:8704
    v_mfma_f32_16x16x32_bf16 v[228:231], v[212:215], v[68:71], v[228:231]
    ds_read_b64_tr_b16 v[212:213], v235 offset:12288
    v_mfma_f32_16x16x32_bf16 v[228:231], v[208:211], v[60:63], v[228:231]
    ds_read_b64_tr_b16 v[214:215], v235 offset:12800
    s_waitcnt lgkmcnt(10)
    v_mfma_f32_16x16x32_bf16 v[136:139], v[184:187], v[56:59], v[136:139]
    ds_read_b64_tr_b16 v[208:209], v235 offset:8192
    v_mfma_f32_16x16x32_bf16 v[136:139], v[188:191], v[64:67], v[136:139]
    ds_read_b64_tr_b16 v[210:211], v235 offset:8704
    s_barrier
    ds_read_b128 v[72:75], v253 offset:16384
    v_mfma_f32_16x16x32_bf16 v[140:143], v[188:191], v[68:71], v[140:143]
    ds_read_b64_tr_b16 v[188:189], v236 offset:4096
    v_mfma_f32_16x16x32_bf16 v[140:143], v[184:187], v[60:63], v[140:143]
    ds_read_b128 v[76:79], v253 offset:18432
    ds_read_b64_tr_b16 v[190:191], v236 offset:4608
    s_waitcnt lgkmcnt(12)
    v_mfma_f32_16x16x32_bf16 v[144:147], v[192:195], v[56:59], v[144:147]
    ds_read_b64_tr_b16 v[184:185], v236 offset:0
    v_mfma_f32_16x16x32_bf16 v[144:147], v[196:199], v[64:67], v[144:147]
    ds_read_b128 v[80:83], v253 offset:16448
    ds_read_b64_tr_b16 v[186:187], v236 offset:512
    v_mfma_f32_16x16x32_bf16 v[148:151], v[196:199], v[68:71], v[148:151]
    ds_read_b64_tr_b16 v[196:197], v237 offset:4096
    v_mfma_f32_16x16x32_bf16 v[148:151], v[192:195], v[60:63], v[148:151]
    ds_read_b128 v[84:87], v253 offset:18496
    ds_read_b64_tr_b16 v[198:199], v237 offset:4608
    s_waitcnt lgkmcnt(14)
    v_mfma_f32_16x16x32_bf16 v[152:155], v[200:203], v[56:59], v[152:155]
    ds_read_b64_tr_b16 v[192:193], v237 offset:0
    v_mfma_f32_16x16x32_bf16 v[152:155], v[204:207], v[64:67], v[152:155]
    ds_read_b64_tr_b16 v[194:195], v237 offset:512
    v_mfma_f32_16x16x32_bf16 v[156:159], v[204:207], v[68:71], v[156:159]
    ds_read_b64_tr_b16 v[204:205], v238 offset:4096
    v_mfma_f32_16x16x32_bf16 v[156:159], v[200:203], v[60:63], v[156:159]
    ds_read_b64_tr_b16 v[206:207], v238 offset:4608
    s_waitcnt lgkmcnt(14)
    v_mfma_f32_16x16x32_bf16 v[160:163], v[208:211], v[56:59], v[160:163]
    ds_read_b64_tr_b16 v[200:201], v238 offset:0
    v_mfma_f32_16x16x32_bf16 v[160:163], v[212:215], v[64:67], v[160:163]
    ds_read_b64_tr_b16 v[202:203], v238 offset:512
    v_mfma_f32_16x16x32_bf16 v[164:167], v[212:215], v[68:71], v[164:167]
    ds_read_b64_tr_b16 v[212:213], v239 offset:4096
    v_mfma_f32_16x16x32_bf16 v[164:167], v[208:211], v[60:63], v[164:167]
    ds_read_b64_tr_b16 v[214:215], v239 offset:4608
    s_waitcnt lgkmcnt(11)
    v_mfma_f32_16x16x32_bf16 v[168:171], v[184:187], v[72:75], v[168:171]
    ds_read_b64_tr_b16 v[208:209], v239 offset:0
    v_mfma_f32_16x16x32_bf16 v[168:171], v[188:191], v[80:83], v[168:171]
    ds_read_b64_tr_b16 v[210:211], v239 offset:512
    s_waitcnt lgkmcnt(11)
    v_mfma_f32_16x16x32_bf16 v[172:175], v[188:191], v[84:87], v[172:175]
    ds_read_b64_tr_b16 v[188:189], v236 offset:12288
    v_mfma_f32_16x16x32_bf16 v[172:175], v[184:187], v[76:79], v[172:175]
    ds_read_b64_tr_b16 v[190:191], v236 offset:12800
    s_waitcnt lgkmcnt(10)
    v_mfma_f32_16x16x32_bf16 v[176:179], v[192:195], v[72:75], v[176:179]
    ds_read_b64_tr_b16 v[184:185], v236 offset:8192
    v_mfma_f32_16x16x32_bf16 v[176:179], v[196:199], v[80:83], v[176:179]
    ds_read_b64_tr_b16 v[186:187], v236 offset:8704
    v_mfma_f32_16x16x32_bf16 v[180:183], v[196:199], v[84:87], v[180:183]
    ds_read_b64_tr_b16 v[196:197], v237 offset:12288
    v_mfma_f32_16x16x32_bf16 v[180:183], v[192:195], v[76:79], v[180:183]
    ds_read_b64_tr_b16 v[198:199], v237 offset:12800
    s_waitcnt lgkmcnt(10)
    v_mfma_f32_16x16x32_bf16 v[216:219], v[200:203], v[72:75], v[216:219]
    ds_read_b64_tr_b16 v[192:193], v237 offset:8192
    v_mfma_f32_16x16x32_bf16 v[216:219], v[204:207], v[80:83], v[216:219]
    ds_read_b64_tr_b16 v[194:195], v237 offset:8704
    v_mfma_f32_16x16x32_bf16 v[220:223], v[204:207], v[84:87], v[220:223]
    ds_read_b64_tr_b16 v[204:205], v238 offset:12288
    v_mfma_f32_16x16x32_bf16 v[220:223], v[200:203], v[76:79], v[220:223]
    ds_read_b64_tr_b16 v[206:207], v238 offset:12800
    s_waitcnt lgkmcnt(10)
    v_mfma_f32_16x16x32_bf16 v[224:227], v[208:211], v[72:75], v[224:227]
    ds_read_b64_tr_b16 v[200:201], v238 offset:8192
    v_mfma_f32_16x16x32_bf16 v[224:227], v[212:215], v[80:83], v[224:227]
    ds_read_b64_tr_b16 v[202:203], v238 offset:8704
    v_mfma_f32_16x16x32_bf16 v[228:231], v[212:215], v[84:87], v[228:231]
    ds_read_b64_tr_b16 v[212:213], v239 offset:12288
    v_mfma_f32_16x16x32_bf16 v[228:231], v[208:211], v[76:79], v[228:231]
    ds_read_b64_tr_b16 v[214:215], v239 offset:12800
    s_waitcnt lgkmcnt(10)
    v_mfma_f32_16x16x32_bf16 v[136:139], v[184:187], v[72:75], v[136:139]
    ds_read_b64_tr_b16 v[208:209], v239 offset:8192
    v_mfma_f32_16x16x32_bf16 v[136:139], v[188:191], v[80:83], v[136:139]
    ds_read_b64_tr_b16 v[210:211], v239 offset:8704
    s_barrier
    ds_read_b128 v[88:91], v255 offset:16384
    v_mfma_f32_16x16x32_bf16 v[140:143], v[188:191], v[84:87], v[140:143]
    ds_read_b64_tr_b16 v[188:189], v248 offset:4096
    v_mfma_f32_16x16x32_bf16 v[140:143], v[184:187], v[76:79], v[140:143]
    ds_read_b128 v[92:95], v255 offset:18432
    ds_read_b64_tr_b16 v[190:191], v248 offset:4608
    s_waitcnt lgkmcnt(12)
    v_mfma_f32_16x16x32_bf16 v[144:147], v[192:195], v[72:75], v[144:147]
    ds_read_b64_tr_b16 v[184:185], v248 offset:0
    v_mfma_f32_16x16x32_bf16 v[144:147], v[196:199], v[80:83], v[144:147]
    ds_read_b128 v[96:99], v255 offset:16448
    ds_read_b64_tr_b16 v[186:187], v248 offset:512
    v_mfma_f32_16x16x32_bf16 v[148:151], v[196:199], v[84:87], v[148:151]
    ds_read_b64_tr_b16 v[196:197], v249 offset:4096
    v_mfma_f32_16x16x32_bf16 v[148:151], v[192:195], v[76:79], v[148:151]
    ds_read_b128 v[100:103], v255 offset:18496
    ds_read_b64_tr_b16 v[198:199], v249 offset:4608
    s_waitcnt lgkmcnt(14)
    v_mfma_f32_16x16x32_bf16 v[152:155], v[200:203], v[72:75], v[152:155]
    ds_read_b64_tr_b16 v[192:193], v249 offset:0
    v_mfma_f32_16x16x32_bf16 v[152:155], v[204:207], v[80:83], v[152:155]
    ds_read_b64_tr_b16 v[194:195], v249 offset:512
    v_mfma_f32_16x16x32_bf16 v[156:159], v[204:207], v[84:87], v[156:159]
    ds_read_b64_tr_b16 v[204:205], v250 offset:4096
    v_mfma_f32_16x16x32_bf16 v[156:159], v[200:203], v[76:79], v[156:159]
    ds_read_b64_tr_b16 v[206:207], v250 offset:4608
    s_waitcnt lgkmcnt(14)
    v_mfma_f32_16x16x32_bf16 v[160:163], v[208:211], v[72:75], v[160:163]
    ds_read_b64_tr_b16 v[200:201], v250 offset:0
    v_mfma_f32_16x16x32_bf16 v[160:163], v[212:215], v[80:83], v[160:163]
    ds_read_b64_tr_b16 v[202:203], v250 offset:512
    v_mfma_f32_16x16x32_bf16 v[164:167], v[212:215], v[84:87], v[164:167]
    ds_read_b64_tr_b16 v[212:213], v251 offset:4096
    v_mfma_f32_16x16x32_bf16 v[164:167], v[208:211], v[76:79], v[164:167]
    ds_read_b64_tr_b16 v[214:215], v251 offset:4608
    s_waitcnt lgkmcnt(11)
    v_mfma_f32_16x16x32_bf16 v[168:171], v[184:187], v[88:91], v[168:171]
    ds_read_b64_tr_b16 v[208:209], v251 offset:0
    v_mfma_f32_16x16x32_bf16 v[168:171], v[188:191], v[96:99], v[168:171]
    ds_read_b64_tr_b16 v[210:211], v251 offset:512
    s_waitcnt lgkmcnt(11)
    v_mfma_f32_16x16x32_bf16 v[172:175], v[188:191], v[100:103], v[172:175]
    ds_read_b64_tr_b16 v[188:189], v248 offset:12288
    v_mfma_f32_16x16x32_bf16 v[172:175], v[184:187], v[92:95], v[172:175]
    ds_read_b64_tr_b16 v[190:191], v248 offset:12800
    s_waitcnt lgkmcnt(10)
    v_mfma_f32_16x16x32_bf16 v[176:179], v[192:195], v[88:91], v[176:179]
    ds_read_b64_tr_b16 v[184:185], v248 offset:8192
    v_mfma_f32_16x16x32_bf16 v[176:179], v[196:199], v[96:99], v[176:179]
    ds_read_b64_tr_b16 v[186:187], v248 offset:8704
    v_mfma_f32_16x16x32_bf16 v[180:183], v[196:199], v[100:103], v[180:183]
    ds_read_b64_tr_b16 v[196:197], v249 offset:12288
    v_mfma_f32_16x16x32_bf16 v[180:183], v[192:195], v[92:95], v[180:183]
    ds_read_b64_tr_b16 v[198:199], v249 offset:12800
    s_waitcnt lgkmcnt(10)
    v_mfma_f32_16x16x32_bf16 v[216:219], v[200:203], v[88:91], v[216:219]
    ds_read_b64_tr_b16 v[192:193], v249 offset:8192
    v_mfma_f32_16x16x32_bf16 v[216:219], v[204:207], v[96:99], v[216:219]
    ds_read_b64_tr_b16 v[194:195], v249 offset:8704
    v_mfma_f32_16x16x32_bf16 v[220:223], v[204:207], v[100:103], v[220:223]
    ds_read_b64_tr_b16 v[204:205], v250 offset:12288
    v_mfma_f32_16x16x32_bf16 v[220:223], v[200:203], v[92:95], v[220:223]
    ds_read_b64_tr_b16 v[206:207], v250 offset:12800
    s_waitcnt lgkmcnt(10)
    v_mfma_f32_16x16x32_bf16 v[224:227], v[208:211], v[88:91], v[224:227]
    ds_read_b64_tr_b16 v[200:201], v250 offset:8192
    v_mfma_f32_16x16x32_bf16 v[224:227], v[212:215], v[96:99], v[224:227]
    ds_read_b64_tr_b16 v[202:203], v250 offset:8704
    v_mfma_f32_16x16x32_bf16 v[228:231], v[212:215], v[100:103], v[228:231]
    ds_read_b64_tr_b16 v[212:213], v251 offset:12288
    v_mfma_f32_16x16x32_bf16 v[228:231], v[208:211], v[92:95], v[228:231]
    ds_read_b64_tr_b16 v[214:215], v251 offset:12800
    s_waitcnt lgkmcnt(10)
    v_mfma_f32_16x16x32_bf16 v[136:139], v[184:187], v[88:91], v[136:139]
    ds_read_b64_tr_b16 v[208:209], v251 offset:8192
    v_mfma_f32_16x16x32_bf16 v[136:139], v[188:191], v[96:99], v[136:139]
    ds_read_b64_tr_b16 v[210:211], v251 offset:8704
    s_barrier
    ds_read_b128 v[104:107], v253 offset:49152
    v_mfma_f32_16x16x32_bf16 v[140:143], v[188:191], v[100:103], v[140:143]
    ds_read_b64_tr_b16 v[188:189], v236 offset:36864
    v_mfma_f32_16x16x32_bf16 v[140:143], v[184:187], v[92:95], v[140:143]
    ds_read_b128 v[108:111], v253 offset:51200
    ds_read_b64_tr_b16 v[190:191], v236 offset:37376
    s_waitcnt lgkmcnt(12)
    v_mfma_f32_16x16x32_bf16 v[144:147], v[192:195], v[88:91], v[144:147]
    ds_read_b64_tr_b16 v[184:185], v236 offset:32768
    v_mfma_f32_16x16x32_bf16 v[144:147], v[196:199], v[96:99], v[144:147]
    ds_read_b128 v[112:115], v253 offset:49216
    ds_read_b64_tr_b16 v[186:187], v236 offset:33280
    v_mfma_f32_16x16x32_bf16 v[148:151], v[196:199], v[100:103], v[148:151]
    ds_read_b64_tr_b16 v[196:197], v237 offset:36864
    v_mfma_f32_16x16x32_bf16 v[148:151], v[192:195], v[92:95], v[148:151]
    ds_read_b128 v[116:119], v253 offset:51264
    ds_read_b64_tr_b16 v[198:199], v237 offset:37376
    s_waitcnt lgkmcnt(14)
    v_mfma_f32_16x16x32_bf16 v[152:155], v[200:203], v[88:91], v[152:155]
    ds_read_b64_tr_b16 v[192:193], v237 offset:32768
    v_mfma_f32_16x16x32_bf16 v[152:155], v[204:207], v[96:99], v[152:155]
    ds_read_b64_tr_b16 v[194:195], v237 offset:33280
    v_mfma_f32_16x16x32_bf16 v[156:159], v[204:207], v[100:103], v[156:159]
    ds_read_b64_tr_b16 v[204:205], v238 offset:36864
    v_mfma_f32_16x16x32_bf16 v[156:159], v[200:203], v[92:95], v[156:159]
    ds_read_b64_tr_b16 v[206:207], v238 offset:37376
    s_waitcnt lgkmcnt(14)
    v_mfma_f32_16x16x32_bf16 v[160:163], v[208:211], v[88:91], v[160:163]
    ds_read_b64_tr_b16 v[200:201], v238 offset:32768
    v_mfma_f32_16x16x32_bf16 v[160:163], v[212:215], v[96:99], v[160:163]
    ds_read_b64_tr_b16 v[202:203], v238 offset:33280
    v_mfma_f32_16x16x32_bf16 v[164:167], v[212:215], v[100:103], v[164:167]
    ds_read_b64_tr_b16 v[212:213], v239 offset:36864
    v_mfma_f32_16x16x32_bf16 v[164:167], v[208:211], v[92:95], v[164:167]
    ds_read_b64_tr_b16 v[214:215], v239 offset:37376
    s_waitcnt lgkmcnt(11)
    v_mfma_f32_16x16x32_bf16 v[168:171], v[184:187], v[104:107], v[168:171]
    ds_read_b64_tr_b16 v[208:209], v239 offset:32768
    v_mfma_f32_16x16x32_bf16 v[168:171], v[188:191], v[112:115], v[168:171]
    ds_read_b64_tr_b16 v[210:211], v239 offset:33280
    s_waitcnt lgkmcnt(11)
    v_mfma_f32_16x16x32_bf16 v[172:175], v[188:191], v[116:119], v[172:175]
    ds_read_b64_tr_b16 v[188:189], v236 offset:45056
    v_mfma_f32_16x16x32_bf16 v[172:175], v[184:187], v[108:111], v[172:175]
    ds_read_b64_tr_b16 v[190:191], v236 offset:45568
    s_waitcnt lgkmcnt(10)
    v_mfma_f32_16x16x32_bf16 v[176:179], v[192:195], v[104:107], v[176:179]
    ds_read_b64_tr_b16 v[184:185], v236 offset:40960
    v_mfma_f32_16x16x32_bf16 v[176:179], v[196:199], v[112:115], v[176:179]
    ds_read_b64_tr_b16 v[186:187], v236 offset:41472
    v_mfma_f32_16x16x32_bf16 v[180:183], v[196:199], v[116:119], v[180:183]
    ds_read_b64_tr_b16 v[196:197], v237 offset:45056
    v_mfma_f32_16x16x32_bf16 v[180:183], v[192:195], v[108:111], v[180:183]
    ds_read_b64_tr_b16 v[198:199], v237 offset:45568
    s_waitcnt lgkmcnt(10)
    v_mfma_f32_16x16x32_bf16 v[216:219], v[200:203], v[104:107], v[216:219]
    ds_read_b64_tr_b16 v[192:193], v237 offset:40960
    v_mfma_f32_16x16x32_bf16 v[216:219], v[204:207], v[112:115], v[216:219]
    ds_read_b64_tr_b16 v[194:195], v237 offset:41472
    v_mfma_f32_16x16x32_bf16 v[220:223], v[204:207], v[116:119], v[220:223]
    ds_read_b64_tr_b16 v[204:205], v238 offset:45056
    v_mfma_f32_16x16x32_bf16 v[220:223], v[200:203], v[108:111], v[220:223]
    ds_read_b64_tr_b16 v[206:207], v238 offset:45568
    s_waitcnt lgkmcnt(10)
    v_mfma_f32_16x16x32_bf16 v[224:227], v[208:211], v[104:107], v[224:227]
    ds_read_b64_tr_b16 v[200:201], v238 offset:40960
    v_mfma_f32_16x16x32_bf16 v[224:227], v[212:215], v[112:115], v[224:227]
    ds_read_b64_tr_b16 v[202:203], v238 offset:41472
    v_mfma_f32_16x16x32_bf16 v[228:231], v[212:215], v[116:119], v[228:231]
    ds_read_b64_tr_b16 v[212:213], v239 offset:45056
    v_mfma_f32_16x16x32_bf16 v[228:231], v[208:211], v[108:111], v[228:231]
    ds_read_b64_tr_b16 v[214:215], v239 offset:45568
    s_waitcnt lgkmcnt(10)
    v_mfma_f32_16x16x32_bf16 v[136:139], v[184:187], v[104:107], v[136:139]
    ds_read_b64_tr_b16 v[208:209], v239 offset:40960
    v_mfma_f32_16x16x32_bf16 v[136:139], v[188:191], v[112:115], v[136:139]
    ds_read_b64_tr_b16 v[210:211], v239 offset:41472
    s_barrier
    ds_read_b128 v[120:123], v254 offset:49152
    v_mfma_f32_16x16x32_bf16 v[140:143], v[188:191], v[116:119], v[140:143]
    ds_read_b64_tr_b16 v[188:189], v232 offset:36864
    v_mfma_f32_16x16x32_bf16 v[140:143], v[184:187], v[108:111], v[140:143]
    ds_read_b128 v[124:127], v254 offset:51200
    ds_read_b64_tr_b16 v[190:191], v232 offset:37376
    s_waitcnt lgkmcnt(12)
    v_mfma_f32_16x16x32_bf16 v[144:147], v[192:195], v[104:107], v[144:147]
    ds_read_b64_tr_b16 v[184:185], v232 offset:32768
    v_mfma_f32_16x16x32_bf16 v[144:147], v[196:199], v[112:115], v[144:147]
    ds_read_b128 v[128:131], v254 offset:49216
    ds_read_b64_tr_b16 v[186:187], v232 offset:33280
    v_mfma_f32_16x16x32_bf16 v[148:151], v[196:199], v[116:119], v[148:151]
    ds_read_b64_tr_b16 v[196:197], v233 offset:36864
    v_mfma_f32_16x16x32_bf16 v[148:151], v[192:195], v[108:111], v[148:151]
    ds_read_b128 v[132:135], v254 offset:51264
    ds_read_b64_tr_b16 v[198:199], v233 offset:37376
    s_waitcnt lgkmcnt(14)
    v_mfma_f32_16x16x32_bf16 v[152:155], v[200:203], v[104:107], v[152:155]
    ds_read_b64_tr_b16 v[192:193], v233 offset:32768
    v_mfma_f32_16x16x32_bf16 v[152:155], v[204:207], v[112:115], v[152:155]
    ds_read_b64_tr_b16 v[194:195], v233 offset:33280
    v_mfma_f32_16x16x32_bf16 v[156:159], v[204:207], v[116:119], v[156:159]
    ds_read_b64_tr_b16 v[204:205], v234 offset:36864
    v_mfma_f32_16x16x32_bf16 v[156:159], v[200:203], v[108:111], v[156:159]
    ds_read_b64_tr_b16 v[206:207], v234 offset:37376
    s_waitcnt lgkmcnt(14)
    v_mfma_f32_16x16x32_bf16 v[160:163], v[208:211], v[104:107], v[160:163]
    ds_read_b64_tr_b16 v[200:201], v234 offset:32768
    v_mfma_f32_16x16x32_bf16 v[160:163], v[212:215], v[112:115], v[160:163]
    ds_read_b64_tr_b16 v[202:203], v234 offset:33280
    v_mfma_f32_16x16x32_bf16 v[164:167], v[212:215], v[116:119], v[164:167]
    ds_read_b64_tr_b16 v[212:213], v235 offset:36864
    v_mfma_f32_16x16x32_bf16 v[164:167], v[208:211], v[108:111], v[164:167]
    ds_read_b64_tr_b16 v[214:215], v235 offset:37376
    s_waitcnt lgkmcnt(11)
    v_mfma_f32_16x16x32_bf16 v[168:171], v[184:187], v[120:123], v[168:171]
    ds_read_b64_tr_b16 v[208:209], v235 offset:32768
    v_mfma_f32_16x16x32_bf16 v[168:171], v[188:191], v[128:131], v[168:171]
    ds_read_b64_tr_b16 v[210:211], v235 offset:33280
    s_waitcnt lgkmcnt(11)
    v_mfma_f32_16x16x32_bf16 v[172:175], v[188:191], v[132:135], v[172:175]
    ds_read_b64_tr_b16 v[188:189], v232 offset:45056
    v_mfma_f32_16x16x32_bf16 v[172:175], v[184:187], v[124:127], v[172:175]
    ds_read_b64_tr_b16 v[190:191], v232 offset:45568
    s_waitcnt lgkmcnt(10)
    v_mfma_f32_16x16x32_bf16 v[176:179], v[192:195], v[120:123], v[176:179]
    ds_read_b64_tr_b16 v[184:185], v232 offset:40960
    v_mfma_f32_16x16x32_bf16 v[176:179], v[196:199], v[128:131], v[176:179]
    ds_read_b64_tr_b16 v[186:187], v232 offset:41472
    v_mfma_f32_16x16x32_bf16 v[180:183], v[196:199], v[132:135], v[180:183]
    ds_read_b64_tr_b16 v[196:197], v233 offset:45056
    v_mfma_f32_16x16x32_bf16 v[180:183], v[192:195], v[124:127], v[180:183]
    ds_read_b64_tr_b16 v[198:199], v233 offset:45568
    s_waitcnt lgkmcnt(10)
    v_mfma_f32_16x16x32_bf16 v[216:219], v[200:203], v[120:123], v[216:219]
    ds_read_b64_tr_b16 v[192:193], v233 offset:40960
    v_mfma_f32_16x16x32_bf16 v[216:219], v[204:207], v[128:131], v[216:219]
    ds_read_b64_tr_b16 v[194:195], v233 offset:41472
    v_mfma_f32_16x16x32_bf16 v[220:223], v[204:207], v[132:135], v[220:223]
    ds_read_b64_tr_b16 v[204:205], v234 offset:45056
    v_mfma_f32_16x16x32_bf16 v[220:223], v[200:203], v[124:127], v[220:223]
    ds_read_b64_tr_b16 v[206:207], v234 offset:45568
    s_waitcnt lgkmcnt(10)
    v_mfma_f32_16x16x32_bf16 v[224:227], v[208:211], v[120:123], v[224:227]
    ds_read_b64_tr_b16 v[200:201], v234 offset:40960
    v_mfma_f32_16x16x32_bf16 v[224:227], v[212:215], v[128:131], v[224:227]
    ds_read_b64_tr_b16 v[202:203], v234 offset:41472
    v_mfma_f32_16x16x32_bf16 v[228:231], v[212:215], v[132:135], v[228:231]
    ds_read_b64_tr_b16 v[212:213], v235 offset:45056
    v_mfma_f32_16x16x32_bf16 v[228:231], v[208:211], v[124:127], v[228:231]
    ds_read_b64_tr_b16 v[214:215], v235 offset:45568
    s_waitcnt lgkmcnt(10)
    v_mfma_f32_16x16x32_bf16 v[136:139], v[184:187], v[120:123], v[136:139]
    ds_read_b64_tr_b16 v[208:209], v235 offset:40960
    v_mfma_f32_16x16x32_bf16 v[136:139], v[188:191], v[128:131], v[136:139]
    ds_read_b64_tr_b16 v[210:211], v235 offset:41472
    s_barrier
    v_mfma_f32_16x16x32_bf16 v[140:143], v[188:191], v[132:135], v[140:143]
    ds_read_b64_tr_b16 v[188:189], v232 offset:4096
    v_mul_f32 v168, s40, v168
    v_mul_f32 v169, s40, v169
    v_mul_f32 v170, s40, v170
    v_mul_f32 v171, s40, v171
    v_mfma_f32_16x16x32_bf16 v[140:143], v[184:187], v[124:127], v[140:143]
    ds_read_b64_tr_b16 v[190:191], v232 offset:4608
    v_cvt_pk_bf16_f32 v168, v168, v169
    v_cvt_pk_bf16_f32 v169, v170, v171
    v_mul_f32 v172, s40, v172
    v_mul_f32 v173, s40, v173
    s_waitcnt lgkmcnt(10)
    v_mfma_f32_16x16x32_bf16 v[144:147], v[192:195], v[120:123], v[144:147]
    ds_read_b64_tr_b16 v[184:185], v232 offset:0
    v_mul_f32 v174, s40, v174
    v_mul_f32 v175, s40, v175
    v_cvt_pk_bf16_f32 v170, v172, v173
    v_cvt_pk_bf16_f32 v171, v174, v175
    v_mfma_f32_16x16x32_bf16 v[144:147], v[196:199], v[128:131], v[144:147]
    ds_read_b64_tr_b16 v[186:187], v232 offset:512
    v_mul_f32 v176, s40, v176
    v_mul_f32 v177, s40, v177
    v_mul_f32 v178, s40, v178
    v_mul_f32 v179, s40, v179
    v_mfma_f32_16x16x32_bf16 v[148:151], v[196:199], v[132:135], v[148:151]
    ds_read_b64_tr_b16 v[196:197], v233 offset:4096
    v_cvt_pk_bf16_f32 v172, v176, v177
    v_cvt_pk_bf16_f32 v173, v178, v179
    v_mul_f32 v180, s40, v180
    v_mul_f32 v181, s40, v181
    v_mfma_f32_16x16x32_bf16 v[148:151], v[192:195], v[124:127], v[148:151]
    ds_read_b64_tr_b16 v[198:199], v233 offset:4608
    v_mul_f32 v182, s40, v182
    v_mul_f32 v183, s40, v183
    v_cvt_pk_bf16_f32 v174, v180, v181
    v_cvt_pk_bf16_f32 v175, v182, v183
    s_waitcnt lgkmcnt(10)
    v_mfma_f32_16x16x32_bf16 v[152:155], v[200:203], v[120:123], v[152:155]
    ds_read_b64_tr_b16 v[192:193], v233 offset:0
    v_mul_f32 v216, s40, v216
    v_mul_f32 v217, s40, v217
    v_mul_f32 v218, s40, v218
    v_mul_f32 v219, s40, v219
    v_mfma_f32_16x16x32_bf16 v[152:155], v[204:207], v[128:131], v[152:155]
    ds_read_b64_tr_b16 v[194:195], v233 offset:512
    v_cvt_pk_bf16_f32 v176, v216, v217
    v_cvt_pk_bf16_f32 v177, v218, v219
    v_mul_f32 v220, s40, v220
    v_mul_f32 v221, s40, v221
    v_mfma_f32_16x16x32_bf16 v[156:159], v[204:207], v[132:135], v[156:159]
    ds_read_b64_tr_b16 v[204:205], v234 offset:4096
    v_mul_f32 v222, s40, v222
    v_mul_f32 v223, s40, v223
    v_cvt_pk_bf16_f32 v178, v220, v221
    v_cvt_pk_bf16_f32 v179, v222, v223
    v_mfma_f32_16x16x32_bf16 v[156:159], v[200:203], v[124:127], v[156:159]
    ds_read_b64_tr_b16 v[206:207], v234 offset:4608
    v_mul_f32 v224, s40, v224
    v_mul_f32 v225, s40, v225
    v_mul_f32 v226, s40, v226
    v_mul_f32 v227, s40, v227
    s_waitcnt lgkmcnt(10)
    v_mfma_f32_16x16x32_bf16 v[160:163], v[208:211], v[120:123], v[160:163]
    ds_read_b64_tr_b16 v[200:201], v234 offset:0
    v_cvt_pk_bf16_f32 v180, v224, v225
    v_cvt_pk_bf16_f32 v181, v226, v227
    v_mul_f32 v228, s40, v228
    v_mul_f32 v229, s40, v229
    v_mfma_f32_16x16x32_bf16 v[160:163], v[212:215], v[128:131], v[160:163]
    ds_read_b64_tr_b16 v[202:203], v234 offset:512
    v_mul_f32 v230, s40, v230
    v_mul_f32 v231, s40, v231
    v_cvt_pk_bf16_f32 v182, v228, v229
    v_cvt_pk_bf16_f32 v183, v230, v231
    v_mfma_f32_16x16x32_bf16 v[164:167], v[212:215], v[132:135], v[164:167]
    ds_read_b64_tr_b16 v[212:213], v235 offset:4096
    ds_write_b64 v246, v[168:169] offset:0
    ds_write_b64 v246, v[170:171] offset:1024
    ds_write_b64 v246, v[172:173] offset:512
    ds_write_b64 v246, v[174:175] offset:1536
    v_mfma_f32_16x16x32_bf16 v[164:167], v[208:211], v[124:127], v[164:167]
    ds_read_b64_tr_b16 v[214:215], v235 offset:4608
    ds_write_b64 v246, v[176:177] offset:2048
    ds_write_b64 v246, v[178:179] offset:3072
    ds_write_b64 v246, v[180:181] offset:2560
    ds_write_b64 v246, v[182:183] offset:3584
    ds_read_b64_tr_b16 v[208:209], v235 offset:0
    ds_read_b64_tr_b16 v[210:211], v235 offset:512
    v_mul_f32 v136, s40, v136
    v_mul_f32 v137, s40, v137
    v_mul_f32 v138, s40, v138
    v_mul_f32 v139, s40, v139
    v_cvt_pk_bf16_f32 v216, v136, v137
    v_cvt_pk_bf16_f32 v217, v138, v139
    ds_write_b64 v246, v[216:217] offset:4096
    v_mul_f32 v140, s40, v140
    v_mul_f32 v141, s40, v141
    v_mul_f32 v142, s40, v142
    v_mul_f32 v143, s40, v143
    v_cvt_pk_bf16_f32 v218, v140, v141
    v_cvt_pk_bf16_f32 v219, v142, v143
    ds_write_b64 v246, v[218:219] offset:5120
    v_mul_f32 v144, s40, v144
    v_mul_f32 v145, s40, v145
    v_mul_f32 v146, s40, v146
    v_mul_f32 v147, s40, v147
    v_cvt_pk_bf16_f32 v220, v144, v145
    v_cvt_pk_bf16_f32 v221, v146, v147
    ds_write_b64 v246, v[220:221] offset:4608
    v_mul_f32 v148, s40, v148
    v_mul_f32 v149, s40, v149
    v_mul_f32 v150, s40, v150
    v_mul_f32 v151, s40, v151
    v_cvt_pk_bf16_f32 v222, v148, v149
    v_cvt_pk_bf16_f32 v223, v150, v151
    ds_write_b64 v246, v[222:223] offset:5632
    v_mul_f32 v152, s40, v152
    v_mul_f32 v153, s40, v153
    v_mul_f32 v154, s40, v154
    v_mul_f32 v155, s40, v155
    v_cvt_pk_bf16_f32 v224, v152, v153
    v_cvt_pk_bf16_f32 v225, v154, v155
    ds_write_b64 v246, v[224:225] offset:6144
    v_mul_f32 v156, s40, v156
    v_mul_f32 v157, s40, v157
    v_mul_f32 v158, s40, v158
    v_mul_f32 v159, s40, v159
    v_cvt_pk_bf16_f32 v226, v156, v157
    v_cvt_pk_bf16_f32 v227, v158, v159
    ds_write_b64 v246, v[226:227] offset:7168
    v_mul_f32 v160, s40, v160
    v_mul_f32 v161, s40, v161
    v_mul_f32 v162, s40, v162
    v_mul_f32 v163, s40, v163
    v_cvt_pk_bf16_f32 v228, v160, v161
    v_cvt_pk_bf16_f32 v229, v162, v163
    ds_write_b64 v246, v[228:229] offset:6656
    v_mul_f32 v164, s40, v164
    v_mul_f32 v165, s40, v165
    v_mul_f32 v166, s40, v166
    v_mul_f32 v167, s40, v167
    v_cvt_pk_bf16_f32 v230, v164, v165
    v_cvt_pk_bf16_f32 v231, v166, v167
    ds_write_b64 v246, v[230:231] offset:7680
    s_waitcnt lgkmcnt(0)
    s_barrier
    v_lshlrev_b32 v247, 7, v0
    s_branch L_Pgo
L_Ploop:
    s_cmp_lg_u32 s38, s85
    s_cbranch_scc1 L_nohs
    v_mov_b32 v5, 1
    buffer_atomic_add v5, v252, s[76:79], 0 offen sc1
L_nohs:
    s_add_u32 s56, s37, 4
    s_cmp_lg_u32 s38, s56
    s_cbranch_scc1 L_nowopf
    s_lshl_b32 s56, s7, 15
    s_lshl_b32 s57, s37, 13
    s_add_u32 s56, s56, s57
    buffer_load_dword v240, v247, s[20:23], s56 offen
L_nowopf:
    s_lshl_b32 s56, s37, 4
    s_add_u32 s56, s56, s38
    s_cmp_lg_u32 s56, 7
    s_cbranch_scc1 L_nocpf
    s_bfe_u32 s56, s2, 0x30003
    s_lshl_b32 s56, s56, 13
    s_min_u32 s56, s56, L_cold-concat_heads__mha_block_cached__mha_block_cached__near_ridge_kernel-8192
    v_add_u32 v5, s56, v247
    global_load_dword v241, v5, s[70:71]
L_nocpf:
    ds_read_b64_tr_b16 v[188:189], v232 offset:4096
    s_cmp_lt_u32 s29, 30
    s_cselect_b32 s55, s42, 1073741824
    s_cselect_b32 s47, s45, 196608
    s_xor_b32 s55, s55, s4
    s_add_u32 s29, s29, 1
    s_add_u32 s42, s42, 16384
    s_and_b32 s42, s42, 0x7ffff
    s_add_u32 m0, s47, 49152
    s_nop 0
    buffer_load_dwordx4 v243, s[12:15], s55 offen nt lds
    v_mfma_f32_16x16x32_bf16 v[148:151], v[196:199], v[132:135], v[148:151]
    ds_read_b64_tr_b16 v[190:191], v232 offset:4608
    s_add_u32 m0, s47, 52224
    s_nop 0
    buffer_load_dwordx4 v243, s[12:15], s55 offen offset:1024 nt lds
    v_mfma_f32_16x16x32_bf16 v[148:151], v[192:195], v[124:127], v[148:151]
    ds_read_b64_tr_b16 v[184:185], v232 offset:0
    s_add_u32 m0, s47, 55296
    s_nop 0
    buffer_load_dwordx4 v243, s[12:15], s55 offen offset:2048 nt lds
    v_mfma_f32_16x16x32_bf16 v[152:155], v[200:203], v[120:123], v[152:155]
    ds_read_b64_tr_b16 v[186:187], v232 offset:512
    s_add_u32 m0, s47, 58368
    s_nop 0
    buffer_load_dwordx4 v243, s[12:15], s55 offen offset:3072 nt lds
    v_mfma_f32_16x16x32_bf16 v[152:155], v[204:207], v[128:131], v[152:155]
    ds_read_b64_tr_b16 v[196:197], v233 offset:4096
    s_add_u32 m0, s46, 24576
    s_add_u32 s44, s43, 1572864
    v_mfma_f32_16x16x32_bf16 v[156:159], v[204:207], v[132:135], v[156:159]
    ds_read_b64_tr_b16 v[198:199], v233 offset:4608
    s_and_b32 s44, s44, 0x403fffff
    v_mfma_f32_16x16x32_bf16 v[156:159], v[200:203], v[124:127], v[156:159]
    ds_read_b64_tr_b16 v[192:193], v233 offset:0
    buffer_load_dwordx4 v244, s[16:19], s44 offen lds
    v_mfma_f32_16x16x32_bf16 v[160:163], v[208:211], v[120:123], v[160:163]
    ds_read_b64_tr_b16 v[194:195], v233 offset:512
    s_add_u32 m0, s46, 28672
    s_add_u32 s44, s43, 1835008
    v_mfma_f32_16x16x32_bf16 v[160:163], v[212:215], v[128:131], v[160:163]
    ds_read_b64_tr_b16 v[204:205], v234 offset:4096
    s_and_b32 s44, s44, 0x403fffff
    v_mfma_f32_16x16x32_bf16 v[164:167], v[212:215], v[132:135], v[164:167]
    ds_read_b64_tr_b16 v[206:207], v234 offset:4608
    buffer_load_dwordx4 v244, s[16:19], s44 offen lds
    v_mfma_f32_16x16x32_bf16 v[164:167], v[208:211], v[124:127], v[164:167]
    ds_read_b64_tr_b16 v[200:201], v234 offset:0
    ds_read_b64_tr_b16 v[202:203], v234 offset:512
    ds_read_b64_tr_b16 v[212:213], v235 offset:4096
    ds_read_b64_tr_b16 v[214:215], v235 offset:4608
    ds_read_b64_tr_b16 v[208:209], v235 offset:0
    ds_read_b64_tr_b16 v[210:211], v235 offset:512
    s_bitcmp1_b32 s38, 0
    s_cbranch_scc0 L_Pwr
    s_nop 1
    v_mul_f32 v136, s40, v136
    v_mul_f32 v137, s40, v137
    v_mul_f32 v138, s40, v138
    v_mul_f32 v139, s40, v139
    v_cvt_pk_bf16_f32 v168, v136, v137
    v_cvt_pk_bf16_f32 v169, v138, v139
    v_mul_f32 v140, s40, v140
    v_mul_f32 v141, s40, v141
    v_mul_f32 v142, s40, v142
    v_mul_f32 v143, s40, v143
    v_cvt_pk_bf16_f32 v170, v140, v141
    v_cvt_pk_bf16_f32 v171, v142, v143
    v_mul_f32 v144, s40, v144
    v_mul_f32 v145, s40, v145
    v_mul_f32 v146, s40, v146
    v_mul_f32 v147, s40, v147
    v_cvt_pk_bf16_f32 v172, v144, v145
    v_cvt_pk_bf16_f32 v173, v146, v147
    v_mul_f32 v148, s40, v148
    v_mul_f32 v149, s40, v149
    v_mul_f32 v150, s40, v150
    v_mul_f32 v151, s40, v151
    v_cvt_pk_bf16_f32 v174, v148, v149
    v_cvt_pk_bf16_f32 v175, v150, v151
    v_mul_f32 v152, s40, v152
    v_mul_f32 v153, s40, v153
    v_mul_f32 v154, s40, v154
    v_mul_f32 v155, s40, v155
    v_cvt_pk_bf16_f32 v176, v152, v153
    v_cvt_pk_bf16_f32 v177, v154, v155
    v_mul_f32 v156, s40, v156
    v_mul_f32 v157, s40, v157
    v_mul_f32 v158, s40, v158
    v_mul_f32 v159, s40, v159
    v_cvt_pk_bf16_f32 v178, v156, v157
    v_cvt_pk_bf16_f32 v179, v158, v159
    v_mul_f32 v160, s40, v160
    v_mul_f32 v161, s40, v161
    v_mul_f32 v162, s40, v162
    v_mul_f32 v163, s40, v163
    v_cvt_pk_bf16_f32 v180, v160, v161
    v_cvt_pk_bf16_f32 v181, v162, v163
    v_mul_f32 v164, s40, v164
    v_mul_f32 v165, s40, v165
    v_mul_f32 v166, s40, v166
    v_mul_f32 v167, s40, v167
    v_cvt_pk_bf16_f32 v182, v164, v165
    v_cvt_pk_bf16_f32 v183, v166, v167
    s_waitcnt lgkmcnt(0)
    s_branch L_Pgo
L_Pwr:
    ds_write_b64 v246, v[168:169] offset:0
    ds_write_b64 v246, v[170:171] offset:1024
    ds_write_b64 v246, v[172:173] offset:512
    ds_write_b64 v246, v[174:175] offset:1536
    ds_write_b64 v246, v[176:177] offset:2048
    ds_write_b64 v246, v[178:179] offset:3072
    ds_write_b64 v246, v[180:181] offset:2560
    ds_write_b64 v246, v[182:183] offset:3584
    v_mul_f32 v136, s40, v136
    v_mul_f32 v137, s40, v137
    v_mul_f32 v138, s40, v138
    v_mul_f32 v139, s40, v139
    v_cvt_pk_bf16_f32 v216, v136, v137
    v_cvt_pk_bf16_f32 v217, v138, v139
    v_mul_f32 v140, s40, v140
    v_mul_f32 v141, s40, v141
    v_mul_f32 v142, s40, v142
    v_mul_f32 v143, s40, v143
    v_cvt_pk_bf16_f32 v218, v140, v141
    v_cvt_pk_bf16_f32 v219, v142, v143
    ds_write_b64 v246, v[216:217] offset:4096
    v_mul_f32 v144, s40, v144
    v_mul_f32 v145, s40, v145
    v_mul_f32 v146, s40, v146
    v_mul_f32 v147, s40, v147
    v_cvt_pk_bf16_f32 v220, v144, v145
    v_cvt_pk_bf16_f32 v221, v146, v147
    ds_write_b64 v246, v[218:219] offset:5120
    v_mul_f32 v148, s40, v148
    v_mul_f32 v149, s40, v149
    v_mul_f32 v150, s40, v150
    v_mul_f32 v151, s40, v151
    v_cvt_pk_bf16_f32 v222, v148, v149
    v_cvt_pk_bf16_f32 v223, v150, v151
    ds_write_b64 v246, v[220:221] offset:4608
    v_mul_f32 v152, s40, v152
    v_mul_f32 v153, s40, v153
    v_mul_f32 v154, s40, v154
    v_mul_f32 v155, s40, v155
    v_cvt_pk_bf16_f32 v224, v152, v153
    v_cvt_pk_bf16_f32 v225, v154, v155
    ds_write_b64 v246, v[222:223] offset:5632
    v_mul_f32 v156, s40, v156
    v_mul_f32 v157, s40, v157
    v_mul_f32 v158, s40, v158
    v_mul_f32 v159, s40, v159
    v_cvt_pk_bf16_f32 v226, v156, v157
    v_cvt_pk_bf16_f32 v227, v158, v159
    ds_write_b64 v246, v[224:225] offset:6144
    v_mul_f32 v160, s40, v160
    v_mul_f32 v161, s40, v161
    v_mul_f32 v162, s40, v162
    v_mul_f32 v163, s40, v163
    v_cvt_pk_bf16_f32 v228, v160, v161
    v_cvt_pk_bf16_f32 v229, v162, v163
    ds_write_b64 v246, v[226:227] offset:7168
    v_mul_f32 v164, s40, v164
    v_mul_f32 v165, s40, v165
    v_mul_f32 v166, s40, v166
    v_mul_f32 v167, s40, v167
    v_cvt_pk_bf16_f32 v230, v164, v165
    v_cvt_pk_bf16_f32 v231, v166, v167
    ds_write_b64 v246, v[228:229] offset:6656
    ds_write_b64 v246, v[230:231] offset:7680
    s_waitcnt lgkmcnt(0)
L_Pgo:
    v_mfma_f32_16x16x32_bf16 v[136:139], v[184:187], v[8:11], 0
    v_mfma_f32_16x16x32_bf16 v[136:139], v[188:191], v[16:19], v[136:139]
    v_mfma_f32_16x16x32_bf16 v[140:143], v[188:191], v[20:23], 0
    v_mfma_f32_16x16x32_bf16 v[140:143], v[184:187], v[12:15], v[140:143]
    v_mfma_f32_16x16x32_bf16 v[144:147], v[192:195], v[8:11], 0
    v_mfma_f32_16x16x32_bf16 v[144:147], v[196:199], v[16:19], v[144:147]
    s_bitcmp1_b32 0xf8, s38
    s_cbranch_scc0 L_fast0
    s_waitcnt vmcnt(5)
L_fast0:
    s_waitcnt vmcnt(6)
    s_waitcnt lgkmcnt(0)
    s_barrier
    ds_read_b64_tr_b16 v[188:189], v232 offset:12288
    s_cmp_lt_u32 s28, 30
    s_cselect_b32 s54, s41, 1073741824
    s_cselect_b32 s47, s45, 196608
    s_xor_b32 s54, s54, s4
    s_add_u32 s28, s28, 1
    s_add_u32 s41, s41, 16384
    s_and_b32 s41, s41, 0x7ffff
    s_add_u32 m0, s47, 16384
    s_nop 0
    buffer_load_dwordx4 v242, s[8:11], s54 offen nt lds
    v_mfma_f32_16x16x32_bf16 v[148:151], v[196:199], v[20:23], 0
    ds_read_b64_tr_b16 v[190:191], v232 offset:12800
    s_add_u32 m0, s47, 19456
    s_nop 0
    buffer_load_dwordx4 v242, s[8:11], s54 offen offset:1024 nt lds
    v_mfma_f32_16x16x32_bf16 v[148:151], v[192:195], v[12:15], v[148:151]
    ds_read_b64_tr_b16 v[184:185], v232 offset:8192
    s_add_u32 m0, s47, 22528
    s_nop 0
    buffer_load_dwordx4 v242, s[8:11], s54 offen offset:2048 nt lds
    v_mfma_f32_16x16x32_bf16 v[152:155], v[200:203], v[8:11], 0
    ds_read_b64_tr_b16 v[186:187], v232 offset:8704
    s_add_u32 m0, s47, 25600
    s_nop 0
    buffer_load_dwordx4 v242, s[8:11], s54 offen offset:3072 nt lds
    v_mfma_f32_16x16x32_bf16 v[152:155], v[204:207], v[16:19], v[152:155]
    ds_read_b64_tr_b16 v[196:197], v233 offset:12288
    s_add_u32 m0, s46, 0
    s_add_u32 s44, s43, 2097152
    v_mfma_f32_16x16x32_bf16 v[156:159], v[204:207], v[20:23], 0
    ds_read_b64_tr_b16 v[198:199], v233 offset:12800
    s_and_b32 s44, s44, 0x403fffff
    v_mfma_f32_16x16x32_bf16 v[156:159], v[200:203], v[12:15], v[156:159]
    ds_read_b64_tr_b16 v[192:193], v233 offset:8192
    buffer_load_dwordx4 v244, s[16:19], s44 offen lds
    v_mfma_f32_16x16x32_bf16 v[160:163], v[208:211], v[8:11], 0
    ds_read_b64_tr_b16 v[194:195], v233 offset:8704
    s_add_u32 m0, s46, 4096
    s_add_u32 s44, s43, 2359296
    v_mfma_f32_16x16x32_bf16 v[160:163], v[212:215], v[16:19], v[160:163]
    ds_read_b64_tr_b16 v[204:205], v234 offset:12288
    s_and_b32 s44, s44, 0x403fffff
    v_mfma_f32_16x16x32_bf16 v[164:167], v[212:215], v[20:23], 0
    ds_read_b64_tr_b16 v[206:207], v234 offset:12800
    buffer_load_dwordx4 v244, s[16:19], s44 offen lds
    v_mfma_f32_16x16x32_bf16 v[164:167], v[208:211], v[12:15], v[164:167]
    ds_read_b64_tr_b16 v[200:201], v234 offset:8192
    ds_read_b64_tr_b16 v[202:203], v234 offset:8704
    ds_read_b64_tr_b16 v[212:213], v235 offset:12288
    ds_read_b64_tr_b16 v[214:215], v235 offset:12800
    ds_read_b64_tr_b16 v[208:209], v235 offset:8192
    ds_read_b64_tr_b16 v[210:211], v235 offset:8704
    s_waitcnt lgkmcnt(12)
    v_mfma_f32_16x16x32_bf16 v[136:139], v[184:187], v[24:27], v[136:139]
    v_mfma_f32_16x16x32_bf16 v[136:139], v[188:191], v[32:35], v[136:139]
    v_mfma_f32_16x16x32_bf16 v[140:143], v[188:191], v[36:39], v[140:143]
    v_mfma_f32_16x16x32_bf16 v[140:143], v[184:187], v[28:31], v[140:143]
    s_waitcnt lgkmcnt(8)
    v_mfma_f32_16x16x32_bf16 v[144:147], v[192:195], v[24:27], v[144:147]
    v_mfma_f32_16x16x32_bf16 v[144:147], v[196:199], v[32:35], v[144:147]
    s_bitcmp1_b32 0x60, s38
    s_cbranch_scc0 L_fast1
    s_waitcnt vmcnt(5)
L_fast1:
    s_waitcnt vmcnt(6)
    s_waitcnt lgkmcnt(0)
    s_barrier
    ds_read_b64_tr_b16 v[188:189], v232 offset:20480
    s_cmp_lt_u32 s29, 30
    s_cselect_b32 s55, s42, 1073741824
    s_cselect_b32 s47, s45, 196608
    s_xor_b32 s55, s55, s4
    s_add_u32 s29, s29, 1
    s_add_u32 s42, s42, 16384
    s_and_b32 s42, s42, 0x7ffff
    s_add_u32 m0, s47, 32768
    s_nop 0
    buffer_load_dwordx4 v243, s[12:15], s55 offen nt lds
    v_mfma_f32_16x16x32_bf16 v[148:151], v[196:199], v[36:39], v[148:151]
    ds_read_b64_tr_b16 v[190:191], v232 offset:20992
    s_add_u32 m0, s47, 35840
    s_nop 0
    buffer_load_dwordx4 v243, s[12:15], s55 offen offset:1024 nt lds
    v_mfma_f32_16x16x32_bf16 v[148:151], v[192:195], v[28:31], v[148:151]
    ds_read_b64_tr_b16 v[184:185], v232 offset:16384
    s_add_u32 m0, s47, 38912
    s_nop 0
    buffer_load_dwordx4 v243, s[12:15], s55 offen offset:2048 nt lds
    v_mfma_f32_16x16x32_bf16 v[152:155], v[200:203], v[24:27], v[152:155]
    ds_read_b64_tr_b16 v[186:187], v232 offset:16896
    s_add_u32 m0, s47, 41984
    s_nop 0
    buffer_load_dwordx4 v243, s[12:15], s55 offen offset:3072 nt lds
    v_mfma_f32_16x16x32_bf16 v[152:155], v[204:207], v[32:35], v[152:155]
    ds_read_b64_tr_b16 v[196:197], v233 offset:20480
    s_add_u32 m0, s46, 8192
    s_add_u32 s44, s43, 2621440
    v_mfma_f32_16x16x32_bf16 v[156:159], v[204:207], v[36:39], v[156:159]
    ds_read_b64_tr_b16 v[198:199], v233 offset:20992
    s_and_b32 s44, s44, 0x403fffff
    v_mfma_f32_16x16x32_bf16 v[156:159], v[200:203], v[28:31], v[156:159]
    ds_read_b64_tr_b16 v[192:193], v233 offset:16384
    buffer_load_dwordx4 v244, s[16:19], s44 offen lds
    v_mfma_f32_16x16x32_bf16 v[160:163], v[208:211], v[24:27], v[160:163]
    ds_read_b64_tr_b16 v[194:195], v233 offset:16896
    s_add_u32 m0, s46, 12288
    s_add_u32 s44, s43, 2883584
    v_mfma_f32_16x16x32_bf16 v[160:163], v[212:215], v[32:35], v[160:163]
    ds_read_b64_tr_b16 v[204:205], v234 offset:20480
    s_and_b32 s44, s44, 0x403fffff
    v_mfma_f32_16x16x32_bf16 v[164:167], v[212:215], v[36:39], v[164:167]
    ds_read_b64_tr_b16 v[206:207], v234 offset:20992
    buffer_load_dwordx4 v244, s[16:19], s44 offen lds
    v_mfma_f32_16x16x32_bf16 v[164:167], v[208:211], v[28:31], v[164:167]
    ds_read_b64_tr_b16 v[200:201], v234 offset:16384
    ds_read_b64_tr_b16 v[202:203], v234 offset:16896
    ds_read_b64_tr_b16 v[212:213], v235 offset:20480
    ds_read_b64_tr_b16 v[214:215], v235 offset:20992
    ds_read_b64_tr_b16 v[208:209], v235 offset:16384
    ds_read_b64_tr_b16 v[210:211], v235 offset:16896
    s_waitcnt lgkmcnt(12)
    v_mfma_f32_16x16x32_bf16 v[136:139], v[184:187], v[40:43], v[136:139]
    v_mfma_f32_16x16x32_bf16 v[136:139], v[188:191], v[48:51], v[136:139]
    v_mfma_f32_16x16x32_bf16 v[140:143], v[188:191], v[52:55], v[140:143]
    v_mfma_f32_16x16x32_bf16 v[140:143], v[184:187], v[44:47], v[140:143]
    s_waitcnt lgkmcnt(8)
    v_mfma_f32_16x16x32_bf16 v[144:147], v[192:195], v[40:43], v[144:147]
    v_mfma_f32_16x16x32_bf16 v[144:147], v[196:199], v[48:51], v[144:147]
    s_bitcmp1_b32 0xf8, s38
    s_cbranch_scc0 L_fast2
    s_waitcnt vmcnt(5)
L_fast2:
    s_waitcnt vmcnt(6)
    s_waitcnt lgkmcnt(0)
    s_barrier
    ds_read_b64_tr_b16 v[188:189], v232 offset:28672
    s_cmp_lt_u32 s28, 30
    s_cselect_b32 s54, s41, 1073741824
    s_cselect_b32 s47, s45, 196608
    s_xor_b32 s54, s54, s4
    s_add_u32 s28, s28, 1
    s_add_u32 s41, s41, 16384
    s_and_b32 s41, s41, 0x7ffff
    s_add_u32 m0, s47, 0
    s_nop 0
    buffer_load_dwordx4 v242, s[8:11], s54 offen nt lds
    v_mfma_f32_16x16x32_bf16 v[148:151], v[196:199], v[52:55], v[148:151]
    ds_read_b64_tr_b16 v[190:191], v232 offset:29184
    s_add_u32 m0, s47, 3072
    s_nop 0
    buffer_load_dwordx4 v242, s[8:11], s54 offen offset:1024 nt lds
    v_mfma_f32_16x16x32_bf16 v[148:151], v[192:195], v[44:47], v[148:151]
    ds_read_b64_tr_b16 v[184:185], v232 offset:24576
    s_add_u32 m0, s47, 6144
    s_nop 0
    buffer_load_dwordx4 v242, s[8:11], s54 offen offset:2048 nt lds
    v_mfma_f32_16x16x32_bf16 v[152:155], v[200:203], v[40:43], v[152:155]
    ds_read_b64_tr_b16 v[186:187], v232 offset:25088
    s_add_u32 m0, s47, 9216
    s_nop 0
    buffer_load_dwordx4 v242, s[8:11], s54 offen offset:3072 nt lds
    v_mfma_f32_16x16x32_bf16 v[152:155], v[204:207], v[48:51], v[152:155]
    ds_read_b64_tr_b16 v[196:197], v233 offset:28672
    s_add_u32 m0, s46, 16384
    s_add_u32 s44, s43, 3145728
    v_mfma_f32_16x16x32_bf16 v[156:159], v[204:207], v[52:55], v[156:159]
    ds_read_b64_tr_b16 v[198:199], v233 offset:29184
    s_and_b32 s44, s44, 0x403fffff
    v_mfma_f32_16x16x32_bf16 v[156:159], v[200:203], v[44:47], v[156:159]
    ds_read_b64_tr_b16 v[192:193], v233 offset:24576
    buffer_load_dwordx4 v244, s[16:19], s44 offen lds
    v_mfma_f32_16x16x32_bf16 v[160:163], v[208:211], v[40:43], v[160:163]
    ds_read_b64_tr_b16 v[194:195], v233 offset:25088
    s_add_u32 m0, s46, 20480
    s_add_u32 s44, s43, 3407872
    v_mfma_f32_16x16x32_bf16 v[160:163], v[212:215], v[48:51], v[160:163]
    ds_read_b64_tr_b16 v[204:205], v234 offset:28672
    s_and_b32 s44, s44, 0x403fffff
    v_mfma_f32_16x16x32_bf16 v[164:167], v[212:215], v[52:55], v[164:167]
    ds_read_b64_tr_b16 v[206:207], v234 offset:29184
    buffer_load_dwordx4 v244, s[16:19], s44 offen lds
    v_mfma_f32_16x16x32_bf16 v[164:167], v[208:211], v[44:47], v[164:167]
    ds_read_b64_tr_b16 v[200:201], v234 offset:24576
    ds_read_b64_tr_b16 v[202:203], v234 offset:25088
    ds_read_b64_tr_b16 v[212:213], v235 offset:28672
    ds_read_b64_tr_b16 v[214:215], v235 offset:29184
    ds_read_b64_tr_b16 v[208:209], v235 offset:24576
    ds_read_b64_tr_b16 v[210:211], v235 offset:25088
    s_waitcnt lgkmcnt(12)
    v_mfma_f32_16x16x32_bf16 v[136:139], v[184:187], v[56:59], v[136:139]
    v_mfma_f32_16x16x32_bf16 v[136:139], v[188:191], v[64:67], v[136:139]
    v_mfma_f32_16x16x32_bf16 v[140:143], v[188:191], v[68:71], v[140:143]
    v_mfma_f32_16x16x32_bf16 v[140:143], v[184:187], v[60:63], v[140:143]
    s_waitcnt lgkmcnt(8)
    v_mfma_f32_16x16x32_bf16 v[144:147], v[192:195], v[56:59], v[144:147]
    v_mfma_f32_16x16x32_bf16 v[144:147], v[196:199], v[64:67], v[144:147]
    s_bitcmp1_b32 0x60, s38
    s_cbranch_scc0 L_fast3
    s_waitcnt vmcnt(5)
L_fast3:
    s_waitcnt vmcnt(6)
    s_waitcnt lgkmcnt(0)
    s_barrier
    ds_read_b64_tr_b16 v[188:189], v232 offset:4096
    s_cmp_lt_u32 s29, 30
    s_cselect_b32 s55, s42, 1073741824
    s_cselect_b32 s47, s45, 196608
    s_xor_b32 s55, s55, s4
    s_add_u32 s29, s29, 1
    s_add_u32 s42, s42, 16384
    s_and_b32 s42, s42, 0x7ffff
    s_add_u32 m0, s47, 49152
    s_nop 0
    buffer_load_dwordx4 v243, s[12:15], s55 offen nt lds
    v_mfma_f32_16x16x32_bf16 v[148:151], v[196:199], v[68:71], v[148:151]
    ds_read_b64_tr_b16 v[190:191], v232 offset:4608
    s_add_u32 m0, s47, 52224
    s_nop 0
    buffer_load_dwordx4 v243, s[12:15], s55 offen offset:1024 nt lds
    v_mfma_f32_16x16x32_bf16 v[148:151], v[192:195], v[60:63], v[148:151]
    ds_read_b64_tr_b16 v[184:185], v232 offset:0
    s_add_u32 m0, s47, 55296
    s_nop 0
    buffer_load_dwordx4 v243, s[12:15], s55 offen offset:2048 nt lds
    v_mfma_f32_16x16x32_bf16 v[152:155], v[200:203], v[56:59], v[152:155]
    ds_read_b64_tr_b16 v[186:187], v232 offset:512
    s_add_u32 m0, s47, 58368
    s_nop 0
    buffer_load_dwordx4 v243, s[12:15], s55 offen offset:3072 nt lds
    v_mfma_f32_16x16x32_bf16 v[152:155], v[204:207], v[64:67], v[152:155]
    ds_read_b64_tr_b16 v[196:197], v233 offset:4096
    s_add_u32 m0, s46, 24576
    s_add_u32 s44, s43, 3670016
    v_mfma_f32_16x16x32_bf16 v[156:159], v[204:207], v[68:71], v[156:159]
    ds_read_b64_tr_b16 v[198:199], v233 offset:4608
    s_and_b32 s44, s44, 0x403fffff
    v_mfma_f32_16x16x32_bf16 v[156:159], v[200:203], v[60:63], v[156:159]
    ds_read_b64_tr_b16 v[192:193], v233 offset:0
    buffer_load_dwordx4 v244, s[16:19], s44 offen lds
    v_mfma_f32_16x16x32_bf16 v[160:163], v[208:211], v[56:59], v[160:163]
    ds_read_b64_tr_b16 v[194:195], v233 offset:512
    s_add_u32 m0, s46, 28672
    s_add_u32 s44, s43, 3932160
    v_mfma_f32_16x16x32_bf16 v[160:163], v[212:215], v[64:67], v[160:163]
    ds_read_b64_tr_b16 v[204:205], v234 offset:4096
    s_and_b32 s44, s44, 0x403fffff
    v_mfma_f32_16x16x32_bf16 v[164:167], v[212:215], v[68:71], v[164:167]
    ds_read_b64_tr_b16 v[206:207], v234 offset:4608
    buffer_load_dwordx4 v244, s[16:19], s44 offen lds
    v_mfma_f32_16x16x32_bf16 v[164:167], v[208:211], v[60:63], v[164:167]
    ds_read_b64_tr_b16 v[200:201], v234 offset:0
    ds_read_b64_tr_b16 v[202:203], v234 offset:512
    ds_read_b64_tr_b16 v[212:213], v235 offset:4096
    ds_read_b64_tr_b16 v[214:215], v235 offset:4608
    ds_read_b64_tr_b16 v[208:209], v235 offset:0
    ds_read_b64_tr_b16 v[210:211], v235 offset:512
    s_waitcnt lgkmcnt(12)
    v_mfma_f32_16x16x32_bf16 v[136:139], v[184:187], v[72:75], v[136:139]
    v_mfma_f32_16x16x32_bf16 v[136:139], v[188:191], v[80:83], v[136:139]
    v_mfma_f32_16x16x32_bf16 v[140:143], v[188:191], v[84:87], v[140:143]
    v_mfma_f32_16x16x32_bf16 v[140:143], v[184:187], v[76:79], v[140:143]
    s_waitcnt lgkmcnt(8)
    v_mfma_f32_16x16x32_bf16 v[144:147], v[192:195], v[72:75], v[144:147]
    v_mfma_f32_16x16x32_bf16 v[144:147], v[196:199], v[80:83], v[144:147]
    s_bitcmp1_b32 0xf8, s38
    s_cbranch_scc0 L_fast4
    s_waitcnt vmcnt(5)
L_fast4:
    s_waitcnt vmcnt(6)
    s_waitcnt lgkmcnt(0)
    s_barrier
    ds_read_b64_tr_b16 v[188:189], v232 offset:12288
    s_cmp_lt_u32 s28, 30
    s_cselect_b32 s54, s41, 1073741824
    s_cselect_b32 s47, s45, 196608
    s_xor_b32 s54, s54, s4
    s_add_u32 s28, s28, 1
    s_add_u32 s41, s41, 16384
    s_and_b32 s41, s41, 0x7ffff
    s_add_u32 m0, s47, 16384
    s_nop 0
    buffer_load_dwordx4 v242, s[8:11], s54 offen nt lds
    v_mfma_f32_16x16x32_bf16 v[148:151], v[196:199], v[84:87], v[148:151]
    ds_read_b64_tr_b16 v[190:191], v232 offset:12800
    s_add_u32 m0, s47, 19456
    s_nop 0
    buffer_load_dwordx4 v242, s[8:11], s54 offen offset:1024 nt lds
    v_mfma_f32_16x16x32_bf16 v[148:151], v[192:195], v[76:79], v[148:151]
    ds_read_b64_tr_b16 v[184:185], v232 offset:8192
    s_add_u32 m0, s47, 22528
    s_nop 0
    buffer_load_dwordx4 v242, s[8:11], s54 offen offset:2048 nt lds
    v_mfma_f32_16x16x32_bf16 v[152:155], v[200:203], v[72:75], v[152:155]
    ds_read_b64_tr_b16 v[186:187], v232 offset:8704
    s_add_u32 m0, s47, 25600
    s_nop 0
    buffer_load_dwordx4 v242, s[8:11], s54 offen offset:3072 nt lds
    v_mfma_f32_16x16x32_bf16 v[152:155], v[204:207], v[80:83], v[152:155]
    ds_read_b64_tr_b16 v[196:197], v233 offset:12288
    s_add_u32 s30, s30, 1
    s_add_u32 s43, s43, 128
    s_and_b32 s43, s43, 0x3803ff
    v_mfma_f32_16x16x32_bf16 v[156:159], v[204:207], v[84:87], v[156:159]
    ds_read_b64_tr_b16 v[198:199], v233 offset:12800
    s_cmp_ge_u32 s30, 8
    s_cselect_b32 s43, 1073741824, s43
    v_mfma_f32_16x16x32_bf16 v[156:159], v[200:203], v[76:79], v[156:159]
    ds_read_b64_tr_b16 v[192:193], v233 offset:8192
    s_cselect_b32 s46, 196608, s46
    s_add_u32 m0, s46, 0
    v_mfma_f32_16x16x32_bf16 v[160:163], v[208:211], v[72:75], v[160:163]
    ds_read_b64_tr_b16 v[194:195], v233 offset:8704
    s_add_u32 s44, s43, 0
    s_and_b32 s44, s44, 0x403fffff
    buffer_load_dwordx4 v244, s[16:19], s44 offen lds
    v_mfma_f32_16x16x32_bf16 v[160:163], v[212:215], v[80:83], v[160:163]
    ds_read_b64_tr_b16 v[204:205], v234 offset:12288
    s_add_u32 m0, s46, 4096
    s_add_u32 s44, s43, 262144
    v_mfma_f32_16x16x32_bf16 v[164:167], v[212:215], v[84:87], v[164:167]
    ds_read_b64_tr_b16 v[206:207], v234 offset:12800
    s_and_b32 s44, s44, 0x403fffff
    buffer_load_dwordx4 v244, s[16:19], s44 offen lds
    v_mfma_f32_16x16x32_bf16 v[164:167], v[208:211], v[76:79], v[164:167]
    ds_read_b64_tr_b16 v[200:201], v234 offset:8192
    ds_read_b64_tr_b16 v[202:203], v234 offset:8704
    ds_read_b64_tr_b16 v[212:213], v235 offset:12288
    ds_read_b64_tr_b16 v[214:215], v235 offset:12800
    ds_read_b64_tr_b16 v[208:209], v235 offset:8192
    ds_read_b64_tr_b16 v[210:211], v235 offset:8704
    s_waitcnt lgkmcnt(12)
    v_mfma_f32_16x16x32_bf16 v[136:139], v[184:187], v[88:91], v[136:139]
    v_mfma_f32_16x16x32_bf16 v[136:139], v[188:191], v[96:99], v[136:139]
    v_mfma_f32_16x16x32_bf16 v[140:143], v[188:191], v[100:103], v[140:143]
    v_mfma_f32_16x16x32_bf16 v[140:143], v[184:187], v[92:95], v[140:143]
    s_waitcnt lgkmcnt(8)
    v_mfma_f32_16x16x32_bf16 v[144:147], v[192:195], v[88:91], v[144:147]
    v_mfma_f32_16x16x32_bf16 v[144:147], v[196:199], v[96:99], v[144:147]
    s_bitcmp1_b32 0x60, s38
    s_cbranch_scc0 L_fast5
    s_waitcnt vmcnt(5)
L_fast5:
    s_waitcnt vmcnt(6)
    s_waitcnt lgkmcnt(0)
    s_barrier
    ds_read_b64_tr_b16 v[188:189], v232 offset:20480
    s_cmp_lt_u32 s29, 30
    s_cselect_b32 s55, s42, 1073741824
    s_cselect_b32 s47, s45, 196608
    s_xor_b32 s55, s55, s4
    s_add_u32 s29, s29, 1
    s_add_u32 s42, s42, 16384
    s_and_b32 s42, s42, 0x7ffff
    s_add_u32 m0, s47, 32768
    s_nop 0
    buffer_load_dwordx4 v243, s[12:15], s55 offen nt lds
    v_mfma_f32_16x16x32_bf16 v[148:151], v[196:199], v[100:103], v[148:151]
    ds_read_b64_tr_b16 v[190:191], v232 offset:20992
    s_add_u32 m0, s47, 35840
    s_nop 0
    buffer_load_dwordx4 v243, s[12:15], s55 offen offset:1024 nt lds
    v_mfma_f32_16x16x32_bf16 v[148:151], v[192:195], v[92:95], v[148:151]
    ds_read_b64_tr_b16 v[184:185], v232 offset:16384
    s_add_u32 m0, s47, 38912
    s_nop 0
    buffer_load_dwordx4 v243, s[12:15], s55 offen offset:2048 nt lds
    v_mfma_f32_16x16x32_bf16 v[152:155], v[200:203], v[88:91], v[152:155]
    ds_read_b64_tr_b16 v[186:187], v232 offset:16896
    s_add_u32 m0, s47, 41984
    s_nop 0
    buffer_load_dwordx4 v243, s[12:15], s55 offen offset:3072 nt lds
    v_mfma_f32_16x16x32_bf16 v[152:155], v[204:207], v[96:99], v[152:155]
    ds_read_b64_tr_b16 v[196:197], v233 offset:20480
    s_add_u32 m0, s46, 8192
    s_add_u32 s44, s43, 524288
    v_mfma_f32_16x16x32_bf16 v[156:159], v[204:207], v[100:103], v[156:159]
    ds_read_b64_tr_b16 v[198:199], v233 offset:20992
    s_and_b32 s44, s44, 0x403fffff
    v_mfma_f32_16x16x32_bf16 v[156:159], v[200:203], v[92:95], v[156:159]
    ds_read_b64_tr_b16 v[192:193], v233 offset:16384
    buffer_load_dwordx4 v244, s[16:19], s44 offen lds
    v_mfma_f32_16x16x32_bf16 v[160:163], v[208:211], v[88:91], v[160:163]
    ds_read_b64_tr_b16 v[194:195], v233 offset:16896
    s_add_u32 m0, s46, 12288
    s_add_u32 s44, s43, 786432
    v_mfma_f32_16x16x32_bf16 v[160:163], v[212:215], v[96:99], v[160:163]
    ds_read_b64_tr_b16 v[204:205], v234 offset:20480
    s_and_b32 s44, s44, 0x403fffff
    v_mfma_f32_16x16x32_bf16 v[164:167], v[212:215], v[100:103], v[164:167]
    ds_read_b64_tr_b16 v[206:207], v234 offset:20992
    buffer_load_dwordx4 v244, s[16:19], s44 offen lds
    v_mfma_f32_16x16x32_bf16 v[164:167], v[208:211], v[92:95], v[164:167]
    ds_read_b64_tr_b16 v[200:201], v234 offset:16384
    ds_read_b64_tr_b16 v[202:203], v234 offset:16896
    ds_read_b64_tr_b16 v[212:213], v235 offset:20480
    ds_read_b64_tr_b16 v[214:215], v235 offset:20992
    ds_read_b64_tr_b16 v[208:209], v235 offset:16384
    ds_read_b64_tr_b16 v[210:211], v235 offset:16896
    s_waitcnt lgkmcnt(12)
    v_mfma_f32_16x16x32_bf16 v[136:139], v[184:187], v[104:107], v[136:139]
    v_mfma_f32_16x16x32_bf16 v[136:139], v[188:191], v[112:115], v[136:139]
    v_mfma_f32_16x16x32_bf16 v[140:143], v[188:191], v[116:119], v[140:143]
    v_mfma_f32_16x16x32_bf16 v[140:143], v[184:187], v[108:111], v[140:143]
    s_waitcnt lgkmcnt(8)
    v_mfma_f32_16x16x32_bf16 v[144:147], v[192:195], v[104:107], v[144:147]
    v_mfma_f32_16x16x32_bf16 v[144:147], v[196:199], v[112:115], v[144:147]
    s_bitcmp1_b32 0xfc, s38
    s_cbranch_scc0 L_fast6
    s_waitcnt vmcnt(5)
L_fast6:
    s_waitcnt vmcnt(6)
    s_waitcnt lgkmcnt(0)
    s_barrier
    ds_read_b64_tr_b16 v[188:189], v232 offset:28672
    s_cmp_lt_u32 s28, 30
    s_cselect_b32 s54, s41, 1073741824
    s_cselect_b32 s47, s45, 196608
    s_xor_b32 s54, s54, s4
    s_add_u32 s28, s28, 1
    s_add_u32 s41, s41, 16384
    s_and_b32 s41, s41, 0x7ffff
    s_add_u32 m0, s47, 0
    s_nop 0
    buffer_load_dwordx4 v242, s[8:11], s54 offen nt lds
    v_mfma_f32_16x16x32_bf16 v[148:151], v[196:199], v[116:119], v[148:151]
    ds_read_b64_tr_b16 v[190:191], v232 offset:29184
    s_add_u32 m0, s47, 3072
    s_nop 0
    buffer_load_dwordx4 v242, s[8:11], s54 offen offset:1024 nt lds
    v_mfma_f32_16x16x32_bf16 v[148:151], v[192:195], v[108:111], v[148:151]
    ds_read_b64_tr_b16 v[184:185], v232 offset:24576
    s_add_u32 m0, s47, 6144
    s_nop 0
    buffer_load_dwordx4 v242, s[8:11], s54 offen offset:2048 nt lds
    v_mfma_f32_16x16x32_bf16 v[152:155], v[200:203], v[104:107], v[152:155]
    ds_read_b64_tr_b16 v[186:187], v232 offset:25088
    s_add_u32 m0, s47, 9216
    s_nop 0
    buffer_load_dwordx4 v242, s[8:11], s54 offen offset:3072 nt lds
    v_mfma_f32_16x16x32_bf16 v[152:155], v[204:207], v[112:115], v[152:155]
    ds_read_b64_tr_b16 v[196:197], v233 offset:28672
    s_add_u32 m0, s46, 16384
    s_add_u32 s44, s43, 1048576
    v_mfma_f32_16x16x32_bf16 v[156:159], v[204:207], v[116:119], v[156:159]
    ds_read_b64_tr_b16 v[198:199], v233 offset:29184
    s_and_b32 s44, s44, 0x403fffff
    v_mfma_f32_16x16x32_bf16 v[156:159], v[200:203], v[108:111], v[156:159]
    ds_read_b64_tr_b16 v[192:193], v233 offset:24576
    buffer_load_dwordx4 v244, s[16:19], s44 offen lds
    v_mfma_f32_16x16x32_bf16 v[160:163], v[208:211], v[104:107], v[160:163]
    ds_read_b64_tr_b16 v[194:195], v233 offset:25088
    s_add_u32 m0, s46, 20480
    s_add_u32 s44, s43, 1310720
    v_mfma_f32_16x16x32_bf16 v[160:163], v[212:215], v[112:115], v[160:163]
    ds_read_b64_tr_b16 v[204:205], v234 offset:28672
    s_and_b32 s44, s44, 0x403fffff
    v_mfma_f32_16x16x32_bf16 v[164:167], v[212:215], v[116:119], v[164:167]
    ds_read_b64_tr_b16 v[206:207], v234 offset:29184
    buffer_load_dwordx4 v244, s[16:19], s44 offen lds
    v_mfma_f32_16x16x32_bf16 v[164:167], v[208:211], v[108:111], v[164:167]
    ds_read_b64_tr_b16 v[200:201], v234 offset:24576
    ds_read_b64_tr_b16 v[202:203], v234 offset:25088
    ds_read_b64_tr_b16 v[212:213], v235 offset:28672
    ds_read_b64_tr_b16 v[214:215], v235 offset:29184
    ds_read_b64_tr_b16 v[208:209], v235 offset:24576
    ds_read_b64_tr_b16 v[210:211], v235 offset:25088
    s_waitcnt lgkmcnt(12)
    v_mfma_f32_16x16x32_bf16 v[136:139], v[184:187], v[120:123], v[136:139]
    v_mfma_f32_16x16x32_bf16 v[136:139], v[188:191], v[128:131], v[136:139]
    v_mfma_f32_16x16x32_bf16 v[140:143], v[188:191], v[132:135], v[140:143]
    v_mfma_f32_16x16x32_bf16 v[140:143], v[184:187], v[124:127], v[140:143]
    s_waitcnt lgkmcnt(8)
    v_mfma_f32_16x16x32_bf16 v[144:147], v[192:195], v[120:123], v[144:147]
    v_mfma_f32_16x16x32_bf16 v[144:147], v[196:199], v[128:131], v[144:147]
    s_bitcmp1_b32 0x60, s38
    s_cbranch_scc0 L_fast7
    s_waitcnt vmcnt(5)
L_fast7:
    s_waitcnt vmcnt(6)
    s_waitcnt lgkmcnt(0)
    s_barrier
    s_add_u32 s38, s38, 1
    s_cmp_lt_u32 s38, 8
    s_cbranch_scc1 L_Ploop
    v_add_u32 v232, 98304, v236
    v_add_u32 v248, 65536, v236
    v_add_u32 v233, 98304, v237
    v_add_u32 v249, 65536, v237
    v_add_u32 v234, 98304, v238
    v_add_u32 v250, 65536, v238
    v_add_u32 v235, 98304, v239
    v_add_u32 v251, 65536, v239
    s_lshl_b32 s58, s6, 14
    s_lshl_b32 s50, s37, 12
    s_add_u32 s50, s50, s58
    s_nop 7
    s_cmp_lt_u32 s29, 30
    s_cselect_b32 s55, s42, 1073741824
    s_cselect_b32 s47, s45, 196608
    s_xor_b32 s55, s55, s4
    s_add_u32 s29, s29, 1
    s_add_u32 s42, s42, 16384
    s_and_b32 s42, s42, 0x7ffff
    s_add_u32 m0, s47, 49152
    s_nop 0
    buffer_load_dwordx4 v243, s[12:15], s55 offen nt lds
    s_add_u32 m0, s47, 52224
    s_nop 0
    buffer_load_dwordx4 v243, s[12:15], s55 offen offset:1024 nt lds
    s_add_u32 m0, s47, 55296
    s_nop 0
    buffer_load_dwordx4 v243, s[12:15], s55 offen offset:2048 nt lds
    s_add_u32 m0, s47, 58368
    s_nop 0
    buffer_load_dwordx4 v243, s[12:15], s55 offen offset:3072 nt lds
    v_mfma_f32_16x16x32_bf16 v[148:151], v[196:199], v[132:135], v[148:151]
    v_mfma_f32_16x16x32_bf16 v[148:151], v[192:195], v[124:127], v[148:151]
    v_mfma_f32_16x16x32_bf16 v[152:155], v[200:203], v[120:123], v[152:155]
    v_mfma_f32_16x16x32_bf16 v[152:155], v[204:207], v[128:131], v[152:155]
    v_mfma_f32_16x16x32_bf16 v[156:159], v[204:207], v[132:135], v[156:159]
    v_mfma_f32_16x16x32_bf16 v[156:159], v[200:203], v[124:127], v[156:159]
    v_mfma_f32_16x16x32_bf16 v[160:163], v[208:211], v[120:123], v[160:163]
    v_mfma_f32_16x16x32_bf16 v[160:163], v[212:215], v[128:131], v[160:163]
    v_mfma_f32_16x16x32_bf16 v[164:167], v[212:215], v[132:135], v[164:167]
    v_mfma_f32_16x16x32_bf16 v[164:167], v[208:211], v[124:127], v[164:167]
    v_add_u32 v246, -65536, v246
    v_mul_f32 v136, s40, v136
    v_mul_f32 v137, s40, v137
    v_mul_f32 v138, s40, v138
    v_mul_f32 v139, s40, v139
    v_cvt_pk_bf16_f32 v216, v136, v137
    v_cvt_pk_bf16_f32 v217, v138, v139
    v_mul_f32 v140, s40, v140
    v_mul_f32 v141, s40, v141
    v_mul_f32 v142, s40, v142
    v_mul_f32 v143, s40, v143
    v_cvt_pk_bf16_f32 v218, v140, v141
    v_cvt_pk_bf16_f32 v219, v142, v143
    v_mul_f32 v144, s40, v144
    v_mul_f32 v145, s40, v145
    v_mul_f32 v146, s40, v146
    v_mul_f32 v147, s40, v147
    v_cvt_pk_bf16_f32 v220, v144, v145
    v_cvt_pk_bf16_f32 v221, v146, v147
    v_mul_f32 v148, s40, v148
    v_mul_f32 v149, s40, v149
    v_mul_f32 v150, s40, v150
    v_mul_f32 v151, s40, v151
    v_cvt_pk_bf16_f32 v222, v148, v149
    v_cvt_pk_bf16_f32 v223, v150, v151
    v_mul_f32 v152, s40, v152
    v_mul_f32 v153, s40, v153
    v_mul_f32 v154, s40, v154
    v_mul_f32 v155, s40, v155
    v_cvt_pk_bf16_f32 v224, v152, v153
    v_cvt_pk_bf16_f32 v225, v154, v155
    v_mul_f32 v156, s40, v156
    v_mul_f32 v157, s40, v157
    v_mul_f32 v158, s40, v158
    v_mul_f32 v159, s40, v159
    v_cvt_pk_bf16_f32 v226, v156, v157
    v_cvt_pk_bf16_f32 v227, v158, v159
    v_mul_f32 v160, s40, v160
    v_mul_f32 v161, s40, v161
    v_mul_f32 v162, s40, v162
    v_mul_f32 v163, s40, v163
    v_cvt_pk_bf16_f32 v228, v160, v161
    v_cvt_pk_bf16_f32 v229, v162, v163
    v_mul_f32 v164, s40, v164
    v_mul_f32 v165, s40, v165
    v_mul_f32 v166, s40, v166
    v_mul_f32 v167, s40, v167
    v_cvt_pk_bf16_f32 v230, v164, v165
    v_cvt_pk_bf16_f32 v231, v166, v167
    ds_write_b64 v246, v[168:169] offset:0
    ds_write_b64 v246, v[170:171] offset:1024
    ds_write_b64 v246, v[172:173] offset:512
    ds_write_b64 v246, v[174:175] offset:1536
    ds_write_b64 v246, v[176:177] offset:2048
    ds_write_b64 v246, v[178:179] offset:3072
    ds_write_b64 v246, v[180:181] offset:2560
    ds_write_b64 v246, v[182:183] offset:3584
    ds_write_b64 v246, v[216:217] offset:4096
    ds_write_b64 v246, v[218:219] offset:5120
    ds_write_b64 v246, v[220:221] offset:4608
    ds_write_b64 v246, v[222:223] offset:5632
    ds_write_b64 v246, v[224:225] offset:6144
    ds_write_b64 v246, v[226:227] offset:7168
    ds_write_b64 v246, v[228:229] offset:6656
    ds_write_b64 v246, v[230:231] offset:7680
    s_waitcnt vmcnt(4)
    s_waitcnt lgkmcnt(0)
    s_barrier
    s_cmp_lt_u32 s28, 30
    s_cselect_b32 s54, s41, 1073741824
    s_cselect_b32 s47, s45, 196608
    s_xor_b32 s54, s54, s4
    s_add_u32 s28, s28, 1
    s_add_u32 s41, s41, 16384
    s_and_b32 s41, s41, 0x7ffff
    s_add_u32 m0, s47, 16384
    s_nop 0
    buffer_load_dwordx4 v242, s[8:11], s54 offen nt lds
    s_add_u32 m0, s47, 19456
    s_nop 0
    buffer_load_dwordx4 v242, s[8:11], s54 offen offset:1024 nt lds
    s_add_u32 m0, s47, 22528
    s_nop 0
    buffer_load_dwordx4 v242, s[8:11], s54 offen offset:2048 nt lds
    s_add_u32 m0, s47, 25600
    s_nop 0
    buffer_load_dwordx4 v242, s[8:11], s54 offen offset:3072 nt lds
    s_lshl_b32 s44, s37, 13
    s_add_u32 s44, s44, 98304
    v_add_u32 v246, s44, v252
    ds_read_b128 v[8:11], v246 offset:0
    ds_read_b128 v[12:15], v246 offset:1024
    ds_read_b128 v[16:19], v246 offset:2048
    ds_read_b128 v[20:23], v246 offset:3072
    ds_read_b128 v[24:27], v246 offset:4096
    ds_read_b128 v[28:31], v246 offset:5120
    ds_read_b128 v[32:35], v246 offset:6144
    ds_read_b128 v[36:39], v246 offset:7168
    s_lshl_b32 s44, s37, 13
    s_add_u32 s44, s44, 131072
    v_add_u32 v246, s44, v252
    ds_read_b128 v[40:43], v246 offset:0
    ds_read_b128 v[44:47], v246 offset:1024
    ds_read_b128 v[48:51], v246 offset:2048
    ds_read_b128 v[52:55], v246 offset:3072
    ds_read_b128 v[56:59], v246 offset:4096
    ds_read_b128 v[60:63], v246 offset:5120
    ds_read_b128 v[64:67], v246 offset:6144
    ds_read_b128 v[68:71], v246 offset:7168
    s_lshl_b32 s44, s37, 13
    s_add_u32 s44, s44, 65536
    v_add_u32 v246, s44, v252
    s_lshl_b32 s44, s37, 13
    s_add_u32 s44, s44, 32768
    v_add_u32 v247, s44, v252
    s_waitcnt vmcnt(4)
    s_waitcnt lgkmcnt(0)
    s_barrier
    s_add_u32 m0, s45, 98304
    s_add_u32 s44, s51, 256
    s_and_b32 s44, s44, 0x7ffff
    buffer_load_dwordx4 v245, s[20:23], s44 offen lds
    s_add_u32 m0, s45, 102400
    s_add_u32 s44, s51, 33024
    s_and_b32 s44, s44, 0x7ffff
    buffer_load_dwordx4 v245, s[20:23], s44 offen lds
    s_add_u32 m0, s45, 106496
    s_add_u32 s44, s51, 65792
    s_and_b32 s44, s44, 0x7ffff
    buffer_load_dwordx4 v245, s[20:23], s44 offen lds
    s_add_u32 m0, s45, 110592
    s_add_u32 s44, s51, 98560
    s_and_b32 s44, s44, 0x7ffff
    buffer_load_dwordx4 v245, s[20:23], s44 offen lds
    s_cmp_lt_u32 s29, 30
    s_cselect_b32 s55, s42, 1073741824
    s_cselect_b32 s47, s45, 196608
    s_xor_b32 s55, s55, s4
    s_add_u32 s29, s29, 1
    s_add_u32 s42, s42, 16384
    s_and_b32 s42, s42, 0x7ffff
    s_add_u32 m0, s47, 32768
    s_nop 0
    buffer_load_dwordx4 v243, s[12:15], s55 offen nt lds
    s_add_u32 m0, s47, 35840
    s_nop 0
    buffer_load_dwordx4 v243, s[12:15], s55 offen offset:1024 nt lds
    s_add_u32 m0, s47, 38912
    s_nop 0
    buffer_load_dwordx4 v243, s[12:15], s55 offen offset:2048 nt lds
    s_add_u32 m0, s47, 41984
    s_nop 0
    buffer_load_dwordx4 v243, s[12:15], s55 offen offset:3072 nt lds
    s_waitcnt vmcnt(8)
    s_waitcnt lgkmcnt(0)
    s_barrier
    s_add_u32 m0, s45, 114688
    s_add_u32 s44, s51, 131328
    s_and_b32 s44, s44, 0x7ffff
    buffer_load_dwordx4 v245, s[20:23], s44 offen lds
    s_add_u32 m0, s45, 118784
    s_add_u32 s44, s51, 164096
    s_and_b32 s44, s44, 0x7ffff
    buffer_load_dwordx4 v245, s[20:23], s44 offen lds
    s_add_u32 m0, s45, 122880
    s_add_u32 s44, s51, 196864
    s_and_b32 s44, s44, 0x7ffff
    buffer_load_dwordx4 v245, s[20:23], s44 offen lds
    s_add_u32 m0, s45, 126976
    s_add_u32 s44, s51, 229632
    s_and_b32 s44, s44, 0x7ffff
    buffer_load_dwordx4 v245, s[20:23], s44 offen lds
    s_cmp_lt_u32 s28, 30
    s_cselect_b32 s54, s41, 1073741824
    s_cselect_b32 s47, s45, 196608
    s_xor_b32 s54, s54, s4
    s_add_u32 s28, s28, 1
    s_add_u32 s41, s41, 16384
    s_and_b32 s41, s41, 0x7ffff
    s_add_u32 m0, s47, 0
    s_nop 0
    buffer_load_dwordx4 v242, s[8:11], s54 offen nt lds
    s_add_u32 m0, s47, 3072
    s_nop 0
    buffer_load_dwordx4 v242, s[8:11], s54 offen offset:1024 nt lds
    s_add_u32 m0, s47, 6144
    s_nop 0
    buffer_load_dwordx4 v242, s[8:11], s54 offen offset:2048 nt lds
    s_add_u32 m0, s47, 9216
    s_nop 0
    buffer_load_dwordx4 v242, s[8:11], s54 offen offset:3072 nt lds
    s_waitcnt vmcnt(8)
    s_waitcnt lgkmcnt(0)
    s_barrier
    ds_read_b64_tr_b16 v[184:185], v232 offset:0
    ds_read_b64_tr_b16 v[186:187], v232 offset:512
    ds_read_b64_tr_b16 v[188:189], v232 offset:4096
    ds_read_b64_tr_b16 v[190:191], v232 offset:4608
    ds_read_b64_tr_b16 v[192:193], v232 offset:8192
    ds_read_b64_tr_b16 v[194:195], v232 offset:8704
    ds_read_b64_tr_b16 v[196:197], v232 offset:12288
    ds_read_b64_tr_b16 v[198:199], v232 offset:12800
    ds_read_b64_tr_b16 v[200:201], v233 offset:0
    ds_read_b64_tr_b16 v[202:203], v233 offset:512
    ds_read_b64_tr_b16 v[204:205], v233 offset:4096
    ds_read_b64_tr_b16 v[206:207], v233 offset:4608
    ds_read_b64_tr_b16 v[208:209], v233 offset:8192
    ds_read_b64_tr_b16 v[210:211], v233 offset:8704
    ds_read_b64_tr_b16 v[212:213], v233 offset:12288
    ds_read_b64_tr_b16 v[214:215], v233 offset:12800
    s_add_u32 m0, s45, 131072
    s_add_u32 s44, s51, 262400
    s_and_b32 s44, s44, 0x7ffff
    buffer_load_dwordx4 v245, s[20:23], s44 offen lds
    s_add_u32 m0, s45, 135168
    s_add_u32 s44, s51, 295168
    s_and_b32 s44, s44, 0x7ffff
    buffer_load_dwordx4 v245, s[20:23], s44 offen lds
    s_add_u32 m0, s45, 139264
    s_add_u32 s44, s51, 327936
    s_and_b32 s44, s44, 0x7ffff
    buffer_load_dwordx4 v245, s[20:23], s44 offen lds
    s_add_u32 m0, s45, 143360
    s_add_u32 s44, s51, 360704
    s_and_b32 s44, s44, 0x7ffff
    buffer_load_dwordx4 v245, s[20:23], s44 offen lds
    s_cmp_lt_u32 s29, 30
    s_cselect_b32 s55, s42, 1073741824
    s_cselect_b32 s47, s45, 196608
    s_xor_b32 s55, s55, s4
    s_add_u32 s29, s29, 1
    s_add_u32 s42, s42, 16384
    s_and_b32 s42, s42, 0x7ffff
    s_add_u32 m0, s47, 49152
    s_nop 0
    buffer_load_dwordx4 v243, s[12:15], s55 offen nt lds
    s_add_u32 m0, s47, 52224
    s_nop 0
    buffer_load_dwordx4 v243, s[12:15], s55 offen offset:1024 nt lds
    s_add_u32 m0, s47, 55296
    s_nop 0
    buffer_load_dwordx4 v243, s[12:15], s55 offen offset:2048 nt lds
    s_add_u32 m0, s47, 58368
    s_nop 0
    buffer_load_dwordx4 v243, s[12:15], s55 offen offset:3072 nt lds
    s_waitcnt vmcnt(8)
    s_barrier
    s_waitcnt lgkmcnt(12)
    v_mfma_f32_16x16x32_bf16 v[136:139], v[184:187], v[8:11], 0
    v_mfma_f32_16x16x32_bf16 v[136:139], v[188:191], v[16:19], v[136:139]
    s_waitcnt lgkmcnt(8)
    v_mfma_f32_16x16x32_bf16 v[136:139], v[192:195], v[24:27], v[136:139]
    v_mfma_f32_16x16x32_bf16 v[136:139], v[196:199], v[32:35], v[136:139]
    s_add_u32 m0, s45, 147456
    s_add_u32 s44, s51, 384
    s_and_b32 s44, s44, 0x7ffff
    buffer_load_dwordx4 v245, s[20:23], s44 offen lds
    v_mfma_f32_16x16x32_bf16 v[140:143], v[184:187], v[12:15], 0
    ds_read_b64_tr_b16 v[184:185], v234 offset:0
    s_add_u32 m0, s45, 151552
    s_add_u32 s44, s51, 33152
    s_and_b32 s44, s44, 0x7ffff
    v_mfma_f32_16x16x32_bf16 v[140:143], v[188:191], v[20:23], v[140:143]
    ds_read_b64_tr_b16 v[186:187], v234 offset:512
    buffer_load_dwordx4 v245, s[20:23], s44 offen lds
    s_add_u32 m0, s45, 155648
    s_add_u32 s44, s51, 65920
    v_mfma_f32_16x16x32_bf16 v[140:143], v[192:195], v[28:31], v[140:143]
    ds_read_b64_tr_b16 v[188:189], v234 offset:4096
    s_and_b32 s44, s44, 0x7ffff
    buffer_load_dwordx4 v245, s[20:23], s44 offen lds
    s_add_u32 m0, s45, 159744
    v_mfma_f32_16x16x32_bf16 v[140:143], v[196:199], v[36:39], v[140:143]
    ds_read_b64_tr_b16 v[190:191], v234 offset:4608
    s_add_u32 s44, s51, 98688
    s_and_b32 s44, s44, 0x7ffff
    buffer_load_dwordx4 v245, s[20:23], s44 offen lds
    s_waitcnt lgkmcnt(8)
    v_mfma_f32_16x16x32_bf16 v[144:147], v[200:203], v[8:11], 0
    ds_read_b64_tr_b16 v[192:193], v234 offset:8192
    s_cmp_lt_u32 s28, 30
    s_cselect_b32 s54, s41, 1073741824
    s_cselect_b32 s47, s45, 196608
    v_mfma_f32_16x16x32_bf16 v[144:147], v[204:207], v[16:19], v[144:147]
    ds_read_b64_tr_b16 v[194:195], v234 offset:8704
    s_xor_b32 s54, s54, s4
    s_add_u32 s28, s28, 1
    s_add_u32 s41, s41, 16384
    s_waitcnt lgkmcnt(6)
    v_mfma_f32_16x16x32_bf16 v[144:147], v[208:211], v[24:27], v[144:147]
    ds_read_b64_tr_b16 v[196:197], v234 offset:12288
    s_and_b32 s41, s41, 0x7ffff
    s_add_u32 m0, s47, 16384
    s_nop 0
    buffer_load_dwordx4 v242, s[8:11], s54 offen nt lds
    v_mfma_f32_16x16x32_bf16 v[144:147], v[212:215], v[32:35], v[144:147]
    ds_read_b64_tr_b16 v[198:199], v234 offset:12800
    s_add_u32 m0, s47, 19456
    s_nop 0
    buffer_load_dwordx4 v242, s[8:11], s54 offen offset:1024 nt lds
    s_add_u32 m0, s47, 22528
    v_mfma_f32_16x16x32_bf16 v[148:151], v[200:203], v[12:15], 0
    ds_read_b64_tr_b16 v[200:201], v235 offset:0
    buffer_load_dwordx4 v242, s[8:11], s54 offen offset:2048 nt lds
    s_add_u32 m0, s47, 25600
    s_nop 0
    buffer_load_dwordx4 v242, s[8:11], s54 offen offset:3072 nt lds
    v_mfma_f32_16x16x32_bf16 v[148:151], v[204:207], v[20:23], v[148:151]
    ds_read_b64_tr_b16 v[202:203], v235 offset:512
    v_mfma_f32_16x16x32_bf16 v[148:151], v[208:211], v[28:31], v[148:151]
    ds_read_b64_tr_b16 v[204:205], v235 offset:4096
    v_mfma_f32_16x16x32_bf16 v[148:151], v[212:215], v[36:39], v[148:151]
    s_waitcnt vmcnt(8)
    s_barrier
    ds_read_b64_tr_b16 v[206:207], v235 offset:4608
    s_waitcnt lgkmcnt(8)
    v_mfma_f32_16x16x32_bf16 v[152:155], v[184:187], v[8:11], 0
    ds_read_b64_tr_b16 v[208:209], v235 offset:8192
    v_mfma_f32_16x16x32_bf16 v[152:155], v[188:191], v[16:19], v[152:155]
    ds_read_b64_tr_b16 v[210:211], v235 offset:8704
    s_waitcnt lgkmcnt(6)
    v_mfma_f32_16x16x32_bf16 v[152:155], v[192:195], v[24:27], v[152:155]
    ds_read_b64_tr_b16 v[212:213], v235 offset:12288
    v_mfma_f32_16x16x32_bf16 v[152:155], v[196:199], v[32:35], v[152:155]
    ds_read_b64_tr_b16 v[214:215], v235 offset:12800
    s_cmp_lt_u32 s29, 30
    s_cselect_b32 s55, s42, 1073741824
    v_mfma_f32_16x16x32_bf16 v[156:159], v[184:187], v[12:15], 0
    ds_read_b64_tr_b16 v[184:185], v232 offset:16384
    s_cselect_b32 s47, s45, 196608
    v_mfma_f32_16x16x32_bf16 v[156:159], v[188:191], v[20:23], v[156:159]
    ds_read_b64_tr_b16 v[186:187], v232 offset:16896
    s_xor_b32 s55, s55, s4
    s_add_u32 s29, s29, 1
    v_mfma_f32_16x16x32_bf16 v[156:159], v[192:195], v[28:31], v[156:159]
    ds_read_b128 v[72:75], v246 offset:0
    ds_read_b128 v[76:79], v246 offset:1024
    ds_read_b64_tr_b16 v[188:189], v232 offset:20480
    s_add_u32 s42, s42, 16384
    v_mfma_f32_16x16x32_bf16 v[156:159], v[196:199], v[36:39], v[156:159]
    ds_read_b128 v[80:83], v246 offset:2048
    ds_read_b64_tr_b16 v[190:191], v232 offset:20992
    s_and_b32 s42, s42, 0x7ffff
    s_add_u32 m0, s47, 32768
    s_waitcnt lgkmcnt(11)
    v_mfma_f32_16x16x32_bf16 v[160:163], v[200:203], v[8:11], 0
    ds_read_b128 v[84:87], v246 offset:3072
    ds_read_b64_tr_b16 v[192:193], v232 offset:24576
    buffer_load_dwordx4 v243, s[12:15], s55 offen nt lds
    v_mfma_f32_16x16x32_bf16 v[160:163], v[204:207], v[16:19], v[160:163]
    ds_read_b128 v[88:91], v246 offset:4096
    ds_read_b64_tr_b16 v[194:195], v232 offset:25088
    s_add_u32 m0, s47, 35840
    s_nop 0
    buffer_load_dwordx4 v243, s[12:15], s55 offen offset:1024 nt lds
    s_waitcnt lgkmcnt(11)
    v_mfma_f32_16x16x32_bf16 v[160:163], v[208:211], v[24:27], v[160:163]
    ds_read_b128 v[92:95], v246 offset:5120
    ds_read_b64_tr_b16 v[196:197], v232 offset:28672
    s_add_u32 m0, s47, 38912
    v_mfma_f32_16x16x32_bf16 v[160:163], v[212:215], v[32:35], v[160:163]
    ds_read_b128 v[96:99], v246 offset:6144
    ds_read_b64_tr_b16 v[198:199], v232 offset:29184
    buffer_load_dwordx4 v243, s[12:15], s55 offen offset:2048 nt lds
    s_add_u32 m0, s47, 41984
    v_mfma_f32_16x16x32_bf16 v[164:167], v[200:203], v[12:15], 0
    ds_read_b128 v[100:103], v246 offset:7168
    ds_read_b64_tr_b16 v[200:201], v233 offset:16384
    buffer_load_dwordx4 v243, s[12:15], s55 offen offset:3072 nt lds
    v_mfma_f32_16x16x32_bf16 v[164:167], v[204:207], v[20:23], v[164:167]
    ds_read_b64_tr_b16 v[202:203], v233 offset:16896
    v_mfma_f32_16x16x32_bf16 v[164:167], v[208:211], v[28:31], v[164:167]
    ds_read_b64_tr_b16 v[204:205], v233 offset:20480
    v_mfma_f32_16x16x32_bf16 v[164:167], v[212:215], v[36:39], v[164:167]
    ds_read_b64_tr_b16 v[206:207], v233 offset:20992
    s_waitcnt vmcnt(4)
    s_barrier
    s_waitcnt lgkmcnt(13)
    v_mfma_f32_16x16x32_bf16 v[136:139], v[184:187], v[40:43], v[136:139]
    ds_read_b64_tr_b16 v[208:209], v233 offset:24576
    v_mfma_f32_16x16x32_bf16 v[136:139], v[188:191], v[48:51], v[136:139]
    ds_read_b64_tr_b16 v[210:211], v233 offset:25088
    s_waitcnt lgkmcnt(7)
    v_mfma_f32_16x16x32_bf16 v[136:139], v[192:195], v[56:59], v[136:139]
    ds_read_b64_tr_b16 v[212:213], v233 offset:28672
    v_mfma_f32_16x16x32_bf16 v[136:139], v[196:199], v[64:67], v[136:139]
    ds_read_b64_tr_b16 v[214:215], v233 offset:29184
    s_add_u32 m0, s45, 98304
    s_add_u32 s44, s51, 131456
    s_and_b32 s44, s44, 0x7ffff
    buffer_load_dwordx4 v245, s[20:23], s44 offen lds
    v_mfma_f32_16x16x32_bf16 v[140:143], v[184:187], v[44:47], v[140:143]
    ds_read_b64_tr_b16 v[184:185], v234 offset:16384
    s_add_u32 m0, s45, 102400
    s_add_u32 s44, s51, 164224
    s_and_b32 s44, s44, 0x7ffff
    v_mfma_f32_16x16x32_bf16 v[140:143], v[188:191], v[52:55], v[140:143]
    ds_read_b64_tr_b16 v[186:187], v234 offset:16896
    buffer_load_dwordx4 v245, s[20:23], s44 offen lds
    s_add_u32 m0, s45, 106496
    s_add_u32 s44, s51, 196992
    v_mfma_f32_16x16x32_bf16 v[140:143], v[192:195], v[60:63], v[140:143]
    ds_read_b64_tr_b16 v[188:189], v234 offset:20480
    s_and_b32 s44, s44, 0x7ffff
    buffer_load_dwordx4 v245, s[20:23], s44 offen lds
    s_add_u32 m0, s45, 110592
    v_mfma_f32_16x16x32_bf16 v[140:143], v[196:199], v[68:71], v[140:143]
    ds_read_b64_tr_b16 v[190:191], v234 offset:20992
    s_add_u32 s44, s51, 229760
    s_and_b32 s44, s44, 0x7ffff
    buffer_load_dwordx4 v245, s[20:23], s44 offen lds
    s_waitcnt lgkmcnt(8)
    v_mfma_f32_16x16x32_bf16 v[144:147], v[200:203], v[40:43], v[144:147]
    ds_read_b64_tr_b16 v[192:193], v234 offset:24576
    s_cmp_lt_u32 s28, 30
    s_cselect_b32 s54, s41, 1073741824
    s_cselect_b32 s47, s45, 196608
    v_mfma_f32_16x16x32_bf16 v[144:147], v[204:207], v[48:51], v[144:147]
    ds_read_b64_tr_b16 v[194:195], v234 offset:25088
    s_xor_b32 s54, s54, s4
    s_add_u32 s28, s28, 1
    s_add_u32 s41, s41, 16384
    s_waitcnt lgkmcnt(6)
    v_mfma_f32_16x16x32_bf16 v[144:147], v[208:211], v[56:59], v[144:147]
    ds_read_b64_tr_b16 v[196:197], v234 offset:28672
    s_and_b32 s41, s41, 0x7ffff
    s_add_u32 m0, s47, 0
    s_nop 0
    buffer_load_dwordx4 v242, s[8:11], s54 offen nt lds
    v_mfma_f32_16x16x32_bf16 v[144:147], v[212:215], v[64:67], v[144:147]
    ds_read_b64_tr_b16 v[198:199], v234 offset:29184
    s_add_u32 m0, s47, 3072
    s_nop 0
    buffer_load_dwordx4 v242, s[8:11], s54 offen offset:1024 nt lds
    s_add_u32 m0, s47, 6144
    v_mfma_f32_16x16x32_bf16 v[148:151], v[200:203], v[44:47], v[148:151]
    ds_read_b64_tr_b16 v[200:201], v235 offset:16384
    buffer_load_dwordx4 v242, s[8:11], s54 offen offset:2048 nt lds
    s_add_u32 m0, s47, 9216
    s_nop 0
    buffer_load_dwordx4 v242, s[8:11], s54 offen offset:3072 nt lds
    v_mfma_f32_16x16x32_bf16 v[148:151], v[204:207], v[52:55], v[148:151]
    ds_read_b64_tr_b16 v[202:203], v235 offset:16896
    v_mfma_f32_16x16x32_bf16 v[148:151], v[208:211], v[60:63], v[148:151]
    ds_read_b64_tr_b16 v[204:205], v235 offset:20480
    v_mfma_f32_16x16x32_bf16 v[148:151], v[212:215], v[68:71], v[148:151]
    s_waitcnt vmcnt(8)
    s_barrier
    ds_read_b64_tr_b16 v[206:207], v235 offset:20992
    s_waitcnt lgkmcnt(8)
    v_mfma_f32_16x16x32_bf16 v[152:155], v[184:187], v[40:43], v[152:155]
    ds_read_b64_tr_b16 v[208:209], v235 offset:24576
    v_mfma_f32_16x16x32_bf16 v[152:155], v[188:191], v[48:51], v[152:155]
    ds_read_b64_tr_b16 v[210:211], v235 offset:25088
    s_waitcnt lgkmcnt(6)
    v_mfma_f32_16x16x32_bf16 v[152:155], v[192:195], v[56:59], v[152:155]
    ds_read_b64_tr_b16 v[212:213], v235 offset:28672
    v_mfma_f32_16x16x32_bf16 v[152:155], v[196:199], v[64:67], v[152:155]
    ds_read_b64_tr_b16 v[214:215], v235 offset:29184
    s_cmp_lt_u32 s29, 30
    s_cselect_b32 s55, s42, 1073741824
    v_mfma_f32_16x16x32_bf16 v[156:159], v[184:187], v[44:47], v[156:159]
    ds_read_b64_tr_b16 v[184:185], v232 offset:32768
    s_cselect_b32 s47, s45, 196608
    v_mfma_f32_16x16x32_bf16 v[156:159], v[188:191], v[52:55], v[156:159]
    ds_read_b64_tr_b16 v[186:187], v232 offset:33280
    s_xor_b32 s55, s55, s4
    s_add_u32 s29, s29, 1
    v_mfma_f32_16x16x32_bf16 v[156:159], v[192:195], v[60:63], v[156:159]
    ds_read_b64_tr_b16 v[188:189], v232 offset:36864
    s_add_u32 s42, s42, 16384
    v_mfma_f32_16x16x32_bf16 v[156:159], v[196:199], v[68:71], v[156:159]
    ds_read_b64_tr_b16 v[190:191], v232 offset:37376
    s_and_b32 s42, s42, 0x7ffff
    s_add_u32 m0, s47, 49152
    s_waitcnt lgkmcnt(8)
    v_mfma_f32_16x16x32_bf16 v[160:163], v[200:203], v[40:43], v[160:163]
    ds_read_b64_tr_b16 v[192:193], v232 offset:40960
    buffer_load_dwordx4 v243, s[12:15], s55 offen nt lds
    v_mfma_f32_16x16x32_bf16 v[160:163], v[204:207], v[48:51], v[160:163]
    ds_read_b64_tr_b16 v[194:195], v232 offset:41472
    s_add_u32 m0, s47, 52224
    s_nop 0
    buffer_load_dwordx4 v243, s[12:15], s55 offen offset:1024 nt lds
    s_waitcnt lgkmcnt(6)
    v_mfma_f32_16x16x32_bf16 v[160:163], v[208:211], v[56:59], v[160:163]
    ds_read_b64_tr_b16 v[196:197], v232 offset:45056
    s_add_u32 m0, s47, 55296
    v_mfma_f32_16x16x32_bf16 v[160:163], v[212:215], v[64:67], v[160:163]
    ds_read_b64_tr_b16 v[198:199], v232 offset:45568
    buffer_load_dwordx4 v243, s[12:15], s55 offen offset:2048 nt lds
    s_add_u32 m0, s47, 58368
    v_mfma_f32_16x16x32_bf16 v[164:167], v[200:203], v[44:47], v[164:167]
    ds_read_b64_tr_b16 v[200:201], v233 offset:32768
    buffer_load_dwordx4 v243, s[12:15], s55 offen offset:3072 nt lds
    v_mfma_f32_16x16x32_bf16 v[164:167], v[204:207], v[52:55], v[164:167]
    ds_read_b64_tr_b16 v[202:203], v233 offset:33280
    v_mfma_f32_16x16x32_bf16 v[164:167], v[208:211], v[60:63], v[164:167]
    ds_read_b64_tr_b16 v[204:205], v233 offset:36864
    v_mfma_f32_16x16x32_bf16 v[164:167], v[212:215], v[68:71], v[164:167]
    ds_read_b64_tr_b16 v[206:207], v233 offset:37376
    s_waitcnt vmcnt(4)
    s_barrier
    s_waitcnt lgkmcnt(8)
    v_mfma_f32_16x16x32_bf16 v[136:139], v[184:187], v[72:75], v[136:139]
    ds_read_b64_tr_b16 v[208:209], v233 offset:40960
    v_mfma_f32_16x16x32_bf16 v[136:139], v[188:191], v[80:83], v[136:139]
    ds_read_b64_tr_b16 v[210:211], v233 offset:41472
    s_waitcnt lgkmcnt(6)
    v_mfma_f32_16x16x32_bf16 v[136:139], v[192:195], v[88:91], v[136:139]
    ds_read_b64_tr_b16 v[212:213], v233 offset:45056
    v_mfma_f32_16x16x32_bf16 v[136:139], v[196:199], v[96:99], v[136:139]
    ds_read_b64_tr_b16 v[214:215], v233 offset:45568
    s_add_u32 m0, s45, 114688
    s_add_u32 s44, s51, 262528
    s_and_b32 s44, s44, 0x7ffff
    buffer_load_dwordx4 v245, s[20:23], s44 offen lds
    v_mfma_f32_16x16x32_bf16 v[140:143], v[184:187], v[76:79], v[140:143]
    ds_read_b64_tr_b16 v[184:185], v234 offset:32768
    s_add_u32 m0, s45, 118784
    s_add_u32 s44, s51, 295296
    s_and_b32 s44, s44, 0x7ffff
    v_mfma_f32_16x16x32_bf16 v[140:143], v[188:191], v[84:87], v[140:143]
    ds_read_b64_tr_b16 v[186:187], v234 offset:33280
    buffer_load_dwordx4 v245, s[20:23], s44 offen lds
    s_add_u32 m0, s45, 122880
    s_add_u32 s44, s51, 328064
    v_mfma_f32_16x16x32_bf16 v[140:143], v[192:195], v[92:95], v[140:143]
    ds_read_b64_tr_b16 v[188:189], v234 offset:36864
    s_and_b32 s44, s44, 0x7ffff
    buffer_load_dwordx4 v245, s[20:23], s44 offen lds
    s_add_u32 m0, s45, 126976
    v_mfma_f32_16x16x32_bf16 v[140:143], v[196:199], v[100:103], v[140:143]
    ds_read_b64_tr_b16 v[190:191], v234 offset:37376
    s_add_u32 s44, s51, 360832
    s_and_b32 s44, s44, 0x7ffff
    buffer_load_dwordx4 v245, s[20:23], s44 offen lds
    s_waitcnt lgkmcnt(8)
    v_mfma_f32_16x16x32_bf16 v[144:147], v[200:203], v[72:75], v[144:147]
    ds_read_b64_tr_b16 v[192:193], v234 offset:40960
    s_cmp_lt_u32 s28, 30
    s_cselect_b32 s54, s41, 1073741824
    s_cselect_b32 s47, s45, 196608
    v_mfma_f32_16x16x32_bf16 v[144:147], v[204:207], v[80:83], v[144:147]
    ds_read_b64_tr_b16 v[194:195], v234 offset:41472
    s_xor_b32 s54, s54, s4
    s_add_u32 s28, s28, 1
    s_add_u32 s41, s41, 16384
    s_waitcnt lgkmcnt(6)
    v_mfma_f32_16x16x32_bf16 v[144:147], v[208:211], v[88:91], v[144:147]
    ds_read_b64_tr_b16 v[196:197], v234 offset:45056
    s_and_b32 s41, s41, 0x7ffff
    s_add_u32 m0, s47, 16384
    s_nop 0
    buffer_load_dwordx4 v242, s[8:11], s54 offen nt lds
    v_mfma_f32_16x16x32_bf16 v[144:147], v[212:215], v[96:99], v[144:147]
    ds_read_b64_tr_b16 v[198:199], v234 offset:45568
    s_add_u32 m0, s47, 19456
    s_nop 0
    buffer_load_dwordx4 v242, s[8:11], s54 offen offset:1024 nt lds
    s_add_u32 m0, s47, 22528
    v_mfma_f32_16x16x32_bf16 v[148:151], v[200:203], v[76:79], v[148:151]
    ds_read_b64_tr_b16 v[200:201], v235 offset:32768
    buffer_load_dwordx4 v242, s[8:11], s54 offen offset:2048 nt lds
    s_add_u32 m0, s47, 25600
    s_nop 0
    buffer_load_dwordx4 v242, s[8:11], s54 offen offset:3072 nt lds
    v_mfma_f32_16x16x32_bf16 v[148:151], v[204:207], v[84:87], v[148:151]
    ds_read_b64_tr_b16 v[202:203], v235 offset:33280
    v_mfma_f32_16x16x32_bf16 v[148:151], v[208:211], v[92:95], v[148:151]
    ds_read_b64_tr_b16 v[204:205], v235 offset:36864
    v_cvt_pk_bf16_f32 v168, v136, v137
    v_mfma_f32_16x16x32_bf16 v[148:151], v[212:215], v[100:103], v[148:151]
    s_waitcnt vmcnt(8)
    s_barrier
    ds_read_b64_tr_b16 v[206:207], v235 offset:37376
    v_cvt_pk_bf16_f32 v169, v138, v139
    s_waitcnt lgkmcnt(8)
    v_mfma_f32_16x16x32_bf16 v[152:155], v[184:187], v[72:75], v[152:155]
    ds_read_b64_tr_b16 v[208:209], v235 offset:40960
    v_cvt_pk_bf16_f32 v170, v144, v145
    v_mfma_f32_16x16x32_bf16 v[152:155], v[188:191], v[80:83], v[152:155]
    ds_read_b64_tr_b16 v[210:211], v235 offset:41472
    v_cvt_pk_bf16_f32 v171, v146, v147
    s_waitcnt lgkmcnt(6)
    v_mfma_f32_16x16x32_bf16 v[152:155], v[192:195], v[88:91], v[152:155]
    ds_read_b64_tr_b16 v[212:213], v235 offset:45056
    v_mfma_f32_16x16x32_bf16 v[152:155], v[196:199], v[96:99], v[152:155]
    ds_read_b64_tr_b16 v[214:215], v235 offset:45568
    s_cmp_lt_u32 s29, 30
    s_cselect_b32 s55, s42, 1073741824
    v_mfma_f32_16x16x32_bf16 v[156:159], v[184:187], v[76:79], v[156:159]
    ds_read_b64_tr_b16 v[184:185], v232 offset:49152
    s_cselect_b32 s47, s45, 196608
    v_mfma_f32_16x16x32_bf16 v[156:159], v[188:191], v[84:87], v[156:159]
    ds_read_b64_tr_b16 v[186:187], v232 offset:49664
    s_xor_b32 s55, s55, s4
    s_add_u32 s29, s29, 1
    v_mfma_f32_16x16x32_bf16 v[156:159], v[192:195], v[92:95], v[156:159]
    ds_read_b64_tr_b16 v[188:189], v232 offset:53248
    s_add_u32 s42, s42, 16384
    v_cvt_pk_bf16_f32 v172, v140, v141
    v_mfma_f32_16x16x32_bf16 v[156:159], v[196:199], v[100:103], v[156:159]
    ds_read_b64_tr_b16 v[190:191], v232 offset:53760
    s_and_b32 s42, s42, 0x7ffff
    s_add_u32 m0, s47, 32768
    v_cvt_pk_bf16_f32 v173, v142, v143
    s_waitcnt lgkmcnt(8)
    v_mfma_f32_16x16x32_bf16 v[160:163], v[200:203], v[72:75], v[160:163]
    ds_read_b64_tr_b16 v[192:193], v232 offset:57344
    buffer_load_dwordx4 v243, s[12:15], s55 offen nt lds
    v_cvt_pk_bf16_f32 v174, v148, v149
    v_mfma_f32_16x16x32_bf16 v[160:163], v[204:207], v[80:83], v[160:163]
    ds_read_b64_tr_b16 v[194:195], v232 offset:57856
    s_add_u32 m0, s47, 35840
    s_nop 0
    buffer_load_dwordx4 v243, s[12:15], s55 offen offset:1024 nt lds
    v_cvt_pk_bf16_f32 v175, v150, v151
    s_waitcnt lgkmcnt(6)
    v_mfma_f32_16x16x32_bf16 v[160:163], v[208:211], v[88:91], v[160:163]
    ds_read_b64_tr_b16 v[196:197], v232 offset:61440
    s_add_u32 m0, s47, 38912
    v_mfma_f32_16x16x32_bf16 v[160:163], v[212:215], v[96:99], v[160:163]
    ds_read_b64_tr_b16 v[198:199], v232 offset:61952
    buffer_load_dwordx4 v243, s[12:15], s55 offen offset:2048 nt lds
    s_add_u32 m0, s47, 41984
    v_mfma_f32_16x16x32_bf16 v[164:167], v[200:203], v[76:79], v[164:167]
    ds_read_b64_tr_b16 v[200:201], v233 offset:49152
    buffer_load_dwordx4 v243, s[12:15], s55 offen offset:3072 nt lds
    v_mfma_f32_16x16x32_bf16 v[164:167], v[204:207], v[84:87], v[164:167]
    ds_read_b64_tr_b16 v[202:203], v233 offset:49664
    v_mfma_f32_16x16x32_bf16 v[164:167], v[208:211], v[92:95], v[164:167]
    ds_read_b64_tr_b16 v[204:205], v233 offset:53248
    v_cvt_pk_bf16_f32 v176, v152, v153
    v_mfma_f32_16x16x32_bf16 v[164:167], v[212:215], v[100:103], v[164:167]
    ds_read_b64_tr_b16 v[206:207], v233 offset:53760
    s_waitcnt vmcnt(4)
    s_barrier
    v_cvt_pk_bf16_f32 v177, v154, v155
    s_waitcnt lgkmcnt(8)
    v_mfma_f32_16x16x32_bf16 v[136:139], v[184:187], v[8:11], 0
    ds_read_b64_tr_b16 v[208:209], v233 offset:57344
    v_cvt_pk_bf16_f32 v178, v160, v161
    v_mfma_f32_16x16x32_bf16 v[136:139], v[188:191], v[16:19], v[136:139]
    ds_read_b64_tr_b16 v[210:211], v233 offset:57856
    v_cvt_pk_bf16_f32 v179, v162, v163
    s_waitcnt lgkmcnt(6)
    v_mfma_f32_16x16x32_bf16 v[136:139], v[192:195], v[24:27], v[136:139]
    ds_read_b64_tr_b16 v[212:213], v233 offset:61440
    v_mfma_f32_16x16x32_bf16 v[136:139], v[196:199], v[32:35], v[136:139]
    ds_read_b64_tr_b16 v[214:215], v233 offset:61952
    s_add_u32 m0, s45, 131072
    s_add_u32 s44, s51, 0
    s_and_b32 s44, s44, 0x7ffff
    buffer_load_dwordx4 v245, s[20:23], s44 offen lds
    v_mfma_f32_16x16x32_bf16 v[140:143], v[184:187], v[12:15], 0
    ds_read_b64_tr_b16 v[184:185], v234 offset:49152
    s_add_u32 m0, s45, 135168
    s_add_u32 s44, s51, 32768
    s_and_b32 s44, s44, 0x7ffff
    v_mfma_f32_16x16x32_bf16 v[140:143], v[188:191], v[20:23], v[140:143]
    ds_read_b64_tr_b16 v[186:187], v234 offset:49664
    buffer_load_dwordx4 v245, s[20:23], s44 offen lds
    s_add_u32 m0, s45, 139264
    s_add_u32 s44, s51, 65536
    v_mfma_f32_16x16x32_bf16 v[140:143], v[192:195], v[28:31], v[140:143]
    ds_read_b64_tr_b16 v[188:189], v234 offset:53248
    v_cvt_pk_bf16_f32 v180, v156, v157
    s_and_b32 s44, s44, 0x7ffff
    buffer_load_dwordx4 v245, s[20:23], s44 offen lds
    s_add_u32 m0, s45, 143360
    v_mfma_f32_16x16x32_bf16 v[140:143], v[196:199], v[36:39], v[140:143]
    ds_read_b64_tr_b16 v[190:191], v234 offset:53760
    v_cvt_pk_bf16_f32 v181, v158, v159
    s_add_u32 s44, s51, 98304
    s_and_b32 s44, s44, 0x7ffff
    buffer_load_dwordx4 v245, s[20:23], s44 offen lds
    s_waitcnt lgkmcnt(8)
    v_mfma_f32_16x16x32_bf16 v[144:147], v[200:203], v[8:11], 0
    ds_read_b64_tr_b16 v[192:193], v234 offset:57344
    v_cvt_pk_bf16_f32 v182, v164, v165
    s_cmp_lt_u32 s28, 30
    s_cselect_b32 s54, s41, 1073741824
    s_cselect_b32 s47, s45, 196608
    v_mfma_f32_16x16x32_bf16 v[144:147], v[204:207], v[16:19], v[144:147]
    ds_read_b64_tr_b16 v[194:195], v234 offset:57856
    v_cvt_pk_bf16_f32 v183, v166, v167
    s_xor_b32 s54, s54, s4
    s_add_u32 s28, s28, 1
    s_add_u32 s41, s41, 16384
    s_waitcnt lgkmcnt(6)
    v_mfma_f32_16x16x32_bf16 v[144:147], v[208:211], v[24:27], v[144:147]
    ds_read_b64_tr_b16 v[196:197], v234 offset:61440
    s_and_b32 s41, s41, 0x7ffff
    s_add_u32 m0, s47, 0
    s_nop 0
    buffer_load_dwordx4 v242, s[8:11], s54 offen nt lds
    v_mfma_f32_16x16x32_bf16 v[144:147], v[212:215], v[32:35], v[144:147]
    ds_read_b64_tr_b16 v[198:199], v234 offset:61952
    s_add_u32 m0, s47, 3072
    s_nop 0
    buffer_load_dwordx4 v242, s[8:11], s54 offen offset:1024 nt lds
    s_add_u32 m0, s47, 6144
    v_mfma_f32_16x16x32_bf16 v[148:151], v[200:203], v[12:15], 0
    ds_read_b64_tr_b16 v[200:201], v235 offset:49152
    buffer_load_dwordx4 v242, s[8:11], s54 offen offset:2048 nt lds
    s_add_u32 m0, s47, 9216
    s_nop 0
    buffer_load_dwordx4 v242, s[8:11], s54 offen offset:3072 nt lds
    v_mfma_f32_16x16x32_bf16 v[148:151], v[204:207], v[20:23], v[148:151]
    ds_read_b64_tr_b16 v[202:203], v235 offset:49664
    v_mfma_f32_16x16x32_bf16 v[148:151], v[208:211], v[28:31], v[148:151]
    ds_read_b64_tr_b16 v[204:205], v235 offset:53248
    v_mfma_f32_16x16x32_bf16 v[148:151], v[212:215], v[36:39], v[148:151]
    s_waitcnt vmcnt(8)
    s_barrier
    ds_read_b64_tr_b16 v[206:207], v235 offset:53760
    s_waitcnt lgkmcnt(8)
    v_mfma_f32_16x16x32_bf16 v[152:155], v[184:187], v[8:11], 0
    ds_read_b64_tr_b16 v[208:209], v235 offset:57344
    v_mfma_f32_16x16x32_bf16 v[152:155], v[188:191], v[16:19], v[152:155]
    ds_read_b64_tr_b16 v[210:211], v235 offset:57856
    s_waitcnt lgkmcnt(6)
    v_mfma_f32_16x16x32_bf16 v[152:155], v[192:195], v[24:27], v[152:155]
    ds_read_b64_tr_b16 v[212:213], v235 offset:61440
    v_mfma_f32_16x16x32_bf16 v[152:155], v[196:199], v[32:35], v[152:155]
    ds_read_b64_tr_b16 v[214:215], v235 offset:61952
    s_cmp_lt_u32 s29, 30
    s_cselect_b32 s55, s42, 1073741824
    v_mfma_f32_16x16x32_bf16 v[156:159], v[184:187], v[12:15], 0
    ds_read_b64_tr_b16 v[184:185], v232 offset:0
    s_cselect_b32 s47, s45, 196608
    v_mfma_f32_16x16x32_bf16 v[156:159], v[188:191], v[20:23], v[156:159]
    ds_read_b64_tr_b16 v[186:187], v232 offset:512
    s_xor_b32 s55, s55, s4
    s_add_u32 s29, s29, 1
    v_mfma_f32_16x16x32_bf16 v[156:159], v[192:195], v[28:31], v[156:159]
    ds_read_b64_tr_b16 v[188:189], v232 offset:4096
    s_add_u32 s42, s42, 16384
    v_mfma_f32_16x16x32_bf16 v[156:159], v[196:199], v[36:39], v[156:159]
    ds_read_b64_tr_b16 v[190:191], v232 offset:4608
    s_and_b32 s42, s42, 0x7ffff
    s_add_u32 m0, s47, 49152
    s_waitcnt lgkmcnt(8)
    v_mfma_f32_16x16x32_bf16 v[160:163], v[200:203], v[8:11], 0
    ds_read_b64_tr_b16 v[192:193], v232 offset:8192
    buffer_load_dwordx4 v243, s[12:15], s55 offen nt lds
    v_mfma_f32_16x16x32_bf16 v[160:163], v[204:207], v[16:19], v[160:163]
    ds_read_b64_tr_b16 v[194:195], v232 offset:8704
    s_add_u32 m0, s47, 52224
    s_nop 0
    buffer_load_dwordx4 v243, s[12:15], s55 offen offset:1024 nt lds
    s_waitcnt lgkmcnt(6)
    v_mfma_f32_16x16x32_bf16 v[160:163], v[208:211], v[24:27], v[160:163]
    ds_read_b64_tr_b16 v[196:197], v232 offset:12288
    s_add_u32 m0, s47, 55296
    v_mfma_f32_16x16x32_bf16 v[160:163], v[212:215], v[32:35], v[160:163]
    ds_read_b64_tr_b16 v[198:199], v232 offset:12800
    buffer_load_dwordx4 v243, s[12:15], s55 offen offset:2048 nt lds
    s_add_u32 m0, s47, 58368
    v_mfma_f32_16x16x32_bf16 v[164:167], v[200:203], v[12:15], 0
    ds_read_b64_tr_b16 v[200:201], v233 offset:0
    buffer_load_dwordx4 v243, s[12:15], s55 offen offset:3072 nt lds
    v_mfma_f32_16x16x32_bf16 v[164:167], v[204:207], v[20:23], v[164:167]
    ds_read_b64_tr_b16 v[202:203], v233 offset:512
    v_mfma_f32_16x16x32_bf16 v[164:167], v[208:211], v[28:31], v[164:167]
    ds_read_b64_tr_b16 v[204:205], v233 offset:4096
    v_mfma_f32_16x16x32_bf16 v[164:167], v[212:215], v[36:39], v[164:167]
    ds_read_b64_tr_b16 v[206:207], v233 offset:4608
    s_waitcnt vmcnt(4)
    s_barrier
    s_waitcnt lgkmcnt(8)
    v_mfma_f32_16x16x32_bf16 v[136:139], v[184:187], v[40:43], v[136:139]
    ds_read_b64_tr_b16 v[208:209], v233 offset:8192
    v_mfma_f32_16x16x32_bf16 v[136:139], v[188:191], v[48:51], v[136:139]
    ds_read_b64_tr_b16 v[210:211], v233 offset:8704
    s_waitcnt lgkmcnt(6)
    v_mfma_f32_16x16x32_bf16 v[136:139], v[192:195], v[56:59], v[136:139]
    ds_read_b64_tr_b16 v[212:213], v233 offset:12288
    v_mfma_f32_16x16x32_bf16 v[136:139], v[196:199], v[64:67], v[136:139]
    ds_read_b64_tr_b16 v[214:215], v233 offset:12800
    s_add_u32 m0, s45, 147456
    s_add_u32 s44, s51, 131072
    s_and_b32 s44, s44, 0x7ffff
    buffer_load_dwordx4 v245, s[20:23], s44 offen lds
    v_mfma_f32_16x16x32_bf16 v[140:143], v[184:187], v[44:47], v[140:143]
    ds_read_b64_tr_b16 v[184:185], v234 offset:0
    s_add_u32 m0, s45, 151552
    s_add_u32 s44, s51, 163840
    s_and_b32 s44, s44, 0x7ffff
    v_mfma_f32_16x16x32_bf16 v[140:143], v[188:191], v[52:55], v[140:143]
    ds_read_b64_tr_b16 v[186:187], v234 offset:512
    buffer_load_dwordx4 v245, s[20:23], s44 offen lds
    s_add_u32 m0, s45, 155648
    s_add_u32 s44, s51, 196608
    v_mfma_f32_16x16x32_bf16 v[140:143], v[192:195], v[60:63], v[140:143]
    ds_read_b64_tr_b16 v[188:189], v234 offset:4096
    s_and_b32 s44, s44, 0x7ffff
    buffer_load_dwordx4 v245, s[20:23], s44 offen lds
    s_add_u32 m0, s45, 159744
    v_mfma_f32_16x16x32_bf16 v[140:143], v[196:199], v[68:71], v[140:143]
    ds_read_b64_tr_b16 v[190:191], v234 offset:4608
    s_add_u32 s44, s51, 229376
    s_and_b32 s44, s44, 0x7ffff
    buffer_load_dwordx4 v245, s[20:23], s44 offen lds
    s_waitcnt lgkmcnt(8)
    v_mfma_f32_16x16x32_bf16 v[144:147], v[200:203], v[40:43], v[144:147]
    ds_read_b64_tr_b16 v[192:193], v234 offset:8192
    s_cmp_lt_u32 s28, 30
    s_cselect_b32 s54, s41, 1073741824
    s_cselect_b32 s47, s45, 196608
    v_mfma_f32_16x16x32_bf16 v[144:147], v[204:207], v[48:51], v[144:147]
    ds_read_b64_tr_b16 v[194:195], v234 offset:8704
    s_xor_b32 s54, s54, s4
    s_add_u32 s28, s28, 1
    s_add_u32 s41, s41, 16384
    s_waitcnt lgkmcnt(6)
    v_mfma_f32_16x16x32_bf16 v[144:147], v[208:211], v[56:59], v[144:147]
    ds_read_b64_tr_b16 v[196:197], v234 offset:12288
    s_and_b32 s41, s41, 0x7ffff
    s_add_u32 m0, s47, 16384
    s_nop 0
    buffer_load_dwordx4 v242, s[8:11], s54 offen nt lds
    v_mfma_f32_16x16x32_bf16 v[144:147], v[212:215], v[64:67], v[144:147]
    ds_read_b64_tr_b16 v[198:199], v234 offset:12800
    s_add_u32 m0, s47, 19456
    s_nop 0
    buffer_load_dwordx4 v242, s[8:11], s54 offen offset:1024 nt lds
    s_add_u32 m0, s47, 22528
    v_mfma_f32_16x16x32_bf16 v[148:151], v[200:203], v[44:47], v[148:151]
    ds_read_b64_tr_b16 v[200:201], v235 offset:0
    buffer_load_dwordx4 v242, s[8:11], s54 offen offset:2048 nt lds
    s_add_u32 m0, s47, 25600
    s_nop 0
    buffer_load_dwordx4 v242, s[8:11], s54 offen offset:3072 nt lds
    v_mfma_f32_16x16x32_bf16 v[148:151], v[204:207], v[52:55], v[148:151]
    ds_read_b64_tr_b16 v[202:203], v235 offset:512
    v_mfma_f32_16x16x32_bf16 v[148:151], v[208:211], v[60:63], v[148:151]
    ds_read_b64_tr_b16 v[204:205], v235 offset:4096
    v_mfma_f32_16x16x32_bf16 v[148:151], v[212:215], v[68:71], v[148:151]
    s_waitcnt vmcnt(8)
    s_barrier
    ds_read_b64_tr_b16 v[206:207], v235 offset:4608
    s_waitcnt lgkmcnt(8)
    v_mfma_f32_16x16x32_bf16 v[152:155], v[184:187], v[40:43], v[152:155]
    ds_read_b64_tr_b16 v[208:209], v235 offset:8192
    v_mfma_f32_16x16x32_bf16 v[152:155], v[188:191], v[48:51], v[152:155]
    ds_read_b64_tr_b16 v[210:211], v235 offset:8704
    s_waitcnt lgkmcnt(6)
    v_mfma_f32_16x16x32_bf16 v[152:155], v[192:195], v[56:59], v[152:155]
    ds_read_b64_tr_b16 v[212:213], v235 offset:12288
    v_mfma_f32_16x16x32_bf16 v[152:155], v[196:199], v[64:67], v[152:155]
    ds_read_b64_tr_b16 v[214:215], v235 offset:12800
    s_cmp_lt_u32 s29, 30
    s_cselect_b32 s55, s42, 1073741824
    v_mfma_f32_16x16x32_bf16 v[156:159], v[184:187], v[44:47], v[156:159]
    ds_read_b64_tr_b16 v[184:185], v232 offset:16384
    s_cselect_b32 s47, s45, 196608
    v_mfma_f32_16x16x32_bf16 v[156:159], v[188:191], v[52:55], v[156:159]
    ds_read_b64_tr_b16 v[186:187], v232 offset:16896
    s_xor_b32 s55, s55, s4
    s_add_u32 s29, s29, 1
    v_mfma_f32_16x16x32_bf16 v[156:159], v[192:195], v[60:63], v[156:159]
    ds_read_b64_tr_b16 v[188:189], v232 offset:20480
    s_add_u32 s42, s42, 16384
    v_mfma_f32_16x16x32_bf16 v[156:159], v[196:199], v[68:71], v[156:159]
    ds_read_b64_tr_b16 v[190:191], v232 offset:20992
    s_and_b32 s42, s42, 0x7ffff
    s_add_u32 m0, s47, 32768
    s_waitcnt lgkmcnt(8)
    v_mfma_f32_16x16x32_bf16 v[160:163], v[200:203], v[40:43], v[160:163]
    ds_read_b64_tr_b16 v[192:193], v232 offset:24576
    buffer_load_dwordx4 v243, s[12:15], s55 offen nt lds
    v_mfma_f32_16x16x32_bf16 v[160:163], v[204:207], v[48:51], v[160:163]
    ds_read_b64_tr_b16 v[194:195], v232 offset:25088
    s_add_u32 m0, s47, 35840
    s_nop 0
    buffer_load_dwordx4 v243, s[12:15], s55 offen offset:1024 nt lds
    s_waitcnt lgkmcnt(6)
    v_mfma_f32_16x16x32_bf16 v[160:163], v[208:211], v[56:59], v[160:163]
    ds_read_b64_tr_b16 v[196:197], v232 offset:28672
    s_add_u32 m0, s47, 38912
    v_mfma_f32_16x16x32_bf16 v[160:163], v[212:215], v[64:67], v[160:163]
    ds_read_b64_tr_b16 v[198:199], v232 offset:29184
    buffer_load_dwordx4 v243, s[12:15], s55 offen offset:2048 nt lds
    s_add_u32 m0, s47, 41984
    v_mfma_f32_16x16x32_bf16 v[164:167], v[200:203], v[44:47], v[164:167]
    ds_read_b64_tr_b16 v[200:201], v233 offset:16384
    buffer_load_dwordx4 v243, s[12:15], s55 offen offset:3072 nt lds
    v_mfma_f32_16x16x32_bf16 v[164:167], v[204:207], v[52:55], v[164:167]
    ds_read_b64_tr_b16 v[202:203], v233 offset:16896
    v_mfma_f32_16x16x32_bf16 v[164:167], v[208:211], v[60:63], v[164:167]
    ds_read_b64_tr_b16 v[204:205], v233 offset:20480
    v_mfma_f32_16x16x32_bf16 v[164:167], v[212:215], v[68:71], v[164:167]
    ds_read_b64_tr_b16 v[206:207], v233 offset:20992
    s_waitcnt vmcnt(4)
    s_barrier
    s_waitcnt lgkmcnt(8)
    v_mfma_f32_16x16x32_bf16 v[136:139], v[184:187], v[72:75], v[136:139]
    ds_read_b64_tr_b16 v[208:209], v233 offset:24576
    v_mfma_f32_16x16x32_bf16 v[136:139], v[188:191], v[80:83], v[136:139]
    ds_read_b64_tr_b16 v[210:211], v233 offset:25088
    s_waitcnt lgkmcnt(6)
    v_mfma_f32_16x16x32_bf16 v[136:139], v[192:195], v[88:91], v[136:139]
    ds_read_b64_tr_b16 v[212:213], v233 offset:28672
    v_mfma_f32_16x16x32_bf16 v[136:139], v[196:199], v[96:99], v[136:139]
    ds_read_b64_tr_b16 v[214:215], v233 offset:29184
    s_add_u32 m0, s45, 98304
    s_add_u32 s44, s51, 262144
    s_and_b32 s44, s44, 0x7ffff
    buffer_load_dwordx4 v245, s[20:23], s44 offen lds
    v_mfma_f32_16x16x32_bf16 v[140:143], v[184:187], v[76:79], v[140:143]
    ds_read_b64_tr_b16 v[184:185], v234 offset:16384
    s_add_u32 m0, s45, 102400
    s_add_u32 s44, s51, 294912
    s_and_b32 s44, s44, 0x7ffff
    v_mfma_f32_16x16x32_bf16 v[140:143], v[188:191], v[84:87], v[140:143]
    ds_read_b64_tr_b16 v[186:187], v234 offset:16896
    buffer_load_dwordx4 v245, s[20:23], s44 offen lds
    s_add_u32 m0, s45, 106496
    s_add_u32 s44, s51, 327680
    v_mfma_f32_16x16x32_bf16 v[140:143], v[192:195], v[92:95], v[140:143]
    ds_read_b64_tr_b16 v[188:189], v234 offset:20480
    s_and_b32 s44, s44, 0x7ffff
    buffer_load_dwordx4 v245, s[20:23], s44 offen lds
    s_add_u32 m0, s45, 110592
    v_mfma_f32_16x16x32_bf16 v[140:143], v[196:199], v[100:103], v[140:143]
    ds_read_b64_tr_b16 v[190:191], v234 offset:20992
    s_add_u32 s44, s51, 360448
    s_and_b32 s44, s44, 0x7ffff
    buffer_load_dwordx4 v245, s[20:23], s44 offen lds
    s_waitcnt lgkmcnt(8)
    v_mfma_f32_16x16x32_bf16 v[144:147], v[200:203], v[72:75], v[144:147]
    ds_read_b64_tr_b16 v[192:193], v234 offset:24576
    s_add_u32 m0, s45, 0
    s_add_u32 s44, s51, 262272
    s_and_b32 s44, s44, 0x7ffff
    buffer_load_dwordx4 v245, s[20:23], s44 offen lds
    v_mfma_f32_16x16x32_bf16 v[144:147], v[204:207], v[80:83], v[144:147]
    ds_read_b64_tr_b16 v[194:195], v234 offset:25088
    s_add_u32 m0, s45, 4096
    s_add_u32 s44, s51, 295040
    s_and_b32 s44, s44, 0x7ffff
    s_waitcnt lgkmcnt(6)
    v_mfma_f32_16x16x32_bf16 v[144:147], v[208:211], v[88:91], v[144:147]
    ds_read_b64_tr_b16 v[196:197], v234 offset:28672
    buffer_load_dwordx4 v245, s[20:23], s44 offen lds
    s_add_u32 m0, s45, 8192
    s_add_u32 s44, s51, 327808
    v_mfma_f32_16x16x32_bf16 v[144:147], v[212:215], v[96:99], v[144:147]
    ds_read_b64_tr_b16 v[198:199], v234 offset:29184
    s_and_b32 s44, s44, 0x7ffff
    buffer_load_dwordx4 v245, s[20:23], s44 offen lds
    s_add_u32 m0, s45, 12288
    v_mfma_f32_16x16x32_bf16 v[148:151], v[200:203], v[76:79], v[148:151]
    ds_read_b64_tr_b16 v[200:201], v235 offset:16384
    s_add_u32 s44, s51, 360576
    s_and_b32 s44, s44, 0x7ffff
    buffer_load_dwordx4 v245, s[20:23], s44 offen lds
    v_mfma_f32_16x16x32_bf16 v[148:151], v[204:207], v[84:87], v[148:151]
    ds_read_b64_tr_b16 v[202:203], v235 offset:16896
    v_mfma_f32_16x16x32_bf16 v[148:151], v[208:211], v[92:95], v[148:151]
    ds_read_b64_tr_b16 v[204:205], v235 offset:20480
    v_cvt_pk_bf16_f32 v216, v136, v137
    v_mfma_f32_16x16x32_bf16 v[148:151], v[212:215], v[100:103], v[148:151]
    s_waitcnt vmcnt(8)
    s_barrier
    ds_read_b64_tr_b16 v[206:207], v235 offset:20992
    v_cvt_pk_bf16_f32 v217, v138, v139
    s_waitcnt lgkmcnt(8)
    v_mfma_f32_16x16x32_bf16 v[152:155], v[184:187], v[72:75], v[152:155]
    ds_read_b64_tr_b16 v[208:209], v235 offset:24576
    v_cvt_pk_bf16_f32 v218, v144, v145
    v_mfma_f32_16x16x32_bf16 v[152:155], v[188:191], v[80:83], v[152:155]
    ds_read_b64_tr_b16 v[210:211], v235 offset:25088
    v_cvt_pk_bf16_f32 v219, v146, v147
    s_waitcnt lgkmcnt(6)
    v_mfma_f32_16x16x32_bf16 v[152:155], v[192:195], v[88:91], v[152:155]
    ds_read_b64_tr_b16 v[212:213], v235 offset:28672
    v_mfma_f32_16x16x32_bf16 v[152:155], v[196:199], v[96:99], v[152:155]
    ds_read_b64_tr_b16 v[214:215], v235 offset:29184
    s_cmp_lt_u32 s29, 30
    s_cselect_b32 s55, s42, 1073741824
    v_mfma_f32_16x16x32_bf16 v[156:159], v[184:187], v[76:79], v[156:159]
    ds_read_b64_tr_b16 v[184:185], v232 offset:32768
    s_cselect_b32 s47, s45, 196608
    v_mfma_f32_16x16x32_bf16 v[156:159], v[188:191], v[84:87], v[156:159]
    ds_read_b64_tr_b16 v[186:187], v232 offset:33280
    s_xor_b32 s55, s55, s4
    s_add_u32 s29, s29, 1
    v_mfma_f32_16x16x32_bf16 v[156:159], v[192:195], v[92:95], v[156:159]
    ds_read_b64_tr_b16 v[188:189], v232 offset:36864
    s_add_u32 s42, s42, 16384
    v_cvt_pk_bf16_f32 v220, v140, v141
    v_mfma_f32_16x16x32_bf16 v[156:159], v[196:199], v[100:103], v[156:159]
    ds_read_b64_tr_b16 v[190:191], v232 offset:37376
    s_and_b32 s42, s42, 0x7ffff
    s_add_u32 m0, s47, 49152
    v_cvt_pk_bf16_f32 v221, v142, v143
    s_waitcnt lgkmcnt(8)
    v_mfma_f32_16x16x32_bf16 v[160:163], v[200:203], v[72:75], v[160:163]
    ds_read_b64_tr_b16 v[192:193], v232 offset:40960
    buffer_load_dwordx4 v243, s[12:15], s55 offen nt lds
    v_cvt_pk_bf16_f32 v222, v148, v149
    v_mfma_f32_16x16x32_bf16 v[160:163], v[204:207], v[80:83], v[160:163]
    ds_read_b64_tr_b16 v[194:195], v232 offset:41472
    s_add_u32 m0, s47, 52224
    s_nop 0
    buffer_load_dwordx4 v243, s[12:15], s55 offen offset:1024 nt lds
    v_cvt_pk_bf16_f32 v223, v150, v151
    s_waitcnt lgkmcnt(6)
    v_mfma_f32_16x16x32_bf16 v[160:163], v[208:211], v[88:91], v[160:163]
    ds_read_b64_tr_b16 v[196:197], v232 offset:45056
    s_add_u32 m0, s47, 55296
    v_mfma_f32_16x16x32_bf16 v[160:163], v[212:215], v[96:99], v[160:163]
    ds_read_b64_tr_b16 v[198:199], v232 offset:45568
    buffer_load_dwordx4 v243, s[12:15], s55 offen offset:2048 nt lds
    s_add_u32 m0, s47, 58368
    v_mfma_f32_16x16x32_bf16 v[164:167], v[200:203], v[76:79], v[164:167]
    ds_read_b64_tr_b16 v[200:201], v233 offset:32768
    buffer_load_dwordx4 v243, s[12:15], s55 offen offset:3072 nt lds
    v_mfma_f32_16x16x32_bf16 v[164:167], v[204:207], v[84:87], v[164:167]
    ds_read_b64_tr_b16 v[202:203], v233 offset:33280
    v_mfma_f32_16x16x32_bf16 v[164:167], v[208:211], v[92:95], v[164:167]
    ds_read_b64_tr_b16 v[204:205], v233 offset:36864
    v_cvt_pk_bf16_f32 v224, v152, v153
    v_mfma_f32_16x16x32_bf16 v[164:167], v[212:215], v[100:103], v[164:167]
    ds_read_b64_tr_b16 v[206:207], v233 offset:37376
    s_barrier
    v_cvt_pk_bf16_f32 v225, v154, v155
    s_waitcnt lgkmcnt(8)
    v_mfma_f32_16x16x32_bf16 v[136:139], v[184:187], v[8:11], 0
    ds_read_b64_tr_b16 v[208:209], v233 offset:40960
    v_cvt_pk_bf16_f32 v226, v160, v161
    v_mfma_f32_16x16x32_bf16 v[136:139], v[188:191], v[16:19], v[136:139]
    ds_read_b64_tr_b16 v[210:211], v233 offset:41472
    v_cvt_pk_bf16_f32 v227, v162, v163
    s_waitcnt lgkmcnt(6)
    v_mfma_f32_16x16x32_bf16 v[136:139], v[192:195], v[24:27], v[136:139]
    ds_read_b64_tr_b16 v[212:213], v233 offset:45056
    v_mfma_f32_16x16x32_bf16 v[136:139], v[196:199], v[32:35], v[136:139]
    ds_read_b64_tr_b16 v[214:215], v233 offset:45568
    s_add_u32 m0, s45, 114688
    s_add_u32 s44, s51, 393216
    s_and_b32 s44, s44, 0x7ffff
    buffer_load_dwordx4 v245, s[20:23], s44 offen lds
    v_mfma_f32_16x16x32_bf16 v[140:143], v[184:187], v[12:15], 0
    ds_read_b64_tr_b16 v[184:185], v234 offset:32768
    s_add_u32 m0, s45, 118784
    s_add_u32 s44, s51, 425984
    s_and_b32 s44, s44, 0x7ffff
    v_mfma_f32_16x16x32_bf16 v[140:143], v[188:191], v[20:23], v[140:143]
    ds_read_b64_tr_b16 v[186:187], v234 offset:33280
    buffer_load_dwordx4 v245, s[20:23], s44 offen lds
    s_add_u32 m0, s45, 122880
    s_add_u32 s44, s51, 458752
    v_mfma_f32_16x16x32_bf16 v[140:143], v[192:195], v[28:31], v[140:143]
    ds_read_b64_tr_b16 v[188:189], v234 offset:36864
    v_cvt_pk_bf16_f32 v228, v156, v157
    s_and_b32 s44, s44, 0x7ffff
    buffer_load_dwordx4 v245, s[20:23], s44 offen lds
    s_add_u32 m0, s45, 126976
    v_mfma_f32_16x16x32_bf16 v[140:143], v[196:199], v[36:39], v[140:143]
    ds_read_b64_tr_b16 v[190:191], v234 offset:37376
    v_cvt_pk_bf16_f32 v229, v158, v159
    s_add_u32 s44, s51, 491520
    s_and_b32 s44, s44, 0x7ffff
    buffer_load_dwordx4 v245, s[20:23], s44 offen lds
    s_waitcnt lgkmcnt(8)
    v_mfma_f32_16x16x32_bf16 v[144:147], v[200:203], v[8:11], 0
    ds_read_b64_tr_b16 v[192:193], v234 offset:40960
    v_cvt_pk_bf16_f32 v230, v164, v165
    s_add_u32 m0, s45, 16384
    s_add_u32 s44, s51, 393344
    s_and_b32 s44, s44, 0x7ffff
    buffer_load_dwordx4 v245, s[20:23], s44 offen lds
    v_mfma_f32_16x16x32_bf16 v[144:147], v[204:207], v[16:19], v[144:147]
    ds_read_b64_tr_b16 v[194:195], v234 offset:41472
    v_cvt_pk_bf16_f32 v231, v166, v167
    s_add_u32 m0, s45, 20480
    s_add_u32 s44, s51, 426112
    s_and_b32 s44, s44, 0x7ffff
    s_waitcnt lgkmcnt(6)
    v_mfma_f32_16x16x32_bf16 v[144:147], v[208:211], v[24:27], v[144:147]
    ds_read_b64_tr_b16 v[196:197], v234 offset:45056
    buffer_load_dwordx4 v245, s[20:23], s44 offen lds
    s_add_u32 m0, s45, 24576
    s_add_u32 s44, s51, 458880
    v_mfma_f32_16x16x32_bf16 v[144:147], v[212:215], v[32:35], v[144:147]
    ds_read_b64_tr_b16 v[198:199], v234 offset:45568
    s_and_b32 s44, s44, 0x7ffff
    buffer_load_dwordx4 v245, s[20:23], s44 offen lds
    s_add_u32 m0, s45, 28672
    v_mfma_f32_16x16x32_bf16 v[148:151], v[200:203], v[12:15], 0
    ds_read_b64_tr_b16 v[200:201], v235 offset:32768
    s_add_u32 s44, s51, 491648
    s_and_b32 s44, s44, 0x7ffff
    buffer_load_dwordx4 v245, s[20:23], s44 offen lds
    v_mfma_f32_16x16x32_bf16 v[148:151], v[204:207], v[20:23], v[148:151]
    ds_read_b64_tr_b16 v[202:203], v235 offset:33280
    v_mfma_f32_16x16x32_bf16 v[148:151], v[208:211], v[28:31], v[148:151]
    ds_read_b64_tr_b16 v[204:205], v235 offset:36864
    v_mfma_f32_16x16x32_bf16 v[148:151], v[212:215], v[36:39], v[148:151]
    s_waitcnt vmcnt(8)
    s_barrier
    ds_read_b64_tr_b16 v[206:207], v235 offset:37376
    s_waitcnt lgkmcnt(8)
    v_mfma_f32_16x16x32_bf16 v[152:155], v[184:187], v[8:11], 0
    ds_read_b64_tr_b16 v[208:209], v235 offset:40960
    v_mfma_f32_16x16x32_bf16 v[152:155], v[188:191], v[16:19], v[152:155]
    ds_read_b64_tr_b16 v[210:211], v235 offset:41472
    s_waitcnt lgkmcnt(6)
    v_mfma_f32_16x16x32_bf16 v[152:155], v[192:195], v[24:27], v[152:155]
    ds_read_b64_tr_b16 v[212:213], v235 offset:45056
    v_mfma_f32_16x16x32_bf16 v[152:155], v[196:199], v[32:35], v[152:155]
    ds_read_b64_tr_b16 v[214:215], v235 offset:45568
    s_add_u32 m0, s45, 65536
    s_add_u32 s44, s51, 393472
    v_mfma_f32_16x16x32_bf16 v[156:159], v[184:187], v[12:15], 0
    ds_read_b64_tr_b16 v[184:185], v232 offset:49152
    s_and_b32 s44, s44, 0x7ffff
    buffer_load_dwordx4 v245, s[20:23], s44 offen lds
    v_mfma_f32_16x16x32_bf16 v[156:159], v[188:191], v[20:23], v[156:159]
    ds_read_b64_tr_b16 v[186:187], v232 offset:49664
    s_add_u32 m0, s45, 69632
    v_mfma_f32_16x16x32_bf16 v[156:159], v[192:195], v[28:31], v[156:159]
    ds_read_b64_tr_b16 v[188:189], v232 offset:53248
    s_add_u32 s44, s51, 426240
    s_and_b32 s44, s44, 0x7ffff
    v_mfma_f32_16x16x32_bf16 v[156:159], v[196:199], v[36:39], v[156:159]
    ds_read_b64_tr_b16 v[190:191], v232 offset:53760
    buffer_load_dwordx4 v245, s[20:23], s44 offen lds
    s_waitcnt lgkmcnt(8)
    v_mfma_f32_16x16x32_bf16 v[160:163], v[200:203], v[8:11], 0
    ds_read_b64_tr_b16 v[192:193], v232 offset:57344
    s_add_u32 m0, s45, 73728
    s_add_u32 s44, s51, 459008
    v_mfma_f32_16x16x32_bf16 v[160:163], v[204:207], v[16:19], v[160:163]
    ds_read_b64_tr_b16 v[194:195], v232 offset:57856
    s_and_b32 s44, s44, 0x7ffff
    buffer_load_dwordx4 v245, s[20:23], s44 offen lds
    s_waitcnt lgkmcnt(6)
    v_mfma_f32_16x16x32_bf16 v[160:163], v[208:211], v[24:27], v[160:163]
    ds_read_b64_tr_b16 v[196:197], v232 offset:61440
    s_add_u32 m0, s45, 77824
    v_mfma_f32_16x16x32_bf16 v[160:163], v[212:215], v[32:35], v[160:163]
    ds_read_b64_tr_b16 v[198:199], v232 offset:61952
    s_add_u32 s44, s51, 491776
    s_and_b32 s44, s44, 0x7ffff
    v_mfma_f32_16x16x32_bf16 v[164:167], v[200:203], v[12:15], 0
    ds_read_b64_tr_b16 v[200:201], v233 offset:49152
    buffer_load_dwordx4 v245, s[20:23], s44 offen lds
    v_mfma_f32_16x16x32_bf16 v[164:167], v[204:207], v[20:23], v[164:167]
    ds_read_b64_tr_b16 v[202:203], v233 offset:49664
    v_mfma_f32_16x16x32_bf16 v[164:167], v[208:211], v[28:31], v[164:167]
    ds_read_b64_tr_b16 v[204:205], v233 offset:53248
    v_mfma_f32_16x16x32_bf16 v[164:167], v[212:215], v[36:39], v[164:167]
    ds_read_b64_tr_b16 v[206:207], v233 offset:53760
    s_barrier
    s_waitcnt lgkmcnt(8)
    v_mfma_f32_16x16x32_bf16 v[136:139], v[184:187], v[40:43], v[136:139]
    ds_read_b64_tr_b16 v[208:209], v233 offset:57344
    v_mfma_f32_16x16x32_bf16 v[136:139], v[188:191], v[48:51], v[136:139]
    ds_read_b64_tr_b16 v[210:211], v233 offset:57856
    s_waitcnt lgkmcnt(6)
    v_mfma_f32_16x16x32_bf16 v[136:139], v[192:195], v[56:59], v[136:139]
    ds_read_b64_tr_b16 v[212:213], v233 offset:61440
    v_mfma_f32_16x16x32_bf16 v[136:139], v[196:199], v[64:67], v[136:139]
    ds_read_b64_tr_b16 v[214:215], v233 offset:61952
    s_add_u32 m0, s45, 131072
    s_add_u32 s44, s51, 128
    s_and_b32 s44, s44, 0x7ffff
    v_mfma_f32_16x16x32_bf16 v[140:143], v[184:187], v[44:47], v[140:143]
    ds_read_b64_tr_b16 v[184:185], v234 offset:49152
    buffer_load_dwordx4 v245, s[20:23], s44 offen lds
    s_add_u32 m0, s45, 135168
    v_mfma_f32_16x16x32_bf16 v[140:143], v[188:191], v[52:55], v[140:143]
    ds_read_b64_tr_b16 v[186:187], v234 offset:49664
    s_add_u32 s44, s51, 32896
    s_and_b32 s44, s44, 0x7ffff
    v_mfma_f32_16x16x32_bf16 v[140:143], v[192:195], v[60:63], v[140:143]
    ds_read_b64_tr_b16 v[188:189], v234 offset:53248
    buffer_load_dwordx4 v245, s[20:23], s44 offen lds
    s_add_u32 m0, s45, 139264
    v_mfma_f32_16x16x32_bf16 v[140:143], v[196:199], v[68:71], v[140:143]
    ds_read_b64_tr_b16 v[190:191], v234 offset:53760
    s_add_u32 s44, s51, 65664
    s_and_b32 s44, s44, 0x7ffff
    s_waitcnt lgkmcnt(8)
    v_mfma_f32_16x16x32_bf16 v[144:147], v[200:203], v[40:43], v[144:147]
    ds_read_b64_tr_b16 v[192:193], v234 offset:57344
    buffer_load_dwordx4 v245, s[20:23], s44 offen lds
    s_add_u32 m0, s45, 143360
    v_mfma_f32_16x16x32_bf16 v[144:147], v[204:207], v[48:51], v[144:147]
    ds_read_b64_tr_b16 v[194:195], v234 offset:57856
    s_add_u32 s44, s51, 98432
    s_and_b32 s44, s44, 0x7ffff
    s_waitcnt lgkmcnt(6)
    v_mfma_f32_16x16x32_bf16 v[144:147], v[208:211], v[56:59], v[144:147]
    ds_read_b64_tr_b16 v[196:197], v234 offset:61440
    buffer_load_dwordx4 v245, s[20:23], s44 offen lds
    s_add_u32 m0, s45, 81920
    s_add_u32 s44, s51, 393600
    v_mfma_f32_16x16x32_bf16 v[144:147], v[212:215], v[64:67], v[144:147]
    ds_read_b64_tr_b16 v[198:199], v234 offset:61952
    s_and_b32 s44, s44, 0x7ffff
    buffer_load_dwordx4 v245, s[20:23], s44 offen lds
    v_mfma_f32_16x16x32_bf16 v[148:151], v[200:203], v[44:47], v[148:151]
    ds_read_b64_tr_b16 v[200:201], v235 offset:49152
    s_add_u32 m0, s45, 86016
    s_add_u32 s44, s51, 426368
    v_mfma_f32_16x16x32_bf16 v[148:151], v[204:207], v[52:55], v[148:151]
    ds_read_b64_tr_b16 v[202:203], v235 offset:49664
    s_and_b32 s44, s44, 0x7ffff
    buffer_load_dwordx4 v245, s[20:23], s44 offen lds
    v_mfma_f32_16x16x32_bf16 v[148:151], v[208:211], v[60:63], v[148:151]
    ds_read_b64_tr_b16 v[204:205], v235 offset:53248
    s_add_u32 m0, s45, 90112
    s_add_u32 s44, s51, 459136
    v_mfma_f32_16x16x32_bf16 v[148:151], v[212:215], v[68:71], v[148:151]
    ds_read_b64_tr_b16 v[206:207], v235 offset:53760
    s_and_b32 s44, s44, 0x7ffff
    buffer_load_dwordx4 v245, s[20:23], s44 offen lds
    s_waitcnt lgkmcnt(8)
    v_mfma_f32_16x16x32_bf16 v[152:155], v[184:187], v[40:43], v[152:155]
    ds_read_b64_tr_b16 v[208:209], v235 offset:57344
    s_add_u32 m0, s45, 94208
    s_add_u32 s44, s51, 491904
    v_mfma_f32_16x16x32_bf16 v[152:155], v[188:191], v[48:51], v[152:155]
    ds_read_b64_tr_b16 v[210:211], v235 offset:57856
    s_and_b32 s44, s44, 0x7ffff
    buffer_load_dwordx4 v245, s[20:23], s44 offen lds
    s_waitcnt lgkmcnt(6)
    v_mfma_f32_16x16x32_bf16 v[152:155], v[192:195], v[56:59], v[152:155]
    ds_read_b64_tr_b16 v[212:213], v235 offset:61440
    v_mfma_f32_16x16x32_bf16 v[152:155], v[196:199], v[64:67], v[152:155]
    ds_read_b64_tr_b16 v[214:215], v235 offset:61952
    v_mfma_f32_16x16x32_bf16 v[156:159], v[184:187], v[44:47], v[156:159]
    ds_read_b64_tr_b16 v[184:185], v232 offset:0
    v_mfma_f32_16x16x32_bf16 v[156:159], v[188:191], v[52:55], v[156:159]
    ds_read_b64_tr_b16 v[186:187], v232 offset:512
    v_mfma_f32_16x16x32_bf16 v[156:159], v[192:195], v[60:63], v[156:159]
    ds_read_b64_tr_b16 v[188:189], v232 offset:4096
    v_mfma_f32_16x16x32_bf16 v[156:159], v[196:199], v[68:71], v[156:159]
    ds_read_b64_tr_b16 v[190:191], v232 offset:4608
    s_waitcnt lgkmcnt(8)
    v_mfma_f32_16x16x32_bf16 v[160:163], v[200:203], v[40:43], v[160:163]
    ds_read_b64_tr_b16 v[192:193], v232 offset:8192
    v_mfma_f32_16x16x32_bf16 v[160:163], v[204:207], v[48:51], v[160:163]
    ds_read_b64_tr_b16 v[194:195], v232 offset:8704
    s_waitcnt lgkmcnt(6)
    v_mfma_f32_16x16x32_bf16 v[160:163], v[208:211], v[56:59], v[160:163]
    ds_read_b64_tr_b16 v[196:197], v232 offset:12288
    v_mfma_f32_16x16x32_bf16 v[160:163], v[212:215], v[64:67], v[160:163]
    ds_read_b64_tr_b16 v[198:199], v232 offset:12800
    v_mfma_f32_16x16x32_bf16 v[164:167], v[200:203], v[44:47], v[164:167]
    ds_read_b64_tr_b16 v[200:201], v233 offset:0
    v_mfma_f32_16x16x32_bf16 v[164:167], v[204:207], v[52:55], v[164:167]
    ds_read_b64_tr_b16 v[202:203], v233 offset:512
    v_mfma_f32_16x16x32_bf16 v[164:167], v[208:211], v[60:63], v[164:167]
    ds_read_b64_tr_b16 v[204:205], v233 offset:4096
    v_mfma_f32_16x16x32_bf16 v[164:167], v[212:215], v[68:71], v[164:167]
    ds_read_b64_tr_b16 v[206:207], v233 offset:4608
    s_waitcnt vmcnt(16)
    s_barrier
    s_waitcnt lgkmcnt(8)
    v_mfma_f32_16x16x32_bf16 v[136:139], v[184:187], v[72:75], v[136:139]
    ds_read_b64_tr_b16 v[208:209], v233 offset:8192
    v_mfma_f32_16x16x32_bf16 v[136:139], v[188:191], v[80:83], v[136:139]
    ds_read_b64_tr_b16 v[210:211], v233 offset:8704
    s_waitcnt lgkmcnt(6)
    v_mfma_f32_16x16x32_bf16 v[136:139], v[192:195], v[88:91], v[136:139]
    ds_read_b64_tr_b16 v[212:213], v233 offset:12288
    v_mfma_f32_16x16x32_bf16 v[136:139], v[196:199], v[96:99], v[136:139]
    ds_read_b64_tr_b16 v[214:215], v233 offset:12800
    s_add_u32 m0, s45, 147456
    s_add_u32 s44, s51, 131200
    v_mfma_f32_16x16x32_bf16 v[140:143], v[184:187], v[76:79], v[140:143]
    ds_read_b64_tr_b16 v[184:185], v234 offset:0
    s_and_b32 s44, s44, 0x7ffff
    v_mfma_f32_16x16x32_bf16 v[140:143], v[188:191], v[84:87], v[140:143]
    ds_read_b64_tr_b16 v[186:187], v234 offset:512
    buffer_load_dwordx4 v245, s[20:23], s44 offen lds
    v_mfma_f32_16x16x32_bf16 v[140:143], v[192:195], v[92:95], v[140:143]
    ds_read_b64_tr_b16 v[188:189], v234 offset:4096
    s_add_u32 m0, s45, 151552
    v_mfma_f32_16x16x32_bf16 v[140:143], v[196:199], v[100:103], v[140:143]
    ds_read_b64_tr_b16 v[190:191], v234 offset:4608
    s_add_u32 s44, s51, 163968
    s_waitcnt lgkmcnt(8)
    v_mfma_f32_16x16x32_bf16 v[144:147], v[200:203], v[72:75], v[144:147]
    ds_read_b64_tr_b16 v[192:193], v234 offset:8192
    s_and_b32 s44, s44, 0x7ffff
    v_mfma_f32_16x16x32_bf16 v[144:147], v[204:207], v[80:83], v[144:147]
    ds_read_b64_tr_b16 v[194:195], v234 offset:8704
    buffer_load_dwordx4 v245, s[20:23], s44 offen lds
    s_waitcnt lgkmcnt(6)
    v_mfma_f32_16x16x32_bf16 v[144:147], v[208:211], v[88:91], v[144:147]
    ds_read_b64_tr_b16 v[196:197], v234 offset:12288
    s_add_u32 m0, s45, 155648
    s_add_u32 s44, s51, 196736
    v_mfma_f32_16x16x32_bf16 v[144:147], v[212:215], v[96:99], v[144:147]
    ds_read_b64_tr_b16 v[198:199], v234 offset:12800
    s_and_b32 s44, s44, 0x7ffff
    v_mfma_f32_16x16x32_bf16 v[148:151], v[200:203], v[76:79], v[148:151]
    ds_read_b64_tr_b16 v[200:201], v235 offset:0
    buffer_load_dwordx4 v245, s[20:23], s44 offen lds
    v_mfma_f32_16x16x32_bf16 v[148:151], v[204:207], v[84:87], v[148:151]
    ds_read_b64_tr_b16 v[202:203], v235 offset:512
    s_add_u32 m0, s45, 159744
    v_mfma_f32_16x16x32_bf16 v[148:151], v[208:211], v[92:95], v[148:151]
    ds_read_b64_tr_b16 v[204:205], v235 offset:4096
    s_add_u32 s44, s51, 229504
    v_mfma_f32_16x16x32_bf16 v[148:151], v[212:215], v[100:103], v[148:151]
    ds_read_b64_tr_b16 v[206:207], v235 offset:4608
    s_and_b32 s44, s44, 0x7ffff
    s_waitcnt lgkmcnt(8)
    v_mfma_f32_16x16x32_bf16 v[152:155], v[184:187], v[72:75], v[152:155]
    ds_read_b64_tr_b16 v[208:209], v235 offset:8192
    buffer_load_dwordx4 v245, s[20:23], s44 offen lds
    v_mfma_f32_16x16x32_bf16 v[152:155], v[188:191], v[80:83], v[152:155]
    buffer_load_dword v241, v252, s[76:79], 0 offen sc1
    ds_read_b64_tr_b16 v[210:211], v235 offset:8704
    s_waitcnt lgkmcnt(6)
    v_mfma_f32_16x16x32_bf16 v[152:155], v[192:195], v[88:91], v[152:155]
    ds_read_b64_tr_b16 v[212:213], v235 offset:12288
    v_mfma_f32_16x16x32_bf16 v[152:155], v[196:199], v[96:99], v[152:155]
    ds_read_b64_tr_b16 v[214:215], v235 offset:12800
    v_mfma_f32_16x16x32_bf16 v[156:159], v[184:187], v[76:79], v[156:159]
    ds_read_b64_tr_b16 v[184:185], v232 offset:16384
    v_mfma_f32_16x16x32_bf16 v[156:159], v[188:191], v[84:87], v[156:159]
    ds_read_b64_tr_b16 v[186:187], v232 offset:16896
    v_mfma_f32_16x16x32_bf16 v[156:159], v[192:195], v[92:95], v[156:159]
    ds_read_b64_tr_b16 v[188:189], v232 offset:20480
    v_mfma_f32_16x16x32_bf16 v[156:159], v[196:199], v[100:103], v[156:159]
    ds_read_b64_tr_b16 v[190:191], v232 offset:20992
    s_waitcnt lgkmcnt(8)
    v_mfma_f32_16x16x32_bf16 v[160:163], v[200:203], v[72:75], v[160:163]
    ds_read_b64_tr_b16 v[192:193], v232 offset:24576
    v_mfma_f32_16x16x32_bf16 v[160:163], v[204:207], v[80:83], v[160:163]
    ds_read_b64_tr_b16 v[194:195], v232 offset:25088
    s_waitcnt lgkmcnt(6)
    v_mfma_f32_16x16x32_bf16 v[160:163], v[208:211], v[88:91], v[160:163]
    ds_read_b64_tr_b16 v[196:197], v232 offset:28672
    v_mfma_f32_16x16x32_bf16 v[160:163], v[212:215], v[96:99], v[160:163]
    ds_read_b64_tr_b16 v[198:199], v232 offset:29184
    v_mfma_f32_16x16x32_bf16 v[164:167], v[200:203], v[76:79], v[164:167]
    ds_read_b64_tr_b16 v[200:201], v233 offset:16384
    v_mfma_f32_16x16x32_bf16 v[164:167], v[204:207], v[84:87], v[164:167]
    ds_read_b64_tr_b16 v[202:203], v233 offset:16896
    v_mfma_f32_16x16x32_bf16 v[164:167], v[208:211], v[92:95], v[164:167]
    ds_read_b64_tr_b16 v[204:205], v233 offset:20480
    v_mfma_f32_16x16x32_bf16 v[164:167], v[212:215], v[100:103], v[164:167]
    ds_read_b64_tr_b16 v[206:207], v233 offset:20992
    s_waitcnt vmcnt(9)
    s_barrier
    ds_read_b128 v[104:107], v247 offset:0
    ds_read_b128 v[108:111], v247 offset:1024
    ds_read_b128 v[112:115], v247 offset:2048
    ds_read_b128 v[116:119], v247 offset:3072
    ds_read_b128 v[120:123], v247 offset:4096
    ds_read_b128 v[124:127], v247 offset:5120
    ds_read_b128 v[128:131], v247 offset:6144
    ds_read_b128 v[132:135], v247 offset:7168
    s_waitcnt lgkmcnt(7)
    v_mfma_f32_16x16x32_bf16 v[136:139], v[184:187], v[104:107], v[136:139]
    ds_read_b64_tr_b16 v[208:209], v233 offset:24576
    s_waitcnt lgkmcnt(6)
    v_mfma_f32_16x16x32_bf16 v[136:139], v[188:191], v[112:115], v[136:139]
    ds_read_b64_tr_b16 v[210:211], v233 offset:25088
    s_waitcnt lgkmcnt(5)
    v_mfma_f32_16x16x32_bf16 v[136:139], v[192:195], v[120:123], v[136:139]
    ds_read_b64_tr_b16 v[212:213], v233 offset:28672
    s_waitcnt lgkmcnt(4)
    v_mfma_f32_16x16x32_bf16 v[136:139], v[196:199], v[128:131], v[136:139]
    ds_read_b64_tr_b16 v[214:215], v233 offset:29184
    v_mfma_f32_16x16x32_bf16 v[140:143], v[184:187], v[108:111], v[140:143]
    ds_read_b64_tr_b16 v[184:185], v234 offset:16384
    v_mfma_f32_16x16x32_bf16 v[140:143], v[188:191], v[116:119], v[140:143]
    ds_read_b64_tr_b16 v[186:187], v234 offset:16896
    v_mfma_f32_16x16x32_bf16 v[140:143], v[192:195], v[124:127], v[140:143]
    ds_read_b64_tr_b16 v[188:189], v234 offset:20480
    s_waitcnt lgkmcnt(7)
    v_mfma_f32_16x16x32_bf16 v[140:143], v[196:199], v[132:135], v[140:143]
    ds_read_b64_tr_b16 v[190:191], v234 offset:20992
    v_mfma_f32_16x16x32_bf16 v[144:147], v[200:203], v[104:107], v[144:147]
    ds_read_b64_tr_b16 v[192:193], v234 offset:24576
    v_mfma_f32_16x16x32_bf16 v[144:147], v[204:207], v[112:115], v[144:147]
    ds_read_b64_tr_b16 v[194:195], v234 offset:25088
    s_waitcnt lgkmcnt(6)
    v_mfma_f32_16x16x32_bf16 v[144:147], v[208:211], v[120:123], v[144:147]
    ds_read_b64_tr_b16 v[196:197], v234 offset:28672
    v_mfma_f32_16x16x32_bf16 v[144:147], v[212:215], v[128:131], v[144:147]
    ds_read_b64_tr_b16 v[198:199], v234 offset:29184
    v_mfma_f32_16x16x32_bf16 v[148:151], v[200:203], v[108:111], v[148:151]
    ds_read_b64_tr_b16 v[200:201], v235 offset:16384
    v_mfma_f32_16x16x32_bf16 v[148:151], v[204:207], v[116:119], v[148:151]
    ds_read_b64_tr_b16 v[202:203], v235 offset:16896
    s_add_u32 s52, s50, 0
    v_mfma_f32_16x16x32_bf16 v[148:151], v[208:211], v[124:127], v[148:151]
    ds_read_b64_tr_b16 v[204:205], v235 offset:20480
    v_cvt_pk_bf16_f32 v136, v136, v137
    v_mfma_f32_16x16x32_bf16 v[148:151], v[212:215], v[132:135], v[148:151]
    ds_read_b64_tr_b16 v[206:207], v235 offset:20992
    v_cvt_pk_bf16_f32 v137, v138, v139
    s_waitcnt lgkmcnt(8)
    v_mfma_f32_16x16x32_bf16 v[152:155], v[184:187], v[104:107], v[152:155]
    ds_read_b64_tr_b16 v[208:209], v235 offset:24576
    v_cvt_pk_bf16_f32 v138, v144, v145
    v_mfma_f32_16x16x32_bf16 v[152:155], v[188:191], v[112:115], v[152:155]
    ds_read_b64_tr_b16 v[210:211], v235 offset:25088
    v_cvt_pk_bf16_f32 v139, v146, v147
    s_waitcnt lgkmcnt(6)
    v_mfma_f32_16x16x32_bf16 v[152:155], v[192:195], v[120:123], v[152:155]
    ds_read_b64_tr_b16 v[212:213], v235 offset:28672
    buffer_store_dwordx4 v[136:139], v252, s[32:35], s52 offen sc1
    v_mfma_f32_16x16x32_bf16 v[152:155], v[196:199], v[128:131], v[152:155]
    ds_read_b64_tr_b16 v[214:215], v235 offset:29184
    v_mfma_f32_16x16x32_bf16 v[156:159], v[184:187], v[108:111], v[156:159]
    ds_read_b64_tr_b16 v[184:185], v232 offset:32768
    v_mfma_f32_16x16x32_bf16 v[156:159], v[188:191], v[116:119], v[156:159]
    ds_read_b64_tr_b16 v[186:187], v232 offset:33280
    v_mfma_f32_16x16x32_bf16 v[156:159], v[192:195], v[124:127], v[156:159]
    ds_read_b64_tr_b16 v[188:189], v232 offset:36864
    v_cvt_pk_bf16_f32 v140, v140, v141
    v_mfma_f32_16x16x32_bf16 v[156:159], v[196:199], v[132:135], v[156:159]
    ds_read_b64_tr_b16 v[190:191], v232 offset:37376
    v_cvt_pk_bf16_f32 v141, v142, v143
    s_waitcnt lgkmcnt(8)
    v_mfma_f32_16x16x32_bf16 v[160:163], v[200:203], v[104:107], v[160:163]
    ds_read_b64_tr_b16 v[192:193], v232 offset:40960
    v_cvt_pk_bf16_f32 v142, v148, v149
    v_mfma_f32_16x16x32_bf16 v[160:163], v[204:207], v[112:115], v[160:163]
    ds_read_b64_tr_b16 v[194:195], v232 offset:41472
    v_cvt_pk_bf16_f32 v143, v150, v151
    s_waitcnt lgkmcnt(6)
    v_mfma_f32_16x16x32_bf16 v[160:163], v[208:211], v[120:123], v[160:163]
    ds_read_b64_tr_b16 v[196:197], v232 offset:45056
    buffer_store_dwordx4 v[140:143], v252, s[32:35], s52 offen offset:2048 sc1
    v_mfma_f32_16x16x32_bf16 v[160:163], v[212:215], v[128:131], v[160:163]
    ds_read_b64_tr_b16 v[198:199], v232 offset:45568
    v_mfma_f32_16x16x32_bf16 v[164:167], v[200:203], v[108:111], v[164:167]
    ds_read_b64_tr_b16 v[200:201], v233 offset:32768
    v_mfma_f32_16x16x32_bf16 v[164:167], v[204:207], v[116:119], v[164:167]
    ds_read_b64_tr_b16 v[202:203], v233 offset:33280
    v_mfma_f32_16x16x32_bf16 v[164:167], v[208:211], v[124:127], v[164:167]
    ds_read_b64_tr_b16 v[204:205], v233 offset:36864
    v_cvt_pk_bf16_f32 v152, v152, v153
    v_mfma_f32_16x16x32_bf16 v[164:167], v[212:215], v[132:135], v[164:167]
    ds_read_b64_tr_b16 v[206:207], v233 offset:37376
    v_cvt_pk_bf16_f32 v153, v154, v155
    s_waitcnt lgkmcnt(8)
    v_mfma_f32_16x16x32_bf16 v[136:139], v[184:187], v[8:11], 0
    ds_read_b64_tr_b16 v[208:209], v233 offset:40960
    v_cvt_pk_bf16_f32 v154, v160, v161
    v_mfma_f32_16x16x32_bf16 v[136:139], v[188:191], v[16:19], v[136:139]
    ds_read_b64_tr_b16 v[210:211], v233 offset:41472
    v_cvt_pk_bf16_f32 v155, v162, v163
    s_waitcnt lgkmcnt(6)
    v_mfma_f32_16x16x32_bf16 v[136:139], v[192:195], v[24:27], v[136:139]
    ds_read_b64_tr_b16 v[212:213], v233 offset:45056
    buffer_store_dwordx4 v[152:155], v252, s[32:35], s52 offen offset:1024 sc1
    v_mfma_f32_16x16x32_bf16 v[136:139], v[196:199], v[32:35], v[136:139]
    ds_read_b64_tr_b16 v[214:215], v233 offset:45568
    s_waitcnt vmcnt(4)
    s_barrier
    v_mfma_f32_16x16x32_bf16 v[140:143], v[184:187], v[12:15], 0
    ds_read_b64_tr_b16 v[184:185], v234 offset:32768
    v_mfma_f32_16x16x32_bf16 v[140:143], v[188:191], v[20:23], v[140:143]
    ds_read_b64_tr_b16 v[186:187], v234 offset:33280
    v_mfma_f32_16x16x32_bf16 v[140:143], v[192:195], v[28:31], v[140:143]
    ds_read_b64_tr_b16 v[188:189], v234 offset:36864
    v_cvt_pk_bf16_f32 v156, v156, v157
    v_mfma_f32_16x16x32_bf16 v[140:143], v[196:199], v[36:39], v[140:143]
    ds_read_b64_tr_b16 v[190:191], v234 offset:37376
    v_cvt_pk_bf16_f32 v157, v158, v159
    s_waitcnt lgkmcnt(8)
    v_mfma_f32_16x16x32_bf16 v[144:147], v[200:203], v[8:11], 0
    ds_read_b64_tr_b16 v[192:193], v234 offset:40960
    v_cvt_pk_bf16_f32 v158, v164, v165
    v_mfma_f32_16x16x32_bf16 v[144:147], v[204:207], v[16:19], v[144:147]
    ds_read_b64_tr_b16 v[194:195], v234 offset:41472
    v_cvt_pk_bf16_f32 v159, v166, v167
    s_waitcnt lgkmcnt(6)
    v_mfma_f32_16x16x32_bf16 v[144:147], v[208:211], v[24:27], v[144:147]
    ds_read_b64_tr_b16 v[196:197], v234 offset:45056
    buffer_store_dwordx4 v[156:159], v252, s[32:35], s52 offen offset:3072 sc1
    v_mfma_f32_16x16x32_bf16 v[144:147], v[212:215], v[32:35], v[144:147]
    ds_read_b64_tr_b16 v[198:199], v234 offset:45568
    v_mfma_f32_16x16x32_bf16 v[148:151], v[200:203], v[12:15], 0
    ds_read_b64_tr_b16 v[200:201], v235 offset:32768
    v_mfma_f32_16x16x32_bf16 v[148:151], v[204:207], v[20:23], v[148:151]
    ds_read_b64_tr_b16 v[202:203], v235 offset:33280
    v_mfma_f32_16x16x32_bf16 v[148:151], v[208:211], v[28:31], v[148:151]
    ds_read_b64_tr_b16 v[204:205], v235 offset:36864
    v_mfma_f32_16x16x32_bf16 v[148:151], v[212:215], v[36:39], v[148:151]
    ds_read_b64_tr_b16 v[206:207], v235 offset:37376
    s_waitcnt lgkmcnt(8)
    v_mfma_f32_16x16x32_bf16 v[152:155], v[184:187], v[8:11], 0
    ds_read_b64_tr_b16 v[208:209], v235 offset:40960
    v_mfma_f32_16x16x32_bf16 v[152:155], v[188:191], v[16:19], v[152:155]
    ds_read_b64_tr_b16 v[210:211], v235 offset:41472
    s_waitcnt lgkmcnt(6)
    v_mfma_f32_16x16x32_bf16 v[152:155], v[192:195], v[24:27], v[152:155]
    ds_read_b64_tr_b16 v[212:213], v235 offset:45056
    v_mfma_f32_16x16x32_bf16 v[152:155], v[196:199], v[32:35], v[152:155]
    ds_read_b64_tr_b16 v[214:215], v235 offset:45568
    v_mfma_f32_16x16x32_bf16 v[156:159], v[184:187], v[12:15], 0
    ds_read_b64_tr_b16 v[184:185], v232 offset:49152
    v_mfma_f32_16x16x32_bf16 v[156:159], v[188:191], v[20:23], v[156:159]
    ds_read_b64_tr_b16 v[186:187], v232 offset:49664
    v_mfma_f32_16x16x32_bf16 v[156:159], v[192:195], v[28:31], v[156:159]
    ds_read_b64_tr_b16 v[188:189], v232 offset:53248
    v_mfma_f32_16x16x32_bf16 v[156:159], v[196:199], v[36:39], v[156:159]
    ds_read_b64_tr_b16 v[190:191], v232 offset:53760
    s_waitcnt lgkmcnt(8)
    v_mfma_f32_16x16x32_bf16 v[160:163], v[200:203], v[8:11], 0
    ds_read_b64_tr_b16 v[192:193], v232 offset:57344
    v_mfma_f32_16x16x32_bf16 v[160:163], v[204:207], v[16:19], v[160:163]
    ds_read_b64_tr_b16 v[194:195], v232 offset:57856
    s_waitcnt lgkmcnt(6)
    v_mfma_f32_16x16x32_bf16 v[160:163], v[208:211], v[24:27], v[160:163]
    ds_read_b64_tr_b16 v[196:197], v232 offset:61440
    v_mfma_f32_16x16x32_bf16 v[160:163], v[212:215], v[32:35], v[160:163]
    ds_read_b64_tr_b16 v[198:199], v232 offset:61952
    v_mfma_f32_16x16x32_bf16 v[164:167], v[200:203], v[12:15], 0
    ds_read_b64_tr_b16 v[200:201], v233 offset:49152
    v_mfma_f32_16x16x32_bf16 v[164:167], v[204:207], v[20:23], v[164:167]
    ds_read_b64_tr_b16 v[202:203], v233 offset:49664
    v_mfma_f32_16x16x32_bf16 v[164:167], v[208:211], v[28:31], v[164:167]
    ds_read_b64_tr_b16 v[204:205], v233 offset:53248
    v_mfma_f32_16x16x32_bf16 v[164:167], v[212:215], v[36:39], v[164:167]
    ds_read_b64_tr_b16 v[206:207], v233 offset:53760
    s_waitcnt lgkmcnt(8)
    v_mfma_f32_16x16x32_bf16 v[136:139], v[184:187], v[40:43], v[136:139]
    ds_read_b64_tr_b16 v[208:209], v233 offset:57344
    v_mfma_f32_16x16x32_bf16 v[136:139], v[188:191], v[48:51], v[136:139]
    ds_read_b64_tr_b16 v[210:211], v233 offset:57856
    s_waitcnt lgkmcnt(6)
    v_mfma_f32_16x16x32_bf16 v[136:139], v[192:195], v[56:59], v[136:139]
    ds_read_b64_tr_b16 v[212:213], v233 offset:61440
    v_mfma_f32_16x16x32_bf16 v[136:139], v[196:199], v[64:67], v[136:139]
    ds_read_b64_tr_b16 v[214:215], v233 offset:61952
    s_barrier
    v_mfma_f32_16x16x32_bf16 v[140:143], v[184:187], v[44:47], v[140:143]
    ds_read_b64_tr_b16 v[184:185], v234 offset:49152
    v_mfma_f32_16x16x32_bf16 v[140:143], v[188:191], v[52:55], v[140:143]
    ds_read_b64_tr_b16 v[186:187], v234 offset:49664
    v_mfma_f32_16x16x32_bf16 v[140:143], v[192:195], v[60:63], v[140:143]
    ds_read_b64_tr_b16 v[188:189], v234 offset:53248
    v_mfma_f32_16x16x32_bf16 v[140:143], v[196:199], v[68:71], v[140:143]
    ds_read_b64_tr_b16 v[190:191], v234 offset:53760
    s_waitcnt lgkmcnt(8)
    v_mfma_f32_16x16x32_bf16 v[144:147], v[200:203], v[40:43], v[144:147]
    ds_read_b64_tr_b16 v[192:193], v234 offset:57344
    v_mfma_f32_16x16x32_bf16 v[144:147], v[204:207], v[48:51], v[144:147]
    ds_read_b64_tr_b16 v[194:195], v234 offset:57856
    s_waitcnt lgkmcnt(6)
    v_mfma_f32_16x16x32_bf16 v[144:147], v[208:211], v[56:59], v[144:147]
    ds_read_b64_tr_b16 v[196:197], v234 offset:61440
    v_mfma_f32_16x16x32_bf16 v[144:147], v[212:215], v[64:67], v[144:147]
    ds_read_b64_tr_b16 v[198:199], v234 offset:61952
    v_mfma_f32_16x16x32_bf16 v[148:151], v[200:203], v[44:47], v[148:151]
    ds_read_b64_tr_b16 v[200:201], v235 offset:49152
    v_mfma_f32_16x16x32_bf16 v[148:151], v[204:207], v[52:55], v[148:151]
    ds_read_b64_tr_b16 v[202:203], v235 offset:49664
    v_mfma_f32_16x16x32_bf16 v[148:151], v[208:211], v[60:63], v[148:151]
    ds_read_b64_tr_b16 v[204:205], v235 offset:53248
    v_mfma_f32_16x16x32_bf16 v[148:151], v[212:215], v[68:71], v[148:151]
    ds_read_b64_tr_b16 v[206:207], v235 offset:53760
    s_waitcnt lgkmcnt(8)
    v_mfma_f32_16x16x32_bf16 v[152:155], v[184:187], v[40:43], v[152:155]
    ds_read_b64_tr_b16 v[208:209], v235 offset:57344
    v_mfma_f32_16x16x32_bf16 v[152:155], v[188:191], v[48:51], v[152:155]
    ds_read_b64_tr_b16 v[210:211], v235 offset:57856
    s_waitcnt lgkmcnt(6)
    v_mfma_f32_16x16x32_bf16 v[152:155], v[192:195], v[56:59], v[152:155]
    ds_read_b64_tr_b16 v[212:213], v235 offset:61440
    v_mfma_f32_16x16x32_bf16 v[152:155], v[196:199], v[64:67], v[152:155]
    ds_read_b64_tr_b16 v[214:215], v235 offset:61952
    v_mfma_f32_16x16x32_bf16 v[156:159], v[184:187], v[44:47], v[156:159]
    ds_read_b64_tr_b16 v[184:185], v236 offset:0
    v_mfma_f32_16x16x32_bf16 v[156:159], v[188:191], v[52:55], v[156:159]
    ds_read_b64_tr_b16 v[186:187], v236 offset:512
    v_mfma_f32_16x16x32_bf16 v[156:159], v[192:195], v[60:63], v[156:159]
    ds_read_b64_tr_b16 v[188:189], v236 offset:4096
    v_mfma_f32_16x16x32_bf16 v[156:159], v[196:199], v[68:71], v[156:159]
    ds_read_b64_tr_b16 v[190:191], v236 offset:4608
    s_waitcnt lgkmcnt(8)
    v_mfma_f32_16x16x32_bf16 v[160:163], v[200:203], v[40:43], v[160:163]
    ds_read_b64_tr_b16 v[192:193], v236 offset:8192
    v_mfma_f32_16x16x32_bf16 v[160:163], v[204:207], v[48:51], v[160:163]
    ds_read_b64_tr_b16 v[194:195], v236 offset:8704
    s_waitcnt lgkmcnt(6)
    v_mfma_f32_16x16x32_bf16 v[160:163], v[208:211], v[56:59], v[160:163]
    ds_read_b64_tr_b16 v[196:197], v236 offset:12288
    v_mfma_f32_16x16x32_bf16 v[160:163], v[212:215], v[64:67], v[160:163]
    ds_read_b64_tr_b16 v[198:199], v236 offset:12800
    v_mfma_f32_16x16x32_bf16 v[164:167], v[200:203], v[44:47], v[164:167]
    ds_read_b64_tr_b16 v[200:201], v237 offset:0
    v_mfma_f32_16x16x32_bf16 v[164:167], v[204:207], v[52:55], v[164:167]
    ds_read_b64_tr_b16 v[202:203], v237 offset:512
    v_mfma_f32_16x16x32_bf16 v[164:167], v[208:211], v[60:63], v[164:167]
    ds_read_b64_tr_b16 v[204:205], v237 offset:4096
    v_mfma_f32_16x16x32_bf16 v[164:167], v[212:215], v[68:71], v[164:167]
    ds_read_b64_tr_b16 v[206:207], v237 offset:4608
    s_waitcnt lgkmcnt(8)
    v_mfma_f32_16x16x32_bf16 v[136:139], v[184:187], v[72:75], v[136:139]
    ds_read_b64_tr_b16 v[208:209], v237 offset:8192
    v_mfma_f32_16x16x32_bf16 v[136:139], v[188:191], v[80:83], v[136:139]
    ds_read_b64_tr_b16 v[210:211], v237 offset:8704
    s_waitcnt lgkmcnt(6)
    v_mfma_f32_16x16x32_bf16 v[136:139], v[192:195], v[88:91], v[136:139]
    ds_read_b64_tr_b16 v[212:213], v237 offset:12288
    v_mfma_f32_16x16x32_bf16 v[136:139], v[196:199], v[96:99], v[136:139]
    ds_read_b64_tr_b16 v[214:215], v237 offset:12800
    s_barrier
    v_mfma_f32_16x16x32_bf16 v[140:143], v[184:187], v[76:79], v[140:143]
    ds_read_b64_tr_b16 v[184:185], v238 offset:0
    v_mfma_f32_16x16x32_bf16 v[140:143], v[188:191], v[84:87], v[140:143]
    ds_read_b64_tr_b16 v[186:187], v238 offset:512
    v_mfma_f32_16x16x32_bf16 v[140:143], v[192:195], v[92:95], v[140:143]
    ds_read_b64_tr_b16 v[188:189], v238 offset:4096
    v_mfma_f32_16x16x32_bf16 v[140:143], v[196:199], v[100:103], v[140:143]
    ds_read_b64_tr_b16 v[190:191], v238 offset:4608
    s_waitcnt lgkmcnt(8)
    v_mfma_f32_16x16x32_bf16 v[144:147], v[200:203], v[72:75], v[144:147]
    ds_read_b64_tr_b16 v[192:193], v238 offset:8192
    v_mfma_f32_16x16x32_bf16 v[144:147], v[204:207], v[80:83], v[144:147]
    ds_read_b64_tr_b16 v[194:195], v238 offset:8704
    s_waitcnt lgkmcnt(6)
    v_mfma_f32_16x16x32_bf16 v[144:147], v[208:211], v[88:91], v[144:147]
    ds_read_b64_tr_b16 v[196:197], v238 offset:12288
    v_mfma_f32_16x16x32_bf16 v[144:147], v[212:215], v[96:99], v[144:147]
    ds_read_b64_tr_b16 v[198:199], v238 offset:12800
    v_mfma_f32_16x16x32_bf16 v[148:151], v[200:203], v[76:79], v[148:151]
    ds_read_b64_tr_b16 v[200:201], v239 offset:0
    v_mfma_f32_16x16x32_bf16 v[148:151], v[204:207], v[84:87], v[148:151]
    ds_read_b64_tr_b16 v[202:203], v239 offset:512
    v_mfma_f32_16x16x32_bf16 v[148:151], v[208:211], v[92:95], v[148:151]
    ds_read_b64_tr_b16 v[204:205], v239 offset:4096
    v_mfma_f32_16x16x32_bf16 v[148:151], v[212:215], v[100:103], v[148:151]
    ds_read_b64_tr_b16 v[206:207], v239 offset:4608
    s_waitcnt lgkmcnt(8)
    v_mfma_f32_16x16x32_bf16 v[152:155], v[184:187], v[72:75], v[152:155]
    ds_read_b64_tr_b16 v[208:209], v239 offset:8192
    v_mfma_f32_16x16x32_bf16 v[152:155], v[188:191], v[80:83], v[152:155]
    ds_read_b64_tr_b16 v[210:211], v239 offset:8704
    s_waitcnt lgkmcnt(6)
    v_mfma_f32_16x16x32_bf16 v[152:155], v[192:195], v[88:91], v[152:155]
    ds_read_b64_tr_b16 v[212:213], v239 offset:12288
    v_mfma_f32_16x16x32_bf16 v[152:155], v[196:199], v[96:99], v[152:155]
    ds_read_b64_tr_b16 v[214:215], v239 offset:12800
    v_mfma_f32_16x16x32_bf16 v[156:159], v[184:187], v[76:79], v[156:159]
    ds_read_b64_tr_b16 v[184:185], v236 offset:16384
    v_mfma_f32_16x16x32_bf16 v[156:159], v[188:191], v[84:87], v[156:159]
    ds_read_b64_tr_b16 v[186:187], v236 offset:16896
    v_mfma_f32_16x16x32_bf16 v[156:159], v[192:195], v[92:95], v[156:159]
    ds_read_b64_tr_b16 v[188:189], v236 offset:20480
    v_mfma_f32_16x16x32_bf16 v[156:159], v[196:199], v[100:103], v[156:159]
    ds_read_b64_tr_b16 v[190:191], v236 offset:20992
    s_waitcnt lgkmcnt(8)
    v_mfma_f32_16x16x32_bf16 v[160:163], v[200:203], v[72:75], v[160:163]
    ds_read_b64_tr_b16 v[192:193], v236 offset:24576
    v_mfma_f32_16x16x32_bf16 v[160:163], v[204:207], v[80:83], v[160:163]
    ds_read_b64_tr_b16 v[194:195], v236 offset:25088
    s_waitcnt lgkmcnt(6)
    v_mfma_f32_16x16x32_bf16 v[160:163], v[208:211], v[88:91], v[160:163]
    ds_read_b64_tr_b16 v[196:197], v236 offset:28672
    v_mfma_f32_16x16x32_bf16 v[160:163], v[212:215], v[96:99], v[160:163]
    ds_read_b64_tr_b16 v[198:199], v236 offset:29184
    v_mfma_f32_16x16x32_bf16 v[164:167], v[200:203], v[76:79], v[164:167]
    ds_read_b64_tr_b16 v[200:201], v237 offset:16384
    v_mfma_f32_16x16x32_bf16 v[164:167], v[204:207], v[84:87], v[164:167]
    ds_read_b64_tr_b16 v[202:203], v237 offset:16896
    v_mfma_f32_16x16x32_bf16 v[164:167], v[208:211], v[92:95], v[164:167]
    ds_read_b64_tr_b16 v[204:205], v237 offset:20480
    v_mfma_f32_16x16x32_bf16 v[164:167], v[212:215], v[100:103], v[164:167]
    ds_read_b64_tr_b16 v[206:207], v237 offset:20992
    s_waitcnt lgkmcnt(8)
    v_mfma_f32_16x16x32_bf16 v[136:139], v[184:187], v[104:107], v[136:139]
    ds_read_b64_tr_b16 v[208:209], v237 offset:24576
    v_mfma_f32_16x16x32_bf16 v[136:139], v[188:191], v[112:115], v[136:139]
    ds_read_b64_tr_b16 v[210:211], v237 offset:25088
    s_waitcnt lgkmcnt(6)
    v_mfma_f32_16x16x32_bf16 v[136:139], v[192:195], v[120:123], v[136:139]
    ds_read_b64_tr_b16 v[212:213], v237 offset:28672
    v_mfma_f32_16x16x32_bf16 v[136:139], v[196:199], v[128:131], v[136:139]
    ds_read_b64_tr_b16 v[214:215], v237 offset:29184
    s_barrier
    v_mfma_f32_16x16x32_bf16 v[140:143], v[184:187], v[108:111], v[140:143]
    ds_read_b64_tr_b16 v[184:185], v238 offset:16384
    v_mfma_f32_16x16x32_bf16 v[140:143], v[188:191], v[116:119], v[140:143]
    ds_read_b64_tr_b16 v[186:187], v238 offset:16896
    v_mfma_f32_16x16x32_bf16 v[140:143], v[192:195], v[124:127], v[140:143]
    ds_read_b64_tr_b16 v[188:189], v238 offset:20480
    v_mfma_f32_16x16x32_bf16 v[140:143], v[196:199], v[132:135], v[140:143]
    ds_read_b64_tr_b16 v[190:191], v238 offset:20992
    s_waitcnt lgkmcnt(8)
    v_mfma_f32_16x16x32_bf16 v[144:147], v[200:203], v[104:107], v[144:147]
    ds_read_b64_tr_b16 v[192:193], v238 offset:24576
    v_mfma_f32_16x16x32_bf16 v[144:147], v[204:207], v[112:115], v[144:147]
    ds_read_b64_tr_b16 v[194:195], v238 offset:25088
    s_waitcnt lgkmcnt(6)
    v_mfma_f32_16x16x32_bf16 v[144:147], v[208:211], v[120:123], v[144:147]
    ds_read_b64_tr_b16 v[196:197], v238 offset:28672
    v_mfma_f32_16x16x32_bf16 v[144:147], v[212:215], v[128:131], v[144:147]
    ds_read_b64_tr_b16 v[198:199], v238 offset:29184
    v_mfma_f32_16x16x32_bf16 v[148:151], v[200:203], v[108:111], v[148:151]
    ds_read_b64_tr_b16 v[200:201], v239 offset:16384
    v_mfma_f32_16x16x32_bf16 v[148:151], v[204:207], v[116:119], v[148:151]
    ds_read_b64_tr_b16 v[202:203], v239 offset:16896
    s_add_u32 s52, s50, 131072
    v_mfma_f32_16x16x32_bf16 v[148:151], v[208:211], v[124:127], v[148:151]
    ds_read_b64_tr_b16 v[204:205], v239 offset:20480
    v_cvt_pk_bf16_f32 v136, v136, v137
    v_cvt_pk_bf16_f32 v137, v138, v139
    v_mfma_f32_16x16x32_bf16 v[148:151], v[212:215], v[132:135], v[148:151]
    ds_read_b64_tr_b16 v[206:207], v239 offset:20992
    v_cvt_pk_bf16_f32 v138, v144, v145
    v_cvt_pk_bf16_f32 v139, v146, v147
    s_waitcnt lgkmcnt(8)
    v_mfma_f32_16x16x32_bf16 v[152:155], v[184:187], v[104:107], v[152:155]
    ds_read_b64_tr_b16 v[208:209], v239 offset:24576
    buffer_store_dwordx4 v[136:139], v252, s[32:35], s52 offen sc1
    v_mfma_f32_16x16x32_bf16 v[152:155], v[188:191], v[112:115], v[152:155]
    ds_read_b64_tr_b16 v[210:211], v239 offset:25088
    v_lshlrev_b32 v144, 16, v170
    v_and_b32 v145, 0xffff0000, v170
    s_waitcnt lgkmcnt(6)
    v_mfma_f32_16x16x32_bf16 v[152:155], v[192:195], v[120:123], v[152:155]
    ds_read_b64_tr_b16 v[212:213], v239 offset:28672
    v_lshlrev_b32 v146, 16, v171
    v_mfma_f32_16x16x32_bf16 v[152:155], v[196:199], v[128:131], v[152:155]
    ds_read_b64_tr_b16 v[214:215], v239 offset:29184
    v_and_b32 v147, 0xffff0000, v171
    v_lshlrev_b32 v136, 16, v168
    v_mfma_f32_16x16x32_bf16 v[156:159], v[184:187], v[108:111], v[156:159]
    ds_read_b64_tr_b16 v[184:185], v248 offset:0
    v_and_b32 v137, 0xffff0000, v168
    v_mfma_f32_16x16x32_bf16 v[156:159], v[188:191], v[116:119], v[156:159]
    ds_read_b64_tr_b16 v[186:187], v248 offset:512
    v_lshlrev_b32 v138, 16, v169
    v_and_b32 v139, 0xffff0000, v169
    v_mfma_f32_16x16x32_bf16 v[156:159], v[192:195], v[124:127], v[156:159]
    ds_read_b64_tr_b16 v[188:189], v248 offset:4096
    v_cvt_pk_bf16_f32 v140, v140, v141
    v_cvt_pk_bf16_f32 v141, v142, v143
    v_mfma_f32_16x16x32_bf16 v[156:159], v[196:199], v[132:135], v[156:159]
    ds_read_b64_tr_b16 v[190:191], v248 offset:4608
    v_cvt_pk_bf16_f32 v142, v148, v149
    v_cvt_pk_bf16_f32 v143, v150, v151
    s_waitcnt lgkmcnt(8)
    v_mfma_f32_16x16x32_bf16 v[160:163], v[200:203], v[104:107], v[160:163]
    ds_read_b64_tr_b16 v[192:193], v248 offset:8192
    buffer_store_dwordx4 v[140:143], v252, s[32:35], s52 offen offset:2048 sc1
    v_mfma_f32_16x16x32_bf16 v[160:163], v[204:207], v[112:115], v[160:163]
    ds_read_b64_tr_b16 v[194:195], v248 offset:8704
    v_lshlrev_b32 v148, 16, v174
    v_and_b32 v149, 0xffff0000, v174
    s_waitcnt lgkmcnt(6)
    v_mfma_f32_16x16x32_bf16 v[160:163], v[208:211], v[120:123], v[160:163]
    ds_read_b64_tr_b16 v[196:197], v248 offset:12288
    v_lshlrev_b32 v150, 16, v175
    v_mfma_f32_16x16x32_bf16 v[160:163], v[212:215], v[128:131], v[160:163]
    ds_read_b64_tr_b16 v[198:199], v248 offset:12800
    v_and_b32 v151, 0xffff0000, v175
    v_lshlrev_b32 v140, 16, v172
    v_mfma_f32_16x16x32_bf16 v[164:167], v[200:203], v[108:111], v[164:167]
    ds_read_b64_tr_b16 v[200:201], v249 offset:0
    v_and_b32 v141, 0xffff0000, v172
    v_mfma_f32_16x16x32_bf16 v[164:167], v[204:207], v[116:119], v[164:167]
    ds_read_b64_tr_b16 v[202:203], v249 offset:512
    v_lshlrev_b32 v142, 16, v173
    v_and_b32 v143, 0xffff0000, v173
    v_mfma_f32_16x16x32_bf16 v[164:167], v[208:211], v[124:127], v[164:167]
    ds_read_b64_tr_b16 v[204:205], v249 offset:4096
    v_cvt_pk_bf16_f32 v152, v152, v153
    v_cvt_pk_bf16_f32 v153, v154, v155
    v_mfma_f32_16x16x32_bf16 v[164:167], v[212:215], v[132:135], v[164:167]
    ds_read_b64_tr_b16 v[206:207], v249 offset:4608
    v_cvt_pk_bf16_f32 v154, v160, v161
    v_cvt_pk_bf16_f32 v155, v162, v163
    s_waitcnt lgkmcnt(8)
    v_mfma_f32_16x16x32_bf16 v[136:139], v[184:187], v[104:107], v[136:139]
    ds_read_b64_tr_b16 v[208:209], v249 offset:8192
    buffer_store_dwordx4 v[152:155], v252, s[32:35], s52 offen offset:1024 sc1
    v_mfma_f32_16x16x32_bf16 v[136:139], v[188:191], v[112:115], v[136:139]
    ds_read_b64_tr_b16 v[210:211], v249 offset:8704
    v_lshlrev_b32 v160, 16, v178
    v_and_b32 v161, 0xffff0000, v178
    s_waitcnt lgkmcnt(6)
    v_mfma_f32_16x16x32_bf16 v[136:139], v[192:195], v[120:123], v[136:139]
    ds_read_b64_tr_b16 v[212:213], v249 offset:12288
    v_lshlrev_b32 v162, 16, v179
    v_mfma_f32_16x16x32_bf16 v[136:139], v[196:199], v[128:131], v[136:139]
    ds_read_b64_tr_b16 v[214:215], v249 offset:12800
    v_and_b32 v163, 0xffff0000, v179
    v_lshlrev_b32 v152, 16, v176
    s_barrier
    v_mfma_f32_16x16x32_bf16 v[140:143], v[184:187], v[108:111], v[140:143]
    ds_read_b64_tr_b16 v[184:185], v250 offset:0
    v_and_b32 v153, 0xffff0000, v176
    v_mfma_f32_16x16x32_bf16 v[140:143], v[188:191], v[116:119], v[140:143]
    ds_read_b64_tr_b16 v[186:187], v250 offset:512
    v_lshlrev_b32 v154, 16, v177
    v_and_b32 v155, 0xffff0000, v177
    v_mfma_f32_16x16x32_bf16 v[140:143], v[192:195], v[124:127], v[140:143]
    ds_read_b64_tr_b16 v[188:189], v250 offset:4096
    v_cvt_pk_bf16_f32 v156, v156, v157
    v_cvt_pk_bf16_f32 v157, v158, v159
    v_mfma_f32_16x16x32_bf16 v[140:143], v[196:199], v[132:135], v[140:143]
    ds_read_b64_tr_b16 v[190:191], v250 offset:4608
    v_cvt_pk_bf16_f32 v158, v164, v165
    v_cvt_pk_bf16_f32 v159, v166, v167
    s_waitcnt lgkmcnt(8)
    v_mfma_f32_16x16x32_bf16 v[144:147], v[200:203], v[104:107], v[144:147]
    ds_read_b64_tr_b16 v[192:193], v250 offset:8192
    buffer_store_dwordx4 v[156:159], v252, s[32:35], s52 offen offset:3072 sc1
    v_mfma_f32_16x16x32_bf16 v[144:147], v[204:207], v[112:115], v[144:147]
    ds_read_b64_tr_b16 v[194:195], v250 offset:8704
    v_lshlrev_b32 v164, 16, v182
    v_and_b32 v165, 0xffff0000, v182
    s_waitcnt lgkmcnt(6)
    v_mfma_f32_16x16x32_bf16 v[144:147], v[208:211], v[120:123], v[144:147]
    ds_read_b64_tr_b16 v[196:197], v250 offset:12288
    v_lshlrev_b32 v166, 16, v183
    v_mfma_f32_16x16x32_bf16 v[144:147], v[212:215], v[128:131], v[144:147]
    ds_read_b64_tr_b16 v[198:199], v250 offset:12800
    v_and_b32 v167, 0xffff0000, v183
    v_lshlrev_b32 v156, 16, v180
    v_mfma_f32_16x16x32_bf16 v[148:151], v[200:203], v[108:111], v[148:151]
    ds_read_b64_tr_b16 v[200:201], v251 offset:0
    v_and_b32 v157, 0xffff0000, v180
    v_mfma_f32_16x16x32_bf16 v[148:151], v[204:207], v[116:119], v[148:151]
    ds_read_b64_tr_b16 v[202:203], v251 offset:512
    v_lshlrev_b32 v158, 16, v181
    v_and_b32 v159, 0xffff0000, v181
    s_add_u32 s52, s50, 262144
    v_mfma_f32_16x16x32_bf16 v[148:151], v[208:211], v[124:127], v[148:151]
    ds_read_b64_tr_b16 v[204:205], v251 offset:4096
    v_cvt_pk_bf16_f32 v136, v136, v137
    v_cvt_pk_bf16_f32 v137, v138, v139
    v_mfma_f32_16x16x32_bf16 v[148:151], v[212:215], v[132:135], v[148:151]
    ds_read_b64_tr_b16 v[206:207], v251 offset:4608
    v_cvt_pk_bf16_f32 v138, v144, v145
    v_cvt_pk_bf16_f32 v139, v146, v147
    s_waitcnt lgkmcnt(8)
    v_mfma_f32_16x16x32_bf16 v[152:155], v[184:187], v[104:107], v[152:155]
    ds_read_b64_tr_b16 v[208:209], v251 offset:8192
    buffer_store_dwordx4 v[136:139], v252, s[32:35], s52 offen sc1
    v_mfma_f32_16x16x32_bf16 v[152:155], v[188:191], v[112:115], v[152:155]
    ds_read_b64_tr_b16 v[210:211], v251 offset:8704
    v_lshlrev_b32 v144, 16, v218
    v_and_b32 v145, 0xffff0000, v218
    s_waitcnt lgkmcnt(6)
    v_mfma_f32_16x16x32_bf16 v[152:155], v[192:195], v[120:123], v[152:155]
    ds_read_b64_tr_b16 v[212:213], v251 offset:12288
    v_lshlrev_b32 v146, 16, v219
    v_mfma_f32_16x16x32_bf16 v[152:155], v[196:199], v[128:131], v[152:155]
    ds_read_b64_tr_b16 v[214:215], v251 offset:12800
    v_and_b32 v147, 0xffff0000, v219
    v_lshlrev_b32 v136, 16, v216
    v_mfma_f32_16x16x32_bf16 v[156:159], v[184:187], v[108:111], v[156:159]
    ds_read_b64_tr_b16 v[184:185], v248 offset:16384
    v_and_b32 v137, 0xffff0000, v216
    v_mfma_f32_16x16x32_bf16 v[156:159], v[188:191], v[116:119], v[156:159]
    ds_read_b64_tr_b16 v[186:187], v248 offset:16896
    v_lshlrev_b32 v138, 16, v217
    v_and_b32 v139, 0xffff0000, v217
    v_mfma_f32_16x16x32_bf16 v[156:159], v[192:195], v[124:127], v[156:159]
    ds_read_b64_tr_b16 v[188:189], v248 offset:20480
    v_cvt_pk_bf16_f32 v140, v140, v141
    v_cvt_pk_bf16_f32 v141, v142, v143
    v_mfma_f32_16x16x32_bf16 v[156:159], v[196:199], v[132:135], v[156:159]
    ds_read_b64_tr_b16 v[190:191], v248 offset:20992
    v_cvt_pk_bf16_f32 v142, v148, v149
    v_cvt_pk_bf16_f32 v143, v150, v151
    s_waitcnt lgkmcnt(8)
    v_mfma_f32_16x16x32_bf16 v[160:163], v[200:203], v[104:107], v[160:163]
    ds_read_b64_tr_b16 v[192:193], v248 offset:24576
    buffer_store_dwordx4 v[140:143], v252, s[32:35], s52 offen offset:2048 sc1
    v_mfma_f32_16x16x32_bf16 v[160:163], v[204:207], v[112:115], v[160:163]
    ds_read_b64_tr_b16 v[194:195], v248 offset:25088
    v_lshlrev_b32 v148, 16, v222
    v_and_b32 v149, 0xffff0000, v222
    s_waitcnt lgkmcnt(6)
    v_mfma_f32_16x16x32_bf16 v[160:163], v[208:211], v[120:123], v[160:163]
    ds_read_b64_tr_b16 v[196:197], v248 offset:28672
    v_lshlrev_b32 v150, 16, v223
    v_mfma_f32_16x16x32_bf16 v[160:163], v[212:215], v[128:131], v[160:163]
    ds_read_b64_tr_b16 v[198:199], v248 offset:29184
    v_and_b32 v151, 0xffff0000, v223
    v_lshlrev_b32 v140, 16, v220
    v_mfma_f32_16x16x32_bf16 v[164:167], v[200:203], v[108:111], v[164:167]
    ds_read_b64_tr_b16 v[200:201], v249 offset:16384
    v_and_b32 v141, 0xffff0000, v220
    v_mfma_f32_16x16x32_bf16 v[164:167], v[204:207], v[116:119], v[164:167]
    ds_read_b64_tr_b16 v[202:203], v249 offset:16896
    v_lshlrev_b32 v142, 16, v221
    v_and_b32 v143, 0xffff0000, v221
    v_mfma_f32_16x16x32_bf16 v[164:167], v[208:211], v[124:127], v[164:167]
    ds_read_b64_tr_b16 v[204:205], v249 offset:20480
    v_cvt_pk_bf16_f32 v152, v152, v153
    v_cvt_pk_bf16_f32 v153, v154, v155
    v_mfma_f32_16x16x32_bf16 v[164:167], v[212:215], v[132:135], v[164:167]
    ds_read_b64_tr_b16 v[206:207], v249 offset:20992
    v_cvt_pk_bf16_f32 v154, v160, v161
    v_cvt_pk_bf16_f32 v155, v162, v163
    s_waitcnt lgkmcnt(8)
    v_mfma_f32_16x16x32_bf16 v[136:139], v[184:187], v[104:107], v[136:139]
    ds_read_b64_tr_b16 v[208:209], v249 offset:24576
    buffer_store_dwordx4 v[152:155], v252, s[32:35], s52 offen offset:1024 sc1
    v_mfma_f32_16x16x32_bf16 v[136:139], v[188:191], v[112:115], v[136:139]
    ds_read_b64_tr_b16 v[210:211], v249 offset:25088
    v_lshlrev_b32 v160, 16, v226
    v_and_b32 v161, 0xffff0000, v226
    s_waitcnt lgkmcnt(6)
    v_mfma_f32_16x16x32_bf16 v[136:139], v[192:195], v[120:123], v[136:139]
    ds_read_b64_tr_b16 v[212:213], v249 offset:28672
    v_lshlrev_b32 v162, 16, v227
    v_mfma_f32_16x16x32_bf16 v[136:139], v[196:199], v[128:131], v[136:139]
    ds_read_b64_tr_b16 v[214:215], v249 offset:29184
    v_and_b32 v163, 0xffff0000, v227
    v_lshlrev_b32 v152, 16, v224
    s_barrier
    v_mfma_f32_16x16x32_bf16 v[140:143], v[184:187], v[108:111], v[140:143]
    ds_read_b64_tr_b16 v[184:185], v250 offset:16384
    v_and_b32 v153, 0xffff0000, v224
    v_mfma_f32_16x16x32_bf16 v[140:143], v[188:191], v[116:119], v[140:143]
    ds_read_b64_tr_b16 v[186:187], v250 offset:16896
    v_lshlrev_b32 v154, 16, v225
    v_and_b32 v155, 0xffff0000, v225
    v_mfma_f32_16x16x32_bf16 v[140:143], v[192:195], v[124:127], v[140:143]
    ds_read_b64_tr_b16 v[188:189], v250 offset:20480
    v_cvt_pk_bf16_f32 v156, v156, v157
    v_cvt_pk_bf16_f32 v157, v158, v159
    v_mfma_f32_16x16x32_bf16 v[140:143], v[196:199], v[132:135], v[140:143]
    ds_read_b64_tr_b16 v[190:191], v250 offset:20992
    v_cvt_pk_bf16_f32 v158, v164, v165
    v_cvt_pk_bf16_f32 v159, v166, v167
    s_waitcnt lgkmcnt(8)
    v_mfma_f32_16x16x32_bf16 v[144:147], v[200:203], v[104:107], v[144:147]
    ds_read_b64_tr_b16 v[192:193], v250 offset:24576
    buffer_store_dwordx4 v[156:159], v252, s[32:35], s52 offen offset:3072 sc1
    v_mfma_f32_16x16x32_bf16 v[144:147], v[204:207], v[112:115], v[144:147]
    ds_read_b64_tr_b16 v[194:195], v250 offset:25088
    v_lshlrev_b32 v164, 16, v230
    v_and_b32 v165, 0xffff0000, v230
    s_waitcnt lgkmcnt(6)
    v_mfma_f32_16x16x32_bf16 v[144:147], v[208:211], v[120:123], v[144:147]
    ds_read_b64_tr_b16 v[196:197], v250 offset:28672
    v_lshlrev_b32 v166, 16, v231
    v_mfma_f32_16x16x32_bf16 v[144:147], v[212:215], v[128:131], v[144:147]
    ds_read_b64_tr_b16 v[198:199], v250 offset:29184
    v_and_b32 v167, 0xffff0000, v231
    v_lshlrev_b32 v156, 16, v228
    v_mfma_f32_16x16x32_bf16 v[148:151], v[200:203], v[108:111], v[148:151]
    ds_read_b64_tr_b16 v[200:201], v251 offset:16384
    v_and_b32 v157, 0xffff0000, v228
    v_mfma_f32_16x16x32_bf16 v[148:151], v[204:207], v[116:119], v[148:151]
    ds_read_b64_tr_b16 v[202:203], v251 offset:16896
    v_lshlrev_b32 v158, 16, v229
    v_and_b32 v159, 0xffff0000, v229
    s_add_u32 s52, s50, 393216
    v_mfma_f32_16x16x32_bf16 v[148:151], v[208:211], v[124:127], v[148:151]
    ds_read_b64_tr_b16 v[204:205], v251 offset:20480
    v_cvt_pk_bf16_f32 v136, v136, v137
    v_mfma_f32_16x16x32_bf16 v[148:151], v[212:215], v[132:135], v[148:151]
    ds_read_b64_tr_b16 v[206:207], v251 offset:20992
    v_cvt_pk_bf16_f32 v137, v138, v139
    s_waitcnt lgkmcnt(8)
    v_mfma_f32_16x16x32_bf16 v[152:155], v[184:187], v[104:107], v[152:155]
    ds_read_b64_tr_b16 v[208:209], v251 offset:24576
    v_cvt_pk_bf16_f32 v138, v144, v145
    v_mfma_f32_16x16x32_bf16 v[152:155], v[188:191], v[112:115], v[152:155]
    ds_read_b64_tr_b16 v[210:211], v251 offset:25088
    v_cvt_pk_bf16_f32 v139, v146, v147
    s_waitcnt lgkmcnt(6)
    v_mfma_f32_16x16x32_bf16 v[152:155], v[192:195], v[120:123], v[152:155]
    ds_read_b64_tr_b16 v[212:213], v251 offset:28672
    buffer_store_dwordx4 v[136:139], v252, s[32:35], s52 offen sc1
    v_mfma_f32_16x16x32_bf16 v[152:155], v[196:199], v[128:131], v[152:155]
    ds_read_b64_tr_b16 v[214:215], v251 offset:29184
    v_mfma_f32_16x16x32_bf16 v[156:159], v[184:187], v[108:111], v[156:159]
    ds_read_b64_tr_b16 v[184:185], v232 offset:0
    v_mfma_f32_16x16x32_bf16 v[156:159], v[188:191], v[116:119], v[156:159]
    ds_read_b64_tr_b16 v[186:187], v232 offset:512
    v_mfma_f32_16x16x32_bf16 v[156:159], v[192:195], v[124:127], v[156:159]
    ds_read_b64_tr_b16 v[188:189], v232 offset:4096
    v_cvt_pk_bf16_f32 v140, v140, v141
    v_mfma_f32_16x16x32_bf16 v[156:159], v[196:199], v[132:135], v[156:159]
    ds_read_b64_tr_b16 v[190:191], v232 offset:4608
    v_cvt_pk_bf16_f32 v141, v142, v143
    s_waitcnt lgkmcnt(8)
    v_mfma_f32_16x16x32_bf16 v[160:163], v[200:203], v[104:107], v[160:163]
    ds_read_b64_tr_b16 v[192:193], v232 offset:8192
    v_cvt_pk_bf16_f32 v142, v148, v149
    v_mfma_f32_16x16x32_bf16 v[160:163], v[204:207], v[112:115], v[160:163]
    ds_read_b64_tr_b16 v[194:195], v232 offset:8704
    v_cvt_pk_bf16_f32 v143, v150, v151
    s_waitcnt lgkmcnt(6)
    v_mfma_f32_16x16x32_bf16 v[160:163], v[208:211], v[120:123], v[160:163]
    ds_read_b64_tr_b16 v[196:197], v232 offset:12288
    buffer_store_dwordx4 v[140:143], v252, s[32:35], s52 offen offset:2048 sc1
    v_mfma_f32_16x16x32_bf16 v[160:163], v[212:215], v[128:131], v[160:163]
    ds_read_b64_tr_b16 v[198:199], v232 offset:12800
    v_mfma_f32_16x16x32_bf16 v[164:167], v[200:203], v[108:111], v[164:167]
    ds_read_b64_tr_b16 v[200:201], v233 offset:0
    v_mfma_f32_16x16x32_bf16 v[164:167], v[204:207], v[116:119], v[164:167]
    ds_read_b64_tr_b16 v[202:203], v233 offset:512
    v_mfma_f32_16x16x32_bf16 v[164:167], v[208:211], v[124:127], v[164:167]
    ds_read_b64_tr_b16 v[204:205], v233 offset:4096
    v_cvt_pk_bf16_f32 v152, v152, v153
    v_mfma_f32_16x16x32_bf16 v[164:167], v[212:215], v[132:135], v[164:167]
    ds_read_b64_tr_b16 v[206:207], v233 offset:4608
    v_cvt_pk_bf16_f32 v153, v154, v155
    s_waitcnt lgkmcnt(8)
    v_mfma_f32_16x16x32_bf16 v[136:139], v[184:187], v[8:11], 0
    ds_read_b64_tr_b16 v[208:209], v233 offset:8192
    v_cvt_pk_bf16_f32 v154, v160, v161
    v_mfma_f32_16x16x32_bf16 v[136:139], v[188:191], v[16:19], v[136:139]
    ds_read_b64_tr_b16 v[210:211], v233 offset:8704
    v_cvt_pk_bf16_f32 v155, v162, v163
    s_waitcnt lgkmcnt(6)
    v_mfma_f32_16x16x32_bf16 v[136:139], v[192:195], v[24:27], v[136:139]
    ds_read_b64_tr_b16 v[212:213], v233 offset:12288
    buffer_store_dwordx4 v[152:155], v252, s[32:35], s52 offen offset:1024 sc1
    v_mfma_f32_16x16x32_bf16 v[136:139], v[196:199], v[32:35], v[136:139]
    ds_read_b64_tr_b16 v[214:215], v233 offset:12800
    s_barrier
    v_mfma_f32_16x16x32_bf16 v[140:143], v[184:187], v[12:15], 0
    ds_read_b64_tr_b16 v[184:185], v234 offset:0
    v_mfma_f32_16x16x32_bf16 v[140:143], v[188:191], v[20:23], v[140:143]
    ds_read_b64_tr_b16 v[186:187], v234 offset:512
    v_mfma_f32_16x16x32_bf16 v[140:143], v[192:195], v[28:31], v[140:143]
    ds_read_b64_tr_b16 v[188:189], v234 offset:4096
    v_cvt_pk_bf16_f32 v156, v156, v157
    v_mfma_f32_16x16x32_bf16 v[140:143], v[196:199], v[36:39], v[140:143]
    ds_read_b64_tr_b16 v[190:191], v234 offset:4608
    v_cvt_pk_bf16_f32 v157, v158, v159
    s_waitcnt lgkmcnt(8)
    v_mfma_f32_16x16x32_bf16 v[144:147], v[200:203], v[8:11], 0
    ds_read_b64_tr_b16 v[192:193], v234 offset:8192
    v_cvt_pk_bf16_f32 v158, v164, v165
    v_mfma_f32_16x16x32_bf16 v[144:147], v[204:207], v[16:19], v[144:147]
    ds_read_b64_tr_b16 v[194:195], v234 offset:8704
    v_cvt_pk_bf16_f32 v159, v166, v167
    s_waitcnt lgkmcnt(6)
    v_mfma_f32_16x16x32_bf16 v[144:147], v[208:211], v[24:27], v[144:147]
    ds_read_b64_tr_b16 v[196:197], v234 offset:12288
    buffer_store_dwordx4 v[156:159], v252, s[32:35], s52 offen offset:3072 sc1
    v_mfma_f32_16x16x32_bf16 v[144:147], v[212:215], v[32:35], v[144:147]
    ds_read_b64_tr_b16 v[198:199], v234 offset:12800
    v_mfma_f32_16x16x32_bf16 v[148:151], v[200:203], v[12:15], 0
    ds_read_b64_tr_b16 v[200:201], v235 offset:0
    v_mfma_f32_16x16x32_bf16 v[148:151], v[204:207], v[20:23], v[148:151]
    ds_read_b64_tr_b16 v[202:203], v235 offset:512
    v_mfma_f32_16x16x32_bf16 v[148:151], v[208:211], v[28:31], v[148:151]
    ds_read_b64_tr_b16 v[204:205], v235 offset:4096
    v_mfma_f32_16x16x32_bf16 v[148:151], v[212:215], v[36:39], v[148:151]
    ds_read_b64_tr_b16 v[206:207], v235 offset:4608
    s_waitcnt lgkmcnt(8)
    v_mfma_f32_16x16x32_bf16 v[152:155], v[184:187], v[8:11], 0
    ds_read_b64_tr_b16 v[208:209], v235 offset:8192
    v_mfma_f32_16x16x32_bf16 v[152:155], v[188:191], v[16:19], v[152:155]
    ds_read_b64_tr_b16 v[210:211], v235 offset:8704
    s_waitcnt lgkmcnt(6)
    v_mfma_f32_16x16x32_bf16 v[152:155], v[192:195], v[24:27], v[152:155]
    ds_read_b64_tr_b16 v[212:213], v235 offset:12288
    v_mfma_f32_16x16x32_bf16 v[152:155], v[196:199], v[32:35], v[152:155]
    ds_read_b64_tr_b16 v[214:215], v235 offset:12800
    v_mfma_f32_16x16x32_bf16 v[156:159], v[184:187], v[12:15], 0
    ds_read_b64_tr_b16 v[184:185], v232 offset:16384
    v_mfma_f32_16x16x32_bf16 v[156:159], v[188:191], v[20:23], v[156:159]
    ds_read_b64_tr_b16 v[186:187], v232 offset:16896
    v_mfma_f32_16x16x32_bf16 v[156:159], v[192:195], v[28:31], v[156:159]
    ds_read_b64_tr_b16 v[188:189], v232 offset:20480
    v_mfma_f32_16x16x32_bf16 v[156:159], v[196:199], v[36:39], v[156:159]
    ds_read_b64_tr_b16 v[190:191], v232 offset:20992
    s_waitcnt lgkmcnt(8)
    v_mfma_f32_16x16x32_bf16 v[160:163], v[200:203], v[8:11], 0
    ds_read_b64_tr_b16 v[192:193], v232 offset:24576
    v_mfma_f32_16x16x32_bf16 v[160:163], v[204:207], v[16:19], v[160:163]
    ds_read_b64_tr_b16 v[194:195], v232 offset:25088
    s_waitcnt lgkmcnt(6)
    v_mfma_f32_16x16x32_bf16 v[160:163], v[208:211], v[24:27], v[160:163]
    ds_read_b64_tr_b16 v[196:197], v232 offset:28672
    v_mfma_f32_16x16x32_bf16 v[160:163], v[212:215], v[32:35], v[160:163]
    ds_read_b64_tr_b16 v[198:199], v232 offset:29184
    v_mfma_f32_16x16x32_bf16 v[164:167], v[200:203], v[12:15], 0
    ds_read_b64_tr_b16 v[200:201], v233 offset:16384
    v_mfma_f32_16x16x32_bf16 v[164:167], v[204:207], v[20:23], v[164:167]
    ds_read_b64_tr_b16 v[202:203], v233 offset:16896
    v_mfma_f32_16x16x32_bf16 v[164:167], v[208:211], v[28:31], v[164:167]
    ds_read_b64_tr_b16 v[204:205], v233 offset:20480
    v_mfma_f32_16x16x32_bf16 v[164:167], v[212:215], v[36:39], v[164:167]
    ds_read_b64_tr_b16 v[206:207], v233 offset:20992
    s_waitcnt lgkmcnt(8)
    v_mfma_f32_16x16x32_bf16 v[136:139], v[184:187], v[40:43], v[136:139]
    ds_read_b64_tr_b16 v[208:209], v233 offset:24576
    v_mfma_f32_16x16x32_bf16 v[136:139], v[188:191], v[48:51], v[136:139]
    ds_read_b64_tr_b16 v[210:211], v233 offset:25088
    s_waitcnt lgkmcnt(6)
    v_mfma_f32_16x16x32_bf16 v[136:139], v[192:195], v[56:59], v[136:139]
    ds_read_b64_tr_b16 v[212:213], v233 offset:28672
    v_mfma_f32_16x16x32_bf16 v[136:139], v[196:199], v[64:67], v[136:139]
    ds_read_b64_tr_b16 v[214:215], v233 offset:29184
    s_barrier
    v_mfma_f32_16x16x32_bf16 v[140:143], v[184:187], v[44:47], v[140:143]
    ds_read_b64_tr_b16 v[184:185], v234 offset:16384
    v_mfma_f32_16x16x32_bf16 v[140:143], v[188:191], v[52:55], v[140:143]
    ds_read_b64_tr_b16 v[186:187], v234 offset:16896
    v_mfma_f32_16x16x32_bf16 v[140:143], v[192:195], v[60:63], v[140:143]
    ds_read_b64_tr_b16 v[188:189], v234 offset:20480
    v_mfma_f32_16x16x32_bf16 v[140:143], v[196:199], v[68:71], v[140:143]
    ds_read_b64_tr_b16 v[190:191], v234 offset:20992
    s_waitcnt lgkmcnt(8)
    v_mfma_f32_16x16x32_bf16 v[144:147], v[200:203], v[40:43], v[144:147]
    ds_read_b64_tr_b16 v[192:193], v234 offset:24576
    v_mfma_f32_16x16x32_bf16 v[144:147], v[204:207], v[48:51], v[144:147]
    ds_read_b64_tr_b16 v[194:195], v234 offset:25088
    s_waitcnt lgkmcnt(6)
    v_mfma_f32_16x16x32_bf16 v[144:147], v[208:211], v[56:59], v[144:147]
    ds_read_b64_tr_b16 v[196:197], v234 offset:28672
    v_mfma_f32_16x16x32_bf16 v[144:147], v[212:215], v[64:67], v[144:147]
    ds_read_b64_tr_b16 v[198:199], v234 offset:29184
    v_mfma_f32_16x16x32_bf16 v[148:151], v[200:203], v[44:47], v[148:151]
    ds_read_b64_tr_b16 v[200:201], v235 offset:16384
    v_mfma_f32_16x16x32_bf16 v[148:151], v[204:207], v[52:55], v[148:151]
    ds_read_b64_tr_b16 v[202:203], v235 offset:16896
    v_mfma_f32_16x16x32_bf16 v[148:151], v[208:211], v[60:63], v[148:151]
    ds_read_b64_tr_b16 v[204:205], v235 offset:20480
    v_mfma_f32_16x16x32_bf16 v[148:151], v[212:215], v[68:71], v[148:151]
    ds_read_b64_tr_b16 v[206:207], v235 offset:20992
    s_waitcnt lgkmcnt(8)
    v_mfma_f32_16x16x32_bf16 v[152:155], v[184:187], v[40:43], v[152:155]
    ds_read_b64_tr_b16 v[208:209], v235 offset:24576
    v_mfma_f32_16x16x32_bf16 v[152:155], v[188:191], v[48:51], v[152:155]
    ds_read_b64_tr_b16 v[210:211], v235 offset:25088
    s_waitcnt lgkmcnt(6)
    v_mfma_f32_16x16x32_bf16 v[152:155], v[192:195], v[56:59], v[152:155]
    ds_read_b64_tr_b16 v[212:213], v235 offset:28672
    v_mfma_f32_16x16x32_bf16 v[152:155], v[196:199], v[64:67], v[152:155]
    ds_read_b64_tr_b16 v[214:215], v235 offset:29184
    v_mfma_f32_16x16x32_bf16 v[156:159], v[184:187], v[44:47], v[156:159]
    ds_read_b64_tr_b16 v[184:185], v236 offset:32768
    v_mfma_f32_16x16x32_bf16 v[156:159], v[188:191], v[52:55], v[156:159]
    ds_read_b64_tr_b16 v[186:187], v236 offset:33280
    v_mfma_f32_16x16x32_bf16 v[156:159], v[192:195], v[60:63], v[156:159]
    ds_read_b64_tr_b16 v[188:189], v236 offset:36864
    v_mfma_f32_16x16x32_bf16 v[156:159], v[196:199], v[68:71], v[156:159]
    ds_read_b64_tr_b16 v[190:191], v236 offset:37376
    s_waitcnt lgkmcnt(8)
    v_mfma_f32_16x16x32_bf16 v[160:163], v[200:203], v[40:43], v[160:163]
    ds_read_b64_tr_b16 v[192:193], v236 offset:40960
    v_mfma_f32_16x16x32_bf16 v[160:163], v[204:207], v[48:51], v[160:163]
    ds_read_b64_tr_b16 v[194:195], v236 offset:41472
    s_waitcnt lgkmcnt(6)
    v_mfma_f32_16x16x32_bf16 v[160:163], v[208:211], v[56:59], v[160:163]
    ds_read_b64_tr_b16 v[196:197], v236 offset:45056
    v_mfma_f32_16x16x32_bf16 v[160:163], v[212:215], v[64:67], v[160:163]
    ds_read_b64_tr_b16 v[198:199], v236 offset:45568
    v_mfma_f32_16x16x32_bf16 v[164:167], v[200:203], v[44:47], v[164:167]
    ds_read_b64_tr_b16 v[200:201], v237 offset:32768
    v_mfma_f32_16x16x32_bf16 v[164:167], v[204:207], v[52:55], v[164:167]
    ds_read_b64_tr_b16 v[202:203], v237 offset:33280
    v_mfma_f32_16x16x32_bf16 v[164:167], v[208:211], v[60:63], v[164:167]
    ds_read_b64_tr_b16 v[204:205], v237 offset:36864
    v_mfma_f32_16x16x32_bf16 v[164:167], v[212:215], v[68:71], v[164:167]
    ds_read_b64_tr_b16 v[206:207], v237 offset:37376
    s_waitcnt lgkmcnt(8)
    v_mfma_f32_16x16x32_bf16 v[136:139], v[184:187], v[72:75], v[136:139]
    ds_read_b64_tr_b16 v[208:209], v237 offset:40960
    v_mfma_f32_16x16x32_bf16 v[136:139], v[188:191], v[80:83], v[136:139]
    ds_read_b64_tr_b16 v[210:211], v237 offset:41472
    s_waitcnt lgkmcnt(6)
    v_mfma_f32_16x16x32_bf16 v[136:139], v[192:195], v[88:91], v[136:139]
    ds_read_b64_tr_b16 v[212:213], v237 offset:45056
    v_mfma_f32_16x16x32_bf16 v[136:139], v[196:199], v[96:99], v[136:139]
    ds_read_b64_tr_b16 v[214:215], v237 offset:45568
    s_barrier
    v_mfma_f32_16x16x32_bf16 v[140:143], v[184:187], v[76:79], v[140:143]
    ds_read_b64_tr_b16 v[184:185], v238 offset:32768
    v_mfma_f32_16x16x32_bf16 v[140:143], v[188:191], v[84:87], v[140:143]
    ds_read_b64_tr_b16 v[186:187], v238 offset:33280
    v_mfma_f32_16x16x32_bf16 v[140:143], v[192:195], v[92:95], v[140:143]
    ds_read_b64_tr_b16 v[188:189], v238 offset:36864
    v_mfma_f32_16x16x32_bf16 v[140:143], v[196:199], v[100:103], v[140:143]
    ds_read_b64_tr_b16 v[190:191], v238 offset:37376
    s_waitcnt lgkmcnt(8)
    v_mfma_f32_16x16x32_bf16 v[144:147], v[200:203], v[72:75], v[144:147]
    ds_read_b64_tr_b16 v[192:193], v238 offset:40960
    v_mfma_f32_16x16x32_bf16 v[144:147], v[204:207], v[80:83], v[144:147]
    ds_read_b64_tr_b16 v[194:195], v238 offset:41472
    s_waitcnt lgkmcnt(6)
    v_mfma_f32_16x16x32_bf16 v[144:147], v[208:211], v[88:91], v[144:147]
    ds_read_b64_tr_b16 v[196:197], v238 offset:45056
    v_mfma_f32_16x16x32_bf16 v[144:147], v[212:215], v[96:99], v[144:147]
    ds_read_b64_tr_b16 v[198:199], v238 offset:45568
    v_mfma_f32_16x16x32_bf16 v[148:151], v[200:203], v[76:79], v[148:151]
    ds_read_b64_tr_b16 v[200:201], v239 offset:32768
    v_mfma_f32_16x16x32_bf16 v[148:151], v[204:207], v[84:87], v[148:151]
    ds_read_b64_tr_b16 v[202:203], v239 offset:33280
    v_mfma_f32_16x16x32_bf16 v[148:151], v[208:211], v[92:95], v[148:151]
    ds_read_b64_tr_b16 v[204:205], v239 offset:36864
    v_mfma_f32_16x16x32_bf16 v[148:151], v[212:215], v[100:103], v[148:151]
    ds_read_b64_tr_b16 v[206:207], v239 offset:37376
    s_waitcnt lgkmcnt(8)
    v_mfma_f32_16x16x32_bf16 v[152:155], v[184:187], v[72:75], v[152:155]
    ds_read_b64_tr_b16 v[208:209], v239 offset:40960
    v_mfma_f32_16x16x32_bf16 v[152:155], v[188:191], v[80:83], v[152:155]
    ds_read_b64_tr_b16 v[210:211], v239 offset:41472
    s_waitcnt lgkmcnt(6)
    v_mfma_f32_16x16x32_bf16 v[152:155], v[192:195], v[88:91], v[152:155]
    ds_read_b64_tr_b16 v[212:213], v239 offset:45056
    v_mfma_f32_16x16x32_bf16 v[152:155], v[196:199], v[96:99], v[152:155]
    ds_read_b64_tr_b16 v[214:215], v239 offset:45568
    v_mfma_f32_16x16x32_bf16 v[156:159], v[184:187], v[76:79], v[156:159]
    ds_read_b64_tr_b16 v[184:185], v236 offset:49152
    v_mfma_f32_16x16x32_bf16 v[156:159], v[188:191], v[84:87], v[156:159]
    ds_read_b64_tr_b16 v[186:187], v236 offset:49664
    v_mfma_f32_16x16x32_bf16 v[156:159], v[192:195], v[92:95], v[156:159]
    ds_read_b64_tr_b16 v[188:189], v236 offset:53248
    v_mfma_f32_16x16x32_bf16 v[156:159], v[196:199], v[100:103], v[156:159]
    ds_read_b64_tr_b16 v[190:191], v236 offset:53760
    s_waitcnt lgkmcnt(8)
    v_mfma_f32_16x16x32_bf16 v[160:163], v[200:203], v[72:75], v[160:163]
    ds_read_b64_tr_b16 v[192:193], v236 offset:57344
    v_mfma_f32_16x16x32_bf16 v[160:163], v[204:207], v[80:83], v[160:163]
    ds_read_b64_tr_b16 v[194:195], v236 offset:57856
    s_waitcnt lgkmcnt(6)
    v_mfma_f32_16x16x32_bf16 v[160:163], v[208:211], v[88:91], v[160:163]
    ds_read_b64_tr_b16 v[196:197], v236 offset:61440
    v_mfma_f32_16x16x32_bf16 v[160:163], v[212:215], v[96:99], v[160:163]
    ds_read_b64_tr_b16 v[198:199], v236 offset:61952
    v_mfma_f32_16x16x32_bf16 v[164:167], v[200:203], v[76:79], v[164:167]
    ds_read_b64_tr_b16 v[200:201], v237 offset:49152
    v_mfma_f32_16x16x32_bf16 v[164:167], v[204:207], v[84:87], v[164:167]
    ds_read_b64_tr_b16 v[202:203], v237 offset:49664
    v_mfma_f32_16x16x32_bf16 v[164:167], v[208:211], v[92:95], v[164:167]
    ds_read_b64_tr_b16 v[204:205], v237 offset:53248
    v_mfma_f32_16x16x32_bf16 v[164:167], v[212:215], v[100:103], v[164:167]
    ds_read_b64_tr_b16 v[206:207], v237 offset:53760
    s_waitcnt lgkmcnt(8)
    v_mfma_f32_16x16x32_bf16 v[136:139], v[184:187], v[104:107], v[136:139]
    ds_read_b64_tr_b16 v[208:209], v237 offset:57344
    v_mfma_f32_16x16x32_bf16 v[136:139], v[188:191], v[112:115], v[136:139]
    ds_read_b64_tr_b16 v[210:211], v237 offset:57856
    s_waitcnt lgkmcnt(6)
    v_mfma_f32_16x16x32_bf16 v[136:139], v[192:195], v[120:123], v[136:139]
    ds_read_b64_tr_b16 v[212:213], v237 offset:61440
    v_mfma_f32_16x16x32_bf16 v[136:139], v[196:199], v[128:131], v[136:139]
    ds_read_b64_tr_b16 v[214:215], v237 offset:61952
    s_barrier
    v_mfma_f32_16x16x32_bf16 v[140:143], v[184:187], v[108:111], v[140:143]
    ds_read_b64_tr_b16 v[184:185], v238 offset:49152
    v_mfma_f32_16x16x32_bf16 v[140:143], v[188:191], v[116:119], v[140:143]
    ds_read_b64_tr_b16 v[186:187], v238 offset:49664
    v_mfma_f32_16x16x32_bf16 v[140:143], v[192:195], v[124:127], v[140:143]
    ds_read_b64_tr_b16 v[188:189], v238 offset:53248
    v_mfma_f32_16x16x32_bf16 v[140:143], v[196:199], v[132:135], v[140:143]
    ds_read_b64_tr_b16 v[190:191], v238 offset:53760
    s_waitcnt lgkmcnt(8)
    v_mfma_f32_16x16x32_bf16 v[144:147], v[200:203], v[104:107], v[144:147]
    ds_read_b64_tr_b16 v[192:193], v238 offset:57344
    v_mfma_f32_16x16x32_bf16 v[144:147], v[204:207], v[112:115], v[144:147]
    ds_read_b64_tr_b16 v[194:195], v238 offset:57856
    s_waitcnt lgkmcnt(6)
    v_mfma_f32_16x16x32_bf16 v[144:147], v[208:211], v[120:123], v[144:147]
    ds_read_b64_tr_b16 v[196:197], v238 offset:61440
    v_mfma_f32_16x16x32_bf16 v[144:147], v[212:215], v[128:131], v[144:147]
    ds_read_b64_tr_b16 v[198:199], v238 offset:61952
    v_mfma_f32_16x16x32_bf16 v[148:151], v[200:203], v[108:111], v[148:151]
    ds_read_b64_tr_b16 v[200:201], v239 offset:49152
    v_mfma_f32_16x16x32_bf16 v[148:151], v[204:207], v[116:119], v[148:151]
    ds_read_b64_tr_b16 v[202:203], v239 offset:49664
    s_add_u32 s52, s50, 524288
    v_mfma_f32_16x16x32_bf16 v[148:151], v[208:211], v[124:127], v[148:151]
    ds_read_b64_tr_b16 v[204:205], v239 offset:53248
    v_cvt_pk_bf16_f32 v136, v136, v137
    v_mfma_f32_16x16x32_bf16 v[148:151], v[212:215], v[132:135], v[148:151]
    ds_read_b64_tr_b16 v[206:207], v239 offset:53760
    v_cvt_pk_bf16_f32 v137, v138, v139
    s_waitcnt lgkmcnt(8)
    v_mfma_f32_16x16x32_bf16 v[152:155], v[184:187], v[104:107], v[152:155]
    ds_read_b64_tr_b16 v[208:209], v239 offset:57344
    v_cvt_pk_bf16_f32 v138, v144, v145
    v_mfma_f32_16x16x32_bf16 v[152:155], v[188:191], v[112:115], v[152:155]
    ds_read_b64_tr_b16 v[210:211], v239 offset:57856
    v_cvt_pk_bf16_f32 v139, v146, v147
    s_waitcnt lgkmcnt(6)
    v_mfma_f32_16x16x32_bf16 v[152:155], v[192:195], v[120:123], v[152:155]
    ds_read_b64_tr_b16 v[212:213], v239 offset:61440
    buffer_store_dwordx4 v[136:139], v252, s[32:35], s52 offen sc1
    v_mfma_f32_16x16x32_bf16 v[152:155], v[196:199], v[128:131], v[152:155]
    ds_read_b64_tr_b16 v[214:215], v239 offset:61952
    v_mfma_f32_16x16x32_bf16 v[156:159], v[184:187], v[108:111], v[156:159]
    ds_read_b64_tr_b16 v[184:185], v232 offset:32768
    v_mfma_f32_16x16x32_bf16 v[156:159], v[188:191], v[116:119], v[156:159]
    ds_read_b64_tr_b16 v[186:187], v232 offset:33280
    v_mfma_f32_16x16x32_bf16 v[156:159], v[192:195], v[124:127], v[156:159]
    ds_read_b64_tr_b16 v[188:189], v232 offset:36864
    v_cvt_pk_bf16_f32 v140, v140, v141
    v_mfma_f32_16x16x32_bf16 v[156:159], v[196:199], v[132:135], v[156:159]
    ds_read_b64_tr_b16 v[190:191], v232 offset:37376
    v_cvt_pk_bf16_f32 v141, v142, v143
    s_waitcnt lgkmcnt(8)
    v_mfma_f32_16x16x32_bf16 v[160:163], v[200:203], v[104:107], v[160:163]
    ds_read_b64_tr_b16 v[192:193], v232 offset:40960
    v_cvt_pk_bf16_f32 v142, v148, v149
    v_mfma_f32_16x16x32_bf16 v[160:163], v[204:207], v[112:115], v[160:163]
    ds_read_b64_tr_b16 v[194:195], v232 offset:41472
    v_cvt_pk_bf16_f32 v143, v150, v151
    s_waitcnt lgkmcnt(6)
    v_mfma_f32_16x16x32_bf16 v[160:163], v[208:211], v[120:123], v[160:163]
    ds_read_b64_tr_b16 v[196:197], v232 offset:45056
    buffer_store_dwordx4 v[140:143], v252, s[32:35], s52 offen offset:2048 sc1
    v_mfma_f32_16x16x32_bf16 v[160:163], v[212:215], v[128:131], v[160:163]
    ds_read_b64_tr_b16 v[198:199], v232 offset:45568
    v_mfma_f32_16x16x32_bf16 v[164:167], v[200:203], v[108:111], v[164:167]
    ds_read_b64_tr_b16 v[200:201], v233 offset:32768
    v_mfma_f32_16x16x32_bf16 v[164:167], v[204:207], v[116:119], v[164:167]
    ds_read_b64_tr_b16 v[202:203], v233 offset:33280
    v_mfma_f32_16x16x32_bf16 v[164:167], v[208:211], v[124:127], v[164:167]
    ds_read_b64_tr_b16 v[204:205], v233 offset:36864
    v_cvt_pk_bf16_f32 v152, v152, v153
    v_mfma_f32_16x16x32_bf16 v[164:167], v[212:215], v[132:135], v[164:167]
    ds_read_b64_tr_b16 v[206:207], v233 offset:37376
    v_cvt_pk_bf16_f32 v153, v154, v155
    s_waitcnt lgkmcnt(8)
    v_mfma_f32_16x16x32_bf16 v[136:139], v[184:187], v[8:11], 0
    ds_read_b64_tr_b16 v[208:209], v233 offset:40960
    v_cvt_pk_bf16_f32 v154, v160, v161
    v_mfma_f32_16x16x32_bf16 v[136:139], v[188:191], v[16:19], v[136:139]
    ds_read_b64_tr_b16 v[210:211], v233 offset:41472
    v_cvt_pk_bf16_f32 v155, v162, v163
    s_waitcnt lgkmcnt(6)
    v_mfma_f32_16x16x32_bf16 v[136:139], v[192:195], v[24:27], v[136:139]
    ds_read_b64_tr_b16 v[212:213], v233 offset:45056
    buffer_store_dwordx4 v[152:155], v252, s[32:35], s52 offen offset:1024 sc1
    v_mfma_f32_16x16x32_bf16 v[136:139], v[196:199], v[32:35], v[136:139]
    ds_read_b64_tr_b16 v[214:215], v233 offset:45568
    s_barrier
    v_mfma_f32_16x16x32_bf16 v[140:143], v[184:187], v[12:15], 0
    ds_read_b64_tr_b16 v[184:185], v234 offset:32768
    v_mfma_f32_16x16x32_bf16 v[140:143], v[188:191], v[20:23], v[140:143]
    ds_read_b64_tr_b16 v[186:187], v234 offset:33280
    v_mfma_f32_16x16x32_bf16 v[140:143], v[192:195], v[28:31], v[140:143]
    ds_read_b64_tr_b16 v[188:189], v234 offset:36864
    v_cvt_pk_bf16_f32 v156, v156, v157
    v_mfma_f32_16x16x32_bf16 v[140:143], v[196:199], v[36:39], v[140:143]
    ds_read_b64_tr_b16 v[190:191], v234 offset:37376
    v_cvt_pk_bf16_f32 v157, v158, v159
    s_waitcnt lgkmcnt(8)
    v_mfma_f32_16x16x32_bf16 v[144:147], v[200:203], v[8:11], 0
    ds_read_b64_tr_b16 v[192:193], v234 offset:40960
    v_cvt_pk_bf16_f32 v158, v164, v165
    v_mfma_f32_16x16x32_bf16 v[144:147], v[204:207], v[16:19], v[144:147]
    ds_read_b64_tr_b16 v[194:195], v234 offset:41472
    v_cvt_pk_bf16_f32 v159, v166, v167
    s_waitcnt lgkmcnt(6)
    v_mfma_f32_16x16x32_bf16 v[144:147], v[208:211], v[24:27], v[144:147]
    ds_read_b64_tr_b16 v[196:197], v234 offset:45056
    buffer_store_dwordx4 v[156:159], v252, s[32:35], s52 offen offset:3072 sc1
    v_mfma_f32_16x16x32_bf16 v[144:147], v[212:215], v[32:35], v[144:147]
    ds_read_b64_tr_b16 v[198:199], v234 offset:45568
    v_mfma_f32_16x16x32_bf16 v[148:151], v[200:203], v[12:15], 0
    ds_read_b64_tr_b16 v[200:201], v235 offset:32768
    v_mfma_f32_16x16x32_bf16 v[148:151], v[204:207], v[20:23], v[148:151]
    ds_read_b64_tr_b16 v[202:203], v235 offset:33280
    v_mfma_f32_16x16x32_bf16 v[148:151], v[208:211], v[28:31], v[148:151]
    ds_read_b64_tr_b16 v[204:205], v235 offset:36864
    v_mfma_f32_16x16x32_bf16 v[148:151], v[212:215], v[36:39], v[148:151]
    ds_read_b64_tr_b16 v[206:207], v235 offset:37376
    s_waitcnt lgkmcnt(8)
    v_mfma_f32_16x16x32_bf16 v[152:155], v[184:187], v[8:11], 0
    ds_read_b64_tr_b16 v[208:209], v235 offset:40960
    v_mfma_f32_16x16x32_bf16 v[152:155], v[188:191], v[16:19], v[152:155]
    ds_read_b64_tr_b16 v[210:211], v235 offset:41472
    s_waitcnt lgkmcnt(6)
    v_mfma_f32_16x16x32_bf16 v[152:155], v[192:195], v[24:27], v[152:155]
    ds_read_b64_tr_b16 v[212:213], v235 offset:45056
    v_mfma_f32_16x16x32_bf16 v[152:155], v[196:199], v[32:35], v[152:155]
    ds_read_b64_tr_b16 v[214:215], v235 offset:45568
    v_mfma_f32_16x16x32_bf16 v[156:159], v[184:187], v[12:15], 0
    ds_read_b64_tr_b16 v[184:185], v232 offset:49152
    v_mfma_f32_16x16x32_bf16 v[156:159], v[188:191], v[20:23], v[156:159]
    ds_read_b64_tr_b16 v[186:187], v232 offset:49664
    v_mfma_f32_16x16x32_bf16 v[156:159], v[192:195], v[28:31], v[156:159]
    ds_read_b64_tr_b16 v[188:189], v232 offset:53248
    v_mfma_f32_16x16x32_bf16 v[156:159], v[196:199], v[36:39], v[156:159]
    ds_read_b64_tr_b16 v[190:191], v232 offset:53760
    s_waitcnt lgkmcnt(8)
    v_mfma_f32_16x16x32_bf16 v[160:163], v[200:203], v[8:11], 0
    ds_read_b64_tr_b16 v[192:193], v232 offset:57344
    v_mfma_f32_16x16x32_bf16 v[160:163], v[204:207], v[16:19], v[160:163]
    ds_read_b64_tr_b16 v[194:195], v232 offset:57856
    s_waitcnt lgkmcnt(6)
    v_mfma_f32_16x16x32_bf16 v[160:163], v[208:211], v[24:27], v[160:163]
    ds_read_b64_tr_b16 v[196:197], v232 offset:61440
    v_mfma_f32_16x16x32_bf16 v[160:163], v[212:215], v[32:35], v[160:163]
    ds_read_b64_tr_b16 v[198:199], v232 offset:61952
    v_mfma_f32_16x16x32_bf16 v[164:167], v[200:203], v[12:15], 0
    ds_read_b64_tr_b16 v[200:201], v233 offset:49152
    v_mfma_f32_16x16x32_bf16 v[164:167], v[204:207], v[20:23], v[164:167]
    ds_read_b64_tr_b16 v[202:203], v233 offset:49664
    v_mfma_f32_16x16x32_bf16 v[164:167], v[208:211], v[28:31], v[164:167]
    ds_read_b64_tr_b16 v[204:205], v233 offset:53248
    v_mfma_f32_16x16x32_bf16 v[164:167], v[212:215], v[36:39], v[164:167]
    ds_read_b64_tr_b16 v[206:207], v233 offset:53760
    s_waitcnt lgkmcnt(8)
    v_mfma_f32_16x16x32_bf16 v[136:139], v[184:187], v[40:43], v[136:139]
    ds_read_b64_tr_b16 v[208:209], v233 offset:57344
    v_mfma_f32_16x16x32_bf16 v[136:139], v[188:191], v[48:51], v[136:139]
    ds_read_b64_tr_b16 v[210:211], v233 offset:57856
    s_waitcnt lgkmcnt(6)
    v_mfma_f32_16x16x32_bf16 v[136:139], v[192:195], v[56:59], v[136:139]
    ds_read_b64_tr_b16 v[212:213], v233 offset:61440
    v_mfma_f32_16x16x32_bf16 v[136:139], v[196:199], v[64:67], v[136:139]
    ds_read_b64_tr_b16 v[214:215], v233 offset:61952
    s_barrier
    v_mfma_f32_16x16x32_bf16 v[140:143], v[184:187], v[44:47], v[140:143]
    ds_read_b64_tr_b16 v[184:185], v234 offset:49152
    v_mfma_f32_16x16x32_bf16 v[140:143], v[188:191], v[52:55], v[140:143]
    ds_read_b64_tr_b16 v[186:187], v234 offset:49664
    v_mfma_f32_16x16x32_bf16 v[140:143], v[192:195], v[60:63], v[140:143]
    ds_read_b64_tr_b16 v[188:189], v234 offset:53248
    v_mfma_f32_16x16x32_bf16 v[140:143], v[196:199], v[68:71], v[140:143]
    ds_read_b64_tr_b16 v[190:191], v234 offset:53760
    s_waitcnt lgkmcnt(8)
    v_mfma_f32_16x16x32_bf16 v[144:147], v[200:203], v[40:43], v[144:147]
    ds_read_b64_tr_b16 v[192:193], v234 offset:57344
    v_mfma_f32_16x16x32_bf16 v[144:147], v[204:207], v[48:51], v[144:147]
    ds_read_b64_tr_b16 v[194:195], v234 offset:57856
    s_waitcnt lgkmcnt(6)
    v_mfma_f32_16x16x32_bf16 v[144:147], v[208:211], v[56:59], v[144:147]
    ds_read_b64_tr_b16 v[196:197], v234 offset:61440
    v_mfma_f32_16x16x32_bf16 v[144:147], v[212:215], v[64:67], v[144:147]
    ds_read_b64_tr_b16 v[198:199], v234 offset:61952
    v_mfma_f32_16x16x32_bf16 v[148:151], v[200:203], v[44:47], v[148:151]
    ds_read_b64_tr_b16 v[200:201], v235 offset:49152
    v_mfma_f32_16x16x32_bf16 v[148:151], v[204:207], v[52:55], v[148:151]
    ds_read_b64_tr_b16 v[202:203], v235 offset:49664
    v_mfma_f32_16x16x32_bf16 v[148:151], v[208:211], v[60:63], v[148:151]
    ds_read_b64_tr_b16 v[204:205], v235 offset:53248
    v_mfma_f32_16x16x32_bf16 v[148:151], v[212:215], v[68:71], v[148:151]
    ds_read_b64_tr_b16 v[206:207], v235 offset:53760
    s_waitcnt lgkmcnt(8)
    v_mfma_f32_16x16x32_bf16 v[152:155], v[184:187], v[40:43], v[152:155]
    ds_read_b64_tr_b16 v[208:209], v235 offset:57344
    v_mfma_f32_16x16x32_bf16 v[152:155], v[188:191], v[48:51], v[152:155]
    ds_read_b64_tr_b16 v[210:211], v235 offset:57856
    s_waitcnt lgkmcnt(6)
    v_mfma_f32_16x16x32_bf16 v[152:155], v[192:195], v[56:59], v[152:155]
    ds_read_b64_tr_b16 v[212:213], v235 offset:61440
    v_mfma_f32_16x16x32_bf16 v[152:155], v[196:199], v[64:67], v[152:155]
    ds_read_b64_tr_b16 v[214:215], v235 offset:61952
    v_mfma_f32_16x16x32_bf16 v[156:159], v[184:187], v[44:47], v[156:159]
    ds_read_b64_tr_b16 v[184:185], v236 offset:0
    v_mfma_f32_16x16x32_bf16 v[156:159], v[188:191], v[52:55], v[156:159]
    ds_read_b64_tr_b16 v[186:187], v236 offset:512
    v_mfma_f32_16x16x32_bf16 v[156:159], v[192:195], v[60:63], v[156:159]
    ds_read_b64_tr_b16 v[188:189], v236 offset:4096
    v_mfma_f32_16x16x32_bf16 v[156:159], v[196:199], v[68:71], v[156:159]
    ds_read_b64_tr_b16 v[190:191], v236 offset:4608
    s_waitcnt lgkmcnt(8)
    v_mfma_f32_16x16x32_bf16 v[160:163], v[200:203], v[40:43], v[160:163]
    ds_read_b64_tr_b16 v[192:193], v236 offset:8192
    v_mfma_f32_16x16x32_bf16 v[160:163], v[204:207], v[48:51], v[160:163]
    ds_read_b64_tr_b16 v[194:195], v236 offset:8704
    s_waitcnt lgkmcnt(6)
    v_mfma_f32_16x16x32_bf16 v[160:163], v[208:211], v[56:59], v[160:163]
    ds_read_b64_tr_b16 v[196:197], v236 offset:12288
    v_mfma_f32_16x16x32_bf16 v[160:163], v[212:215], v[64:67], v[160:163]
    ds_read_b64_tr_b16 v[198:199], v236 offset:12800
    v_mfma_f32_16x16x32_bf16 v[164:167], v[200:203], v[44:47], v[164:167]
    ds_read_b64_tr_b16 v[200:201], v237 offset:0
    v_mfma_f32_16x16x32_bf16 v[164:167], v[204:207], v[52:55], v[164:167]
    ds_read_b64_tr_b16 v[202:203], v237 offset:512
    v_mfma_f32_16x16x32_bf16 v[164:167], v[208:211], v[60:63], v[164:167]
    ds_read_b64_tr_b16 v[204:205], v237 offset:4096
    v_mfma_f32_16x16x32_bf16 v[164:167], v[212:215], v[68:71], v[164:167]
    ds_read_b64_tr_b16 v[206:207], v237 offset:4608
    s_waitcnt lgkmcnt(8)
    v_mfma_f32_16x16x32_bf16 v[136:139], v[184:187], v[72:75], v[136:139]
    ds_read_b64_tr_b16 v[208:209], v237 offset:8192
    v_mfma_f32_16x16x32_bf16 v[136:139], v[188:191], v[80:83], v[136:139]
    ds_read_b64_tr_b16 v[210:211], v237 offset:8704
    s_waitcnt lgkmcnt(6)
    v_mfma_f32_16x16x32_bf16 v[136:139], v[192:195], v[88:91], v[136:139]
    ds_read_b64_tr_b16 v[212:213], v237 offset:12288
    v_mfma_f32_16x16x32_bf16 v[136:139], v[196:199], v[96:99], v[136:139]
    ds_read_b64_tr_b16 v[214:215], v237 offset:12800
    s_barrier
    v_mfma_f32_16x16x32_bf16 v[140:143], v[184:187], v[76:79], v[140:143]
    ds_read_b64_tr_b16 v[184:185], v238 offset:0
    v_mfma_f32_16x16x32_bf16 v[140:143], v[188:191], v[84:87], v[140:143]
    ds_read_b64_tr_b16 v[186:187], v238 offset:512
    v_mfma_f32_16x16x32_bf16 v[140:143], v[192:195], v[92:95], v[140:143]
    ds_read_b64_tr_b16 v[188:189], v238 offset:4096
    v_mfma_f32_16x16x32_bf16 v[140:143], v[196:199], v[100:103], v[140:143]
    ds_read_b64_tr_b16 v[190:191], v238 offset:4608
    s_waitcnt lgkmcnt(8)
    v_mfma_f32_16x16x32_bf16 v[144:147], v[200:203], v[72:75], v[144:147]
    ds_read_b64_tr_b16 v[192:193], v238 offset:8192
    v_mfma_f32_16x16x32_bf16 v[144:147], v[204:207], v[80:83], v[144:147]
    ds_read_b64_tr_b16 v[194:195], v238 offset:8704
    s_waitcnt lgkmcnt(6)
    v_mfma_f32_16x16x32_bf16 v[144:147], v[208:211], v[88:91], v[144:147]
    ds_read_b64_tr_b16 v[196:197], v238 offset:12288
    v_mfma_f32_16x16x32_bf16 v[144:147], v[212:215], v[96:99], v[144:147]
    ds_read_b64_tr_b16 v[198:199], v238 offset:12800
    v_mfma_f32_16x16x32_bf16 v[148:151], v[200:203], v[76:79], v[148:151]
    ds_read_b64_tr_b16 v[200:201], v239 offset:0
    v_mfma_f32_16x16x32_bf16 v[148:151], v[204:207], v[84:87], v[148:151]
    ds_read_b64_tr_b16 v[202:203], v239 offset:512
    v_mfma_f32_16x16x32_bf16 v[148:151], v[208:211], v[92:95], v[148:151]
    ds_read_b64_tr_b16 v[204:205], v239 offset:4096
    v_mfma_f32_16x16x32_bf16 v[148:151], v[212:215], v[100:103], v[148:151]
    ds_read_b64_tr_b16 v[206:207], v239 offset:4608
    s_waitcnt lgkmcnt(8)
    v_mfma_f32_16x16x32_bf16 v[152:155], v[184:187], v[72:75], v[152:155]
    ds_read_b64_tr_b16 v[208:209], v239 offset:8192
    v_mfma_f32_16x16x32_bf16 v[152:155], v[188:191], v[80:83], v[152:155]
    ds_read_b64_tr_b16 v[210:211], v239 offset:8704
    s_waitcnt lgkmcnt(6)
    v_mfma_f32_16x16x32_bf16 v[152:155], v[192:195], v[88:91], v[152:155]
    ds_read_b64_tr_b16 v[212:213], v239 offset:12288
    v_mfma_f32_16x16x32_bf16 v[152:155], v[196:199], v[96:99], v[152:155]
    ds_read_b64_tr_b16 v[214:215], v239 offset:12800
    v_mfma_f32_16x16x32_bf16 v[156:159], v[184:187], v[76:79], v[156:159]
    ds_read_b64_tr_b16 v[184:185], v236 offset:16384
    v_mfma_f32_16x16x32_bf16 v[156:159], v[188:191], v[84:87], v[156:159]
    ds_read_b64_tr_b16 v[186:187], v236 offset:16896
    v_mfma_f32_16x16x32_bf16 v[156:159], v[192:195], v[92:95], v[156:159]
    ds_read_b64_tr_b16 v[188:189], v236 offset:20480
    v_mfma_f32_16x16x32_bf16 v[156:159], v[196:199], v[100:103], v[156:159]
    ds_read_b64_tr_b16 v[190:191], v236 offset:20992
    s_waitcnt lgkmcnt(8)
    v_mfma_f32_16x16x32_bf16 v[160:163], v[200:203], v[72:75], v[160:163]
    ds_read_b64_tr_b16 v[192:193], v236 offset:24576
    v_mfma_f32_16x16x32_bf16 v[160:163], v[204:207], v[80:83], v[160:163]
    ds_read_b64_tr_b16 v[194:195], v236 offset:25088
    s_waitcnt lgkmcnt(6)
    v_mfma_f32_16x16x32_bf16 v[160:163], v[208:211], v[88:91], v[160:163]
    ds_read_b64_tr_b16 v[196:197], v236 offset:28672
    v_mfma_f32_16x16x32_bf16 v[160:163], v[212:215], v[96:99], v[160:163]
    ds_read_b64_tr_b16 v[198:199], v236 offset:29184
    v_mfma_f32_16x16x32_bf16 v[164:167], v[200:203], v[76:79], v[164:167]
    ds_read_b64_tr_b16 v[200:201], v237 offset:16384
    v_mfma_f32_16x16x32_bf16 v[164:167], v[204:207], v[84:87], v[164:167]
    ds_read_b64_tr_b16 v[202:203], v237 offset:16896
    v_mfma_f32_16x16x32_bf16 v[164:167], v[208:211], v[92:95], v[164:167]
    ds_read_b64_tr_b16 v[204:205], v237 offset:20480
    v_mfma_f32_16x16x32_bf16 v[164:167], v[212:215], v[100:103], v[164:167]
    ds_read_b64_tr_b16 v[206:207], v237 offset:20992
    s_waitcnt lgkmcnt(8)
    v_mfma_f32_16x16x32_bf16 v[136:139], v[184:187], v[104:107], v[136:139]
    ds_read_b64_tr_b16 v[208:209], v237 offset:24576
    v_mfma_f32_16x16x32_bf16 v[136:139], v[188:191], v[112:115], v[136:139]
    ds_read_b64_tr_b16 v[210:211], v237 offset:25088
    s_waitcnt lgkmcnt(6)
    v_mfma_f32_16x16x32_bf16 v[136:139], v[192:195], v[120:123], v[136:139]
    ds_read_b64_tr_b16 v[212:213], v237 offset:28672
    v_mfma_f32_16x16x32_bf16 v[136:139], v[196:199], v[128:131], v[136:139]
    ds_read_b64_tr_b16 v[214:215], v237 offset:29184
    s_barrier
    v_mfma_f32_16x16x32_bf16 v[140:143], v[184:187], v[108:111], v[140:143]
    ds_read_b64_tr_b16 v[184:185], v238 offset:16384
    v_mfma_f32_16x16x32_bf16 v[140:143], v[188:191], v[116:119], v[140:143]
    ds_read_b64_tr_b16 v[186:187], v238 offset:16896
    v_mfma_f32_16x16x32_bf16 v[140:143], v[192:195], v[124:127], v[140:143]
    ds_read_b64_tr_b16 v[188:189], v238 offset:20480
    v_mfma_f32_16x16x32_bf16 v[140:143], v[196:199], v[132:135], v[140:143]
    ds_read_b64_tr_b16 v[190:191], v238 offset:20992
    s_waitcnt lgkmcnt(8)
    v_mfma_f32_16x16x32_bf16 v[144:147], v[200:203], v[104:107], v[144:147]
    ds_read_b64_tr_b16 v[192:193], v238 offset:24576
    v_mfma_f32_16x16x32_bf16 v[144:147], v[204:207], v[112:115], v[144:147]
    ds_read_b64_tr_b16 v[194:195], v238 offset:25088
    s_waitcnt lgkmcnt(6)
    v_mfma_f32_16x16x32_bf16 v[144:147], v[208:211], v[120:123], v[144:147]
    ds_read_b64_tr_b16 v[196:197], v238 offset:28672
    v_mfma_f32_16x16x32_bf16 v[144:147], v[212:215], v[128:131], v[144:147]
    ds_read_b64_tr_b16 v[198:199], v238 offset:29184
    v_mfma_f32_16x16x32_bf16 v[148:151], v[200:203], v[108:111], v[148:151]
    ds_read_b64_tr_b16 v[200:201], v239 offset:16384
    v_mfma_f32_16x16x32_bf16 v[148:151], v[204:207], v[116:119], v[148:151]
    ds_read_b64_tr_b16 v[202:203], v239 offset:16896
    s_add_u32 s52, s50, 655360
    v_mfma_f32_16x16x32_bf16 v[148:151], v[208:211], v[124:127], v[148:151]
    ds_read_b64_tr_b16 v[204:205], v239 offset:20480
    v_cvt_pk_bf16_f32 v136, v136, v137
    v_mfma_f32_16x16x32_bf16 v[148:151], v[212:215], v[132:135], v[148:151]
    ds_read_b64_tr_b16 v[206:207], v239 offset:20992
    v_cvt_pk_bf16_f32 v137, v138, v139
    s_waitcnt lgkmcnt(8)
    v_mfma_f32_16x16x32_bf16 v[152:155], v[184:187], v[104:107], v[152:155]
    ds_read_b64_tr_b16 v[208:209], v239 offset:24576
    v_cvt_pk_bf16_f32 v138, v144, v145
    v_mov_b32 v240, 4
    s_waitcnt vmcnt(4)
    buffer_store_dword v240, v252, s[72:75], 0 offen sc1
    v_mfma_f32_16x16x32_bf16 v[152:155], v[188:191], v[112:115], v[152:155]
    ds_read_b64_tr_b16 v[210:211], v239 offset:25088
    v_cvt_pk_bf16_f32 v139, v146, v147
    s_waitcnt lgkmcnt(6)
    v_mfma_f32_16x16x32_bf16 v[152:155], v[192:195], v[120:123], v[152:155]
    ds_read_b64_tr_b16 v[212:213], v239 offset:28672
    buffer_store_dwordx4 v[136:139], v252, s[32:35], s52 offen sc1
    v_mfma_f32_16x16x32_bf16 v[152:155], v[196:199], v[128:131], v[152:155]
    ds_read_b64_tr_b16 v[214:215], v239 offset:29184
    v_mfma_f32_16x16x32_bf16 v[156:159], v[184:187], v[108:111], v[156:159]
    ds_read_b64_tr_b16 v[184:185], v248 offset:0
    v_mfma_f32_16x16x32_bf16 v[156:159], v[188:191], v[116:119], v[156:159]
    ds_read_b64_tr_b16 v[186:187], v248 offset:512
    v_mfma_f32_16x16x32_bf16 v[156:159], v[192:195], v[124:127], v[156:159]
    ds_read_b64_tr_b16 v[188:189], v248 offset:4096
    v_cvt_pk_bf16_f32 v140, v140, v141
    v_mfma_f32_16x16x32_bf16 v[156:159], v[196:199], v[132:135], v[156:159]
    ds_read_b64_tr_b16 v[190:191], v248 offset:4608
    v_cvt_pk_bf16_f32 v141, v142, v143
    s_waitcnt lgkmcnt(8)
    v_mfma_f32_16x16x32_bf16 v[160:163], v[200:203], v[104:107], v[160:163]
    ds_read_b64_tr_b16 v[192:193], v248 offset:8192
    v_cvt_pk_bf16_f32 v142, v148, v149
    v_mfma_f32_16x16x32_bf16 v[160:163], v[204:207], v[112:115], v[160:163]
    ds_read_b64_tr_b16 v[194:195], v248 offset:8704
    v_cvt_pk_bf16_f32 v143, v150, v151
    s_waitcnt lgkmcnt(6)
    v_mfma_f32_16x16x32_bf16 v[160:163], v[208:211], v[120:123], v[160:163]
    ds_read_b64_tr_b16 v[196:197], v248 offset:12288
    buffer_store_dwordx4 v[140:143], v252, s[32:35], s52 offen offset:2048 sc1
    v_mfma_f32_16x16x32_bf16 v[160:163], v[212:215], v[128:131], v[160:163]
    ds_read_b64_tr_b16 v[198:199], v248 offset:12800
    v_mfma_f32_16x16x32_bf16 v[164:167], v[200:203], v[108:111], v[164:167]
    ds_read_b64_tr_b16 v[200:201], v249 offset:0
    v_mfma_f32_16x16x32_bf16 v[164:167], v[204:207], v[116:119], v[164:167]
    ds_read_b64_tr_b16 v[202:203], v249 offset:512
    v_mfma_f32_16x16x32_bf16 v[164:167], v[208:211], v[124:127], v[164:167]
    ds_read_b64_tr_b16 v[204:205], v249 offset:4096
    v_cvt_pk_bf16_f32 v152, v152, v153
    v_mfma_f32_16x16x32_bf16 v[164:167], v[212:215], v[132:135], v[164:167]
    ds_read_b64_tr_b16 v[206:207], v249 offset:4608
    v_cvt_pk_bf16_f32 v153, v154, v155
    s_waitcnt lgkmcnt(8)
    v_mfma_f32_16x16x32_bf16 v[136:139], v[184:187], v[8:11], 0
    ds_read_b64_tr_b16 v[208:209], v249 offset:8192
    v_cvt_pk_bf16_f32 v154, v160, v161
    v_mfma_f32_16x16x32_bf16 v[136:139], v[188:191], v[16:19], v[136:139]
    ds_read_b64_tr_b16 v[210:211], v249 offset:8704
    v_cvt_pk_bf16_f32 v155, v162, v163
    s_waitcnt lgkmcnt(6)
    v_mfma_f32_16x16x32_bf16 v[136:139], v[192:195], v[24:27], v[136:139]
    ds_read_b64_tr_b16 v[212:213], v249 offset:12288
    buffer_store_dwordx4 v[152:155], v252, s[32:35], s52 offen offset:1024 sc1
    v_mfma_f32_16x16x32_bf16 v[136:139], v[196:199], v[32:35], v[136:139]
    ds_read_b64_tr_b16 v[214:215], v249 offset:12800
    s_barrier
    v_mfma_f32_16x16x32_bf16 v[140:143], v[184:187], v[12:15], 0
    ds_read_b64_tr_b16 v[184:185], v250 offset:0
    v_mfma_f32_16x16x32_bf16 v[140:143], v[188:191], v[20:23], v[140:143]
    ds_read_b64_tr_b16 v[186:187], v250 offset:512
    v_mfma_f32_16x16x32_bf16 v[140:143], v[192:195], v[28:31], v[140:143]
    ds_read_b64_tr_b16 v[188:189], v250 offset:4096
    v_cvt_pk_bf16_f32 v156, v156, v157
    v_mfma_f32_16x16x32_bf16 v[140:143], v[196:199], v[36:39], v[140:143]
    ds_read_b64_tr_b16 v[190:191], v250 offset:4608
    v_cvt_pk_bf16_f32 v157, v158, v159
    s_waitcnt lgkmcnt(8)
    v_mfma_f32_16x16x32_bf16 v[144:147], v[200:203], v[8:11], 0
    ds_read_b64_tr_b16 v[192:193], v250 offset:8192
    v_cvt_pk_bf16_f32 v158, v164, v165
    v_mfma_f32_16x16x32_bf16 v[144:147], v[204:207], v[16:19], v[144:147]
    ds_read_b64_tr_b16 v[194:195], v250 offset:8704
    v_cvt_pk_bf16_f32 v159, v166, v167
    s_waitcnt lgkmcnt(6)
    v_mfma_f32_16x16x32_bf16 v[144:147], v[208:211], v[24:27], v[144:147]
    ds_read_b64_tr_b16 v[196:197], v250 offset:12288
    buffer_store_dwordx4 v[156:159], v252, s[32:35], s52 offen offset:3072 sc1
    v_mfma_f32_16x16x32_bf16 v[144:147], v[212:215], v[32:35], v[144:147]
    ds_read_b64_tr_b16 v[198:199], v250 offset:12800
    v_mfma_f32_16x16x32_bf16 v[148:151], v[200:203], v[12:15], 0
    ds_read_b64_tr_b16 v[200:201], v251 offset:0
    v_mfma_f32_16x16x32_bf16 v[148:151], v[204:207], v[20:23], v[148:151]
    ds_read_b64_tr_b16 v[202:203], v251 offset:512
    v_mfma_f32_16x16x32_bf16 v[148:151], v[208:211], v[28:31], v[148:151]
    ds_read_b64_tr_b16 v[204:205], v251 offset:4096
    v_mfma_f32_16x16x32_bf16 v[148:151], v[212:215], v[36:39], v[148:151]
    ds_read_b64_tr_b16 v[206:207], v251 offset:4608
    s_waitcnt lgkmcnt(8)
    v_mfma_f32_16x16x32_bf16 v[152:155], v[184:187], v[8:11], 0
    ds_read_b64_tr_b16 v[208:209], v251 offset:8192
    v_mfma_f32_16x16x32_bf16 v[152:155], v[188:191], v[16:19], v[152:155]
    ds_read_b64_tr_b16 v[210:211], v251 offset:8704
    s_waitcnt lgkmcnt(6)
    v_mfma_f32_16x16x32_bf16 v[152:155], v[192:195], v[24:27], v[152:155]
    ds_read_b64_tr_b16 v[212:213], v251 offset:12288
    v_mfma_f32_16x16x32_bf16 v[152:155], v[196:199], v[32:35], v[152:155]
    ds_read_b64_tr_b16 v[214:215], v251 offset:12800
    v_mfma_f32_16x16x32_bf16 v[156:159], v[184:187], v[12:15], 0
    ds_read_b64_tr_b16 v[184:185], v248 offset:16384
    v_mfma_f32_16x16x32_bf16 v[156:159], v[188:191], v[20:23], v[156:159]
    ds_read_b64_tr_b16 v[186:187], v248 offset:16896
    v_mfma_f32_16x16x32_bf16 v[156:159], v[192:195], v[28:31], v[156:159]
    ds_read_b64_tr_b16 v[188:189], v248 offset:20480
    v_mfma_f32_16x16x32_bf16 v[156:159], v[196:199], v[36:39], v[156:159]
    ds_read_b64_tr_b16 v[190:191], v248 offset:20992
    s_waitcnt lgkmcnt(8)
    v_mfma_f32_16x16x32_bf16 v[160:163], v[200:203], v[8:11], 0
    ds_read_b64_tr_b16 v[192:193], v248 offset:24576
    v_mfma_f32_16x16x32_bf16 v[160:163], v[204:207], v[16:19], v[160:163]
    ds_read_b64_tr_b16 v[194:195], v248 offset:25088
    s_waitcnt lgkmcnt(6)
    v_mfma_f32_16x16x32_bf16 v[160:163], v[208:211], v[24:27], v[160:163]
    ds_read_b64_tr_b16 v[196:197], v248 offset:28672
    v_mfma_f32_16x16x32_bf16 v[160:163], v[212:215], v[32:35], v[160:163]
    ds_read_b64_tr_b16 v[198:199], v248 offset:29184
    v_mfma_f32_16x16x32_bf16 v[164:167], v[200:203], v[12:15], 0
    ds_read_b64_tr_b16 v[200:201], v249 offset:16384
    v_mfma_f32_16x16x32_bf16 v[164:167], v[204:207], v[20:23], v[164:167]
    ds_read_b64_tr_b16 v[202:203], v249 offset:16896
    v_mfma_f32_16x16x32_bf16 v[164:167], v[208:211], v[28:31], v[164:167]
    ds_read_b64_tr_b16 v[204:205], v249 offset:20480
    v_mfma_f32_16x16x32_bf16 v[164:167], v[212:215], v[36:39], v[164:167]
    ds_read_b64_tr_b16 v[206:207], v249 offset:20992
    s_waitcnt lgkmcnt(8)
    v_mfma_f32_16x16x32_bf16 v[136:139], v[184:187], v[40:43], v[136:139]
    ds_read_b64_tr_b16 v[208:209], v249 offset:24576
    v_mfma_f32_16x16x32_bf16 v[136:139], v[188:191], v[48:51], v[136:139]
    ds_read_b64_tr_b16 v[210:211], v249 offset:25088
    s_waitcnt lgkmcnt(6)
    v_mfma_f32_16x16x32_bf16 v[136:139], v[192:195], v[56:59], v[136:139]
    ds_read_b64_tr_b16 v[212:213], v249 offset:28672
    v_mfma_f32_16x16x32_bf16 v[136:139], v[196:199], v[64:67], v[136:139]
    ds_read_b64_tr_b16 v[214:215], v249 offset:29184
    s_barrier
    v_mfma_f32_16x16x32_bf16 v[140:143], v[184:187], v[44:47], v[140:143]
    ds_read_b64_tr_b16 v[184:185], v250 offset:16384
    v_mfma_f32_16x16x32_bf16 v[140:143], v[188:191], v[52:55], v[140:143]
    ds_read_b64_tr_b16 v[186:187], v250 offset:16896
    v_mfma_f32_16x16x32_bf16 v[140:143], v[192:195], v[60:63], v[140:143]
    ds_read_b64_tr_b16 v[188:189], v250 offset:20480
    v_mfma_f32_16x16x32_bf16 v[140:143], v[196:199], v[68:71], v[140:143]
    ds_read_b64_tr_b16 v[190:191], v250 offset:20992
    s_waitcnt lgkmcnt(8)
    v_mfma_f32_16x16x32_bf16 v[144:147], v[200:203], v[40:43], v[144:147]
    ds_read_b64_tr_b16 v[192:193], v250 offset:24576
    v_mfma_f32_16x16x32_bf16 v[144:147], v[204:207], v[48:51], v[144:147]
    ds_read_b64_tr_b16 v[194:195], v250 offset:25088
    s_waitcnt lgkmcnt(6)
    v_mfma_f32_16x16x32_bf16 v[144:147], v[208:211], v[56:59], v[144:147]
    ds_read_b64_tr_b16 v[196:197], v250 offset:28672
    v_mfma_f32_16x16x32_bf16 v[144:147], v[212:215], v[64:67], v[144:147]
    ds_read_b64_tr_b16 v[198:199], v250 offset:29184
    v_mfma_f32_16x16x32_bf16 v[148:151], v[200:203], v[44:47], v[148:151]
    ds_read_b64_tr_b16 v[200:201], v251 offset:16384
    v_mfma_f32_16x16x32_bf16 v[148:151], v[204:207], v[52:55], v[148:151]
    ds_read_b64_tr_b16 v[202:203], v251 offset:16896
    v_mfma_f32_16x16x32_bf16 v[148:151], v[208:211], v[60:63], v[148:151]
    ds_read_b64_tr_b16 v[204:205], v251 offset:20480
    v_mfma_f32_16x16x32_bf16 v[148:151], v[212:215], v[68:71], v[148:151]
    ds_read_b64_tr_b16 v[206:207], v251 offset:20992
    s_waitcnt lgkmcnt(8)
    v_mfma_f32_16x16x32_bf16 v[152:155], v[184:187], v[40:43], v[152:155]
    ds_read_b64_tr_b16 v[208:209], v251 offset:24576
    v_mfma_f32_16x16x32_bf16 v[152:155], v[188:191], v[48:51], v[152:155]
    ds_read_b64_tr_b16 v[210:211], v251 offset:25088
    s_waitcnt lgkmcnt(6)
    v_mfma_f32_16x16x32_bf16 v[152:155], v[192:195], v[56:59], v[152:155]
    ds_read_b64_tr_b16 v[212:213], v251 offset:28672
    v_mfma_f32_16x16x32_bf16 v[152:155], v[196:199], v[64:67], v[152:155]
    ds_read_b64_tr_b16 v[214:215], v251 offset:29184
    v_mfma_f32_16x16x32_bf16 v[156:159], v[184:187], v[44:47], v[156:159]
    ds_read_b64_tr_b16 v[184:185], v232 offset:0
    v_mfma_f32_16x16x32_bf16 v[156:159], v[188:191], v[52:55], v[156:159]
    ds_read_b64_tr_b16 v[186:187], v232 offset:512
    v_mfma_f32_16x16x32_bf16 v[156:159], v[192:195], v[60:63], v[156:159]
    ds_read_b64_tr_b16 v[188:189], v232 offset:4096
    v_mfma_f32_16x16x32_bf16 v[156:159], v[196:199], v[68:71], v[156:159]
    ds_read_b64_tr_b16 v[190:191], v232 offset:4608
    s_waitcnt lgkmcnt(8)
    v_mfma_f32_16x16x32_bf16 v[160:163], v[200:203], v[40:43], v[160:163]
    ds_read_b64_tr_b16 v[192:193], v232 offset:8192
    v_mfma_f32_16x16x32_bf16 v[160:163], v[204:207], v[48:51], v[160:163]
    ds_read_b64_tr_b16 v[194:195], v232 offset:8704
    s_waitcnt lgkmcnt(6)
    v_mfma_f32_16x16x32_bf16 v[160:163], v[208:211], v[56:59], v[160:163]
    ds_read_b64_tr_b16 v[196:197], v232 offset:12288
    v_mfma_f32_16x16x32_bf16 v[160:163], v[212:215], v[64:67], v[160:163]
    ds_read_b64_tr_b16 v[198:199], v232 offset:12800
    v_mfma_f32_16x16x32_bf16 v[164:167], v[200:203], v[44:47], v[164:167]
    ds_read_b64_tr_b16 v[200:201], v233 offset:0
    v_mfma_f32_16x16x32_bf16 v[164:167], v[204:207], v[52:55], v[164:167]
    ds_read_b64_tr_b16 v[202:203], v233 offset:512
    v_mfma_f32_16x16x32_bf16 v[164:167], v[208:211], v[60:63], v[164:167]
    ds_read_b64_tr_b16 v[204:205], v233 offset:4096
    v_mfma_f32_16x16x32_bf16 v[164:167], v[212:215], v[68:71], v[164:167]
    ds_read_b64_tr_b16 v[206:207], v233 offset:4608
    s_waitcnt lgkmcnt(8)
    v_mfma_f32_16x16x32_bf16 v[136:139], v[184:187], v[72:75], v[136:139]
    ds_read_b64_tr_b16 v[208:209], v233 offset:8192
    v_mfma_f32_16x16x32_bf16 v[136:139], v[188:191], v[80:83], v[136:139]
    ds_read_b64_tr_b16 v[210:211], v233 offset:8704
    s_waitcnt lgkmcnt(6)
    v_mfma_f32_16x16x32_bf16 v[136:139], v[192:195], v[88:91], v[136:139]
    ds_read_b64_tr_b16 v[212:213], v233 offset:12288
    v_mfma_f32_16x16x32_bf16 v[136:139], v[196:199], v[96:99], v[136:139]
    ds_read_b64_tr_b16 v[214:215], v233 offset:12800
    s_barrier
    v_mfma_f32_16x16x32_bf16 v[140:143], v[184:187], v[76:79], v[140:143]
    ds_read_b64_tr_b16 v[184:185], v234 offset:0
    v_mfma_f32_16x16x32_bf16 v[140:143], v[188:191], v[84:87], v[140:143]
    ds_read_b64_tr_b16 v[186:187], v234 offset:512
    v_mfma_f32_16x16x32_bf16 v[140:143], v[192:195], v[92:95], v[140:143]
    ds_read_b64_tr_b16 v[188:189], v234 offset:4096
    v_mfma_f32_16x16x32_bf16 v[140:143], v[196:199], v[100:103], v[140:143]
    ds_read_b64_tr_b16 v[190:191], v234 offset:4608
    s_waitcnt lgkmcnt(8)
    v_mfma_f32_16x16x32_bf16 v[144:147], v[200:203], v[72:75], v[144:147]
    ds_read_b64_tr_b16 v[192:193], v234 offset:8192
    v_mfma_f32_16x16x32_bf16 v[144:147], v[204:207], v[80:83], v[144:147]
    ds_read_b64_tr_b16 v[194:195], v234 offset:8704
    s_waitcnt lgkmcnt(6)
    v_mfma_f32_16x16x32_bf16 v[144:147], v[208:211], v[88:91], v[144:147]
    ds_read_b64_tr_b16 v[196:197], v234 offset:12288
    v_mfma_f32_16x16x32_bf16 v[144:147], v[212:215], v[96:99], v[144:147]
    ds_read_b64_tr_b16 v[198:199], v234 offset:12800
    v_mfma_f32_16x16x32_bf16 v[148:151], v[200:203], v[76:79], v[148:151]
    ds_read_b64_tr_b16 v[200:201], v235 offset:0
    v_mfma_f32_16x16x32_bf16 v[148:151], v[204:207], v[84:87], v[148:151]
    ds_read_b64_tr_b16 v[202:203], v235 offset:512
    v_mfma_f32_16x16x32_bf16 v[148:151], v[208:211], v[92:95], v[148:151]
    ds_read_b64_tr_b16 v[204:205], v235 offset:4096
    v_mfma_f32_16x16x32_bf16 v[148:151], v[212:215], v[100:103], v[148:151]
    ds_read_b64_tr_b16 v[206:207], v235 offset:4608
    s_waitcnt lgkmcnt(8)
    v_mfma_f32_16x16x32_bf16 v[152:155], v[184:187], v[72:75], v[152:155]
    ds_read_b64_tr_b16 v[208:209], v235 offset:8192
    v_mfma_f32_16x16x32_bf16 v[152:155], v[188:191], v[80:83], v[152:155]
    ds_read_b64_tr_b16 v[210:211], v235 offset:8704
    s_waitcnt lgkmcnt(6)
    v_mfma_f32_16x16x32_bf16 v[152:155], v[192:195], v[88:91], v[152:155]
    ds_read_b64_tr_b16 v[212:213], v235 offset:12288
    v_mfma_f32_16x16x32_bf16 v[152:155], v[196:199], v[96:99], v[152:155]
    ds_read_b64_tr_b16 v[214:215], v235 offset:12800
    v_mfma_f32_16x16x32_bf16 v[156:159], v[184:187], v[76:79], v[156:159]
    ds_read_b64_tr_b16 v[184:185], v232 offset:16384
    v_mfma_f32_16x16x32_bf16 v[156:159], v[188:191], v[84:87], v[156:159]
    ds_read_b64_tr_b16 v[186:187], v232 offset:16896
    v_mfma_f32_16x16x32_bf16 v[156:159], v[192:195], v[92:95], v[156:159]
    ds_read_b64_tr_b16 v[188:189], v232 offset:20480
    v_mfma_f32_16x16x32_bf16 v[156:159], v[196:199], v[100:103], v[156:159]
    ds_read_b64_tr_b16 v[190:191], v232 offset:20992
    s_waitcnt lgkmcnt(8)
    v_mfma_f32_16x16x32_bf16 v[160:163], v[200:203], v[72:75], v[160:163]
    ds_read_b64_tr_b16 v[192:193], v232 offset:24576
    v_mfma_f32_16x16x32_bf16 v[160:163], v[204:207], v[80:83], v[160:163]
    ds_read_b64_tr_b16 v[194:195], v232 offset:25088
    s_waitcnt lgkmcnt(6)
    v_mfma_f32_16x16x32_bf16 v[160:163], v[208:211], v[88:91], v[160:163]
    ds_read_b64_tr_b16 v[196:197], v232 offset:28672
    v_mfma_f32_16x16x32_bf16 v[160:163], v[212:215], v[96:99], v[160:163]
    ds_read_b64_tr_b16 v[198:199], v232 offset:29184
    v_mfma_f32_16x16x32_bf16 v[164:167], v[200:203], v[76:79], v[164:167]
    ds_read_b64_tr_b16 v[200:201], v233 offset:16384
    v_mfma_f32_16x16x32_bf16 v[164:167], v[204:207], v[84:87], v[164:167]
    ds_read_b64_tr_b16 v[202:203], v233 offset:16896
    v_mfma_f32_16x16x32_bf16 v[164:167], v[208:211], v[92:95], v[164:167]
    ds_read_b64_tr_b16 v[204:205], v233 offset:20480
    v_mfma_f32_16x16x32_bf16 v[164:167], v[212:215], v[100:103], v[164:167]
    ds_read_b64_tr_b16 v[206:207], v233 offset:20992
    s_waitcnt lgkmcnt(8)
    v_mfma_f32_16x16x32_bf16 v[136:139], v[184:187], v[104:107], v[136:139]
    ds_read_b64_tr_b16 v[208:209], v233 offset:24576
    v_mfma_f32_16x16x32_bf16 v[136:139], v[188:191], v[112:115], v[136:139]
    ds_read_b64_tr_b16 v[210:211], v233 offset:25088
    s_waitcnt lgkmcnt(6)
    v_mfma_f32_16x16x32_bf16 v[136:139], v[192:195], v[120:123], v[136:139]
    ds_read_b64_tr_b16 v[212:213], v233 offset:28672
    v_mfma_f32_16x16x32_bf16 v[136:139], v[196:199], v[128:131], v[136:139]
    ds_read_b64_tr_b16 v[214:215], v233 offset:29184
    v_mfma_f32_16x16x32_bf16 v[140:143], v[184:187], v[108:111], v[140:143]
    ds_read_b64_tr_b16 v[184:185], v234 offset:16384
    v_mfma_f32_16x16x32_bf16 v[140:143], v[188:191], v[116:119], v[140:143]
    ds_read_b64_tr_b16 v[186:187], v234 offset:16896
    v_mfma_f32_16x16x32_bf16 v[140:143], v[192:195], v[124:127], v[140:143]
    ds_read_b64_tr_b16 v[188:189], v234 offset:20480
    v_mfma_f32_16x16x32_bf16 v[140:143], v[196:199], v[132:135], v[140:143]
    ds_read_b64_tr_b16 v[190:191], v234 offset:20992
    s_waitcnt lgkmcnt(8)
    v_mfma_f32_16x16x32_bf16 v[144:147], v[200:203], v[104:107], v[144:147]
    ds_read_b64_tr_b16 v[192:193], v234 offset:24576
    v_mfma_f32_16x16x32_bf16 v[144:147], v[204:207], v[112:115], v[144:147]
    ds_read_b64_tr_b16 v[194:195], v234 offset:25088
    s_waitcnt lgkmcnt(6)
    v_mfma_f32_16x16x32_bf16 v[144:147], v[208:211], v[120:123], v[144:147]
    ds_read_b64_tr_b16 v[196:197], v234 offset:28672
    v_mfma_f32_16x16x32_bf16 v[144:147], v[212:215], v[128:131], v[144:147]
    ds_read_b64_tr_b16 v[198:199], v234 offset:29184
    v_mfma_f32_16x16x32_bf16 v[148:151], v[200:203], v[108:111], v[148:151]
    ds_read_b64_tr_b16 v[200:201], v235 offset:16384
    v_mfma_f32_16x16x32_bf16 v[148:151], v[204:207], v[116:119], v[148:151]
    ds_read_b64_tr_b16 v[202:203], v235 offset:16896
    s_add_u32 s52, s50, 786432
    v_mfma_f32_16x16x32_bf16 v[148:151], v[208:211], v[124:127], v[148:151]
    ds_read_b64_tr_b16 v[204:205], v235 offset:20480
    v_cvt_pk_bf16_f32 v136, v136, v137
    v_mfma_f32_16x16x32_bf16 v[148:151], v[212:215], v[132:135], v[148:151]
    ds_read_b64_tr_b16 v[206:207], v235 offset:20992
    v_cvt_pk_bf16_f32 v137, v138, v139
    s_waitcnt lgkmcnt(8)
    v_mfma_f32_16x16x32_bf16 v[152:155], v[184:187], v[104:107], v[152:155]
    ds_read_b64_tr_b16 v[208:209], v235 offset:24576
    v_cvt_pk_bf16_f32 v138, v144, v145
    v_mfma_f32_16x16x32_bf16 v[152:155], v[188:191], v[112:115], v[152:155]
    ds_read_b64_tr_b16 v[210:211], v235 offset:25088
    v_cvt_pk_bf16_f32 v139, v146, v147
    s_waitcnt lgkmcnt(6)
    v_mfma_f32_16x16x32_bf16 v[152:155], v[192:195], v[120:123], v[152:155]
    ds_read_b64_tr_b16 v[212:213], v235 offset:28672
    buffer_store_dwordx4 v[136:139], v252, s[32:35], s52 offen sc1
    v_mfma_f32_16x16x32_bf16 v[152:155], v[196:199], v[128:131], v[152:155]
    ds_read_b64_tr_b16 v[214:215], v235 offset:29184
    v_mfma_f32_16x16x32_bf16 v[156:159], v[184:187], v[108:111], v[156:159]
    ds_read_b64_tr_b16 v[184:185], v236 offset:32768
    v_mfma_f32_16x16x32_bf16 v[156:159], v[188:191], v[116:119], v[156:159]
    ds_read_b64_tr_b16 v[186:187], v236 offset:33280
    v_mfma_f32_16x16x32_bf16 v[156:159], v[192:195], v[124:127], v[156:159]
    ds_read_b64_tr_b16 v[188:189], v236 offset:36864
    v_cvt_pk_bf16_f32 v140, v140, v141
    v_mfma_f32_16x16x32_bf16 v[156:159], v[196:199], v[132:135], v[156:159]
    ds_read_b64_tr_b16 v[190:191], v236 offset:37376
    v_cvt_pk_bf16_f32 v141, v142, v143
    s_waitcnt lgkmcnt(8)
    v_mfma_f32_16x16x32_bf16 v[160:163], v[200:203], v[104:107], v[160:163]
    ds_read_b64_tr_b16 v[192:193], v236 offset:40960
    v_cvt_pk_bf16_f32 v142, v148, v149
    v_mfma_f32_16x16x32_bf16 v[160:163], v[204:207], v[112:115], v[160:163]
    ds_read_b64_tr_b16 v[194:195], v236 offset:41472
    v_cvt_pk_bf16_f32 v143, v150, v151
    s_waitcnt lgkmcnt(6)
    v_mfma_f32_16x16x32_bf16 v[160:163], v[208:211], v[120:123], v[160:163]
    ds_read_b64_tr_b16 v[196:197], v236 offset:45056
    buffer_store_dwordx4 v[140:143], v252, s[32:35], s52 offen offset:2048 sc1
    v_mfma_f32_16x16x32_bf16 v[160:163], v[212:215], v[128:131], v[160:163]
    ds_read_b64_tr_b16 v[198:199], v236 offset:45568
    v_mfma_f32_16x16x32_bf16 v[164:167], v[200:203], v[108:111], v[164:167]
    ds_read_b64_tr_b16 v[200:201], v237 offset:32768
    v_mfma_f32_16x16x32_bf16 v[164:167], v[204:207], v[116:119], v[164:167]
    ds_read_b64_tr_b16 v[202:203], v237 offset:33280
    v_mfma_f32_16x16x32_bf16 v[164:167], v[208:211], v[124:127], v[164:167]
    ds_read_b64_tr_b16 v[204:205], v237 offset:36864
    v_cvt_pk_bf16_f32 v152, v152, v153
    v_mfma_f32_16x16x32_bf16 v[164:167], v[212:215], v[132:135], v[164:167]
    ds_read_b64_tr_b16 v[206:207], v237 offset:37376
    v_cvt_pk_bf16_f32 v153, v154, v155
    s_waitcnt lgkmcnt(8)
    v_mfma_f32_16x16x32_bf16 v[136:139], v[184:187], v[8:11], 0
    ds_read_b64_tr_b16 v[208:209], v237 offset:40960
    v_cvt_pk_bf16_f32 v154, v160, v161
    v_mfma_f32_16x16x32_bf16 v[136:139], v[188:191], v[16:19], v[136:139]
    ds_read_b64_tr_b16 v[210:211], v237 offset:41472
    v_cvt_pk_bf16_f32 v155, v162, v163
    s_waitcnt lgkmcnt(6)
    v_mfma_f32_16x16x32_bf16 v[136:139], v[192:195], v[24:27], v[136:139]
    ds_read_b64_tr_b16 v[212:213], v237 offset:45056
    buffer_store_dwordx4 v[152:155], v252, s[32:35], s52 offen offset:1024 sc1
    v_mfma_f32_16x16x32_bf16 v[136:139], v[196:199], v[32:35], v[136:139]
    ds_read_b64_tr_b16 v[214:215], v237 offset:45568
    v_mfma_f32_16x16x32_bf16 v[140:143], v[184:187], v[12:15], 0
    ds_read_b64_tr_b16 v[184:185], v238 offset:32768
    v_mfma_f32_16x16x32_bf16 v[140:143], v[188:191], v[20:23], v[140:143]
    ds_read_b64_tr_b16 v[186:187], v238 offset:33280
    v_mfma_f32_16x16x32_bf16 v[140:143], v[192:195], v[28:31], v[140:143]
    ds_read_b64_tr_b16 v[188:189], v238 offset:36864
    v_cvt_pk_bf16_f32 v156, v156, v157
    v_mfma_f32_16x16x32_bf16 v[140:143], v[196:199], v[36:39], v[140:143]
    ds_read_b64_tr_b16 v[190:191], v238 offset:37376
    v_cvt_pk_bf16_f32 v157, v158, v159
    s_waitcnt lgkmcnt(8)
    v_mfma_f32_16x16x32_bf16 v[144:147], v[200:203], v[8:11], 0
    ds_read_b64_tr_b16 v[192:193], v238 offset:40960
    v_cvt_pk_bf16_f32 v158, v164, v165
    v_mfma_f32_16x16x32_bf16 v[144:147], v[204:207], v[16:19], v[144:147]
    ds_read_b64_tr_b16 v[194:195], v238 offset:41472
    v_cvt_pk_bf16_f32 v159, v166, v167
    s_waitcnt lgkmcnt(6)
    v_mfma_f32_16x16x32_bf16 v[144:147], v[208:211], v[24:27], v[144:147]
    ds_read_b64_tr_b16 v[196:197], v238 offset:45056
    buffer_store_dwordx4 v[156:159], v252, s[32:35], s52 offen offset:3072 sc1
    v_mfma_f32_16x16x32_bf16 v[144:147], v[212:215], v[32:35], v[144:147]
    ds_read_b64_tr_b16 v[198:199], v238 offset:45568
    v_mfma_f32_16x16x32_bf16 v[148:151], v[200:203], v[12:15], 0
    ds_read_b64_tr_b16 v[200:201], v239 offset:32768
    v_mfma_f32_16x16x32_bf16 v[148:151], v[204:207], v[20:23], v[148:151]
    ds_read_b64_tr_b16 v[202:203], v239 offset:33280
    v_mfma_f32_16x16x32_bf16 v[148:151], v[208:211], v[28:31], v[148:151]
    ds_read_b64_tr_b16 v[204:205], v239 offset:36864
    v_mfma_f32_16x16x32_bf16 v[148:151], v[212:215], v[36:39], v[148:151]
    ds_read_b64_tr_b16 v[206:207], v239 offset:37376
    s_waitcnt lgkmcnt(8)
    v_mfma_f32_16x16x32_bf16 v[152:155], v[184:187], v[8:11], 0
    ds_read_b64_tr_b16 v[208:209], v239 offset:40960
    v_mfma_f32_16x16x32_bf16 v[152:155], v[188:191], v[16:19], v[152:155]
    ds_read_b64_tr_b16 v[210:211], v239 offset:41472
    s_waitcnt lgkmcnt(6)
    v_mfma_f32_16x16x32_bf16 v[152:155], v[192:195], v[24:27], v[152:155]
    ds_read_b64_tr_b16 v[212:213], v239 offset:45056
    v_mfma_f32_16x16x32_bf16 v[152:155], v[196:199], v[32:35], v[152:155]
    ds_read_b64_tr_b16 v[214:215], v239 offset:45568
    v_mfma_f32_16x16x32_bf16 v[156:159], v[184:187], v[12:15], 0
    ds_read_b64_tr_b16 v[184:185], v236 offset:49152
    v_mfma_f32_16x16x32_bf16 v[156:159], v[188:191], v[20:23], v[156:159]
    ds_read_b64_tr_b16 v[186:187], v236 offset:49664
    v_mfma_f32_16x16x32_bf16 v[156:159], v[192:195], v[28:31], v[156:159]
    ds_read_b64_tr_b16 v[188:189], v236 offset:53248
    v_mfma_f32_16x16x32_bf16 v[156:159], v[196:199], v[36:39], v[156:159]
    ds_read_b64_tr_b16 v[190:191], v236 offset:53760
    s_waitcnt lgkmcnt(8)
    v_mfma_f32_16x16x32_bf16 v[160:163], v[200:203], v[8:11], 0
    ds_read_b64_tr_b16 v[192:193], v236 offset:57344
    v_mfma_f32_16x16x32_bf16 v[160:163], v[204:207], v[16:19], v[160:163]
    ds_read_b64_tr_b16 v[194:195], v236 offset:57856
    s_waitcnt lgkmcnt(6)
    v_mfma_f32_16x16x32_bf16 v[160:163], v[208:211], v[24:27], v[160:163]
    ds_read_b64_tr_b16 v[196:197], v236 offset:61440
    v_mfma_f32_16x16x32_bf16 v[160:163], v[212:215], v[32:35], v[160:163]
    ds_read_b64_tr_b16 v[198:199], v236 offset:61952
    v_mfma_f32_16x16x32_bf16 v[164:167], v[200:203], v[12:15], 0
    ds_read_b64_tr_b16 v[200:201], v237 offset:49152
    v_mfma_f32_16x16x32_bf16 v[164:167], v[204:207], v[20:23], v[164:167]
    ds_read_b64_tr_b16 v[202:203], v237 offset:49664
    v_mfma_f32_16x16x32_bf16 v[164:167], v[208:211], v[28:31], v[164:167]
    ds_read_b64_tr_b16 v[204:205], v237 offset:53248
    v_mfma_f32_16x16x32_bf16 v[164:167], v[212:215], v[36:39], v[164:167]
    ds_read_b64_tr_b16 v[206:207], v237 offset:53760
    s_waitcnt lgkmcnt(8)
    v_mfma_f32_16x16x32_bf16 v[136:139], v[184:187], v[40:43], v[136:139]
    ds_read_b64_tr_b16 v[208:209], v237 offset:57344
    v_mfma_f32_16x16x32_bf16 v[136:139], v[188:191], v[48:51], v[136:139]
    ds_read_b64_tr_b16 v[210:211], v237 offset:57856
    s_waitcnt lgkmcnt(6)
    v_mfma_f32_16x16x32_bf16 v[136:139], v[192:195], v[56:59], v[136:139]
    ds_read_b64_tr_b16 v[212:213], v237 offset:61440
    v_mfma_f32_16x16x32_bf16 v[136:139], v[196:199], v[64:67], v[136:139]
    ds_read_b64_tr_b16 v[214:215], v237 offset:61952
    v_mfma_f32_16x16x32_bf16 v[140:143], v[184:187], v[44:47], v[140:143]
    ds_read_b64_tr_b16 v[184:185], v238 offset:49152
    v_mfma_f32_16x16x32_bf16 v[140:143], v[188:191], v[52:55], v[140:143]
    ds_read_b64_tr_b16 v[186:187], v238 offset:49664
    v_mfma_f32_16x16x32_bf16 v[140:143], v[192:195], v[60:63], v[140:143]
    ds_read_b64_tr_b16 v[188:189], v238 offset:53248
    v_mfma_f32_16x16x32_bf16 v[140:143], v[196:199], v[68:71], v[140:143]
    ds_read_b64_tr_b16 v[190:191], v238 offset:53760
    s_waitcnt lgkmcnt(8)
    v_mfma_f32_16x16x32_bf16 v[144:147], v[200:203], v[40:43], v[144:147]
    ds_read_b64_tr_b16 v[192:193], v238 offset:57344
    v_mfma_f32_16x16x32_bf16 v[144:147], v[204:207], v[48:51], v[144:147]
    ds_read_b64_tr_b16 v[194:195], v238 offset:57856
    s_waitcnt lgkmcnt(6)
    v_mfma_f32_16x16x32_bf16 v[144:147], v[208:211], v[56:59], v[144:147]
    ds_read_b64_tr_b16 v[196:197], v238 offset:61440
    v_mfma_f32_16x16x32_bf16 v[144:147], v[212:215], v[64:67], v[144:147]
    ds_read_b64_tr_b16 v[198:199], v238 offset:61952
    v_mfma_f32_16x16x32_bf16 v[148:151], v[200:203], v[44:47], v[148:151]
    ds_read_b64_tr_b16 v[200:201], v239 offset:49152
    v_mfma_f32_16x16x32_bf16 v[148:151], v[204:207], v[52:55], v[148:151]
    ds_read_b64_tr_b16 v[202:203], v239 offset:49664
    v_mfma_f32_16x16x32_bf16 v[148:151], v[208:211], v[60:63], v[148:151]
    ds_read_b64_tr_b16 v[204:205], v239 offset:53248
    v_mfma_f32_16x16x32_bf16 v[148:151], v[212:215], v[68:71], v[148:151]
    ds_read_b64_tr_b16 v[206:207], v239 offset:53760
    s_waitcnt lgkmcnt(8)
    v_mfma_f32_16x16x32_bf16 v[152:155], v[184:187], v[40:43], v[152:155]
    ds_read_b64_tr_b16 v[208:209], v239 offset:57344
    v_mfma_f32_16x16x32_bf16 v[152:155], v[188:191], v[48:51], v[152:155]
    ds_read_b64_tr_b16 v[210:211], v239 offset:57856
    s_waitcnt lgkmcnt(6)
    v_mfma_f32_16x16x32_bf16 v[152:155], v[192:195], v[56:59], v[152:155]
    ds_read_b64_tr_b16 v[212:213], v239 offset:61440
    v_mfma_f32_16x16x32_bf16 v[152:155], v[196:199], v[64:67], v[152:155]
    ds_read_b64_tr_b16 v[214:215], v239 offset:61952
    v_mfma_f32_16x16x32_bf16 v[156:159], v[184:187], v[44:47], v[156:159]
    ds_read_b64_tr_b16 v[184:185], v232 offset:32768
    v_mfma_f32_16x16x32_bf16 v[156:159], v[188:191], v[52:55], v[156:159]
    ds_read_b64_tr_b16 v[186:187], v232 offset:33280
    v_mfma_f32_16x16x32_bf16 v[156:159], v[192:195], v[60:63], v[156:159]
    ds_read_b64_tr_b16 v[188:189], v232 offset:36864
    v_mfma_f32_16x16x32_bf16 v[156:159], v[196:199], v[68:71], v[156:159]
    ds_read_b64_tr_b16 v[190:191], v232 offset:37376
    s_waitcnt lgkmcnt(8)
    v_mfma_f32_16x16x32_bf16 v[160:163], v[200:203], v[40:43], v[160:163]
    ds_read_b64_tr_b16 v[192:193], v232 offset:40960
    v_mfma_f32_16x16x32_bf16 v[160:163], v[204:207], v[48:51], v[160:163]
    ds_read_b64_tr_b16 v[194:195], v232 offset:41472
    s_waitcnt lgkmcnt(6)
    v_mfma_f32_16x16x32_bf16 v[160:163], v[208:211], v[56:59], v[160:163]
    ds_read_b64_tr_b16 v[196:197], v232 offset:45056
    v_mfma_f32_16x16x32_bf16 v[160:163], v[212:215], v[64:67], v[160:163]
    ds_read_b64_tr_b16 v[198:199], v232 offset:45568
    v_mfma_f32_16x16x32_bf16 v[164:167], v[200:203], v[44:47], v[164:167]
    ds_read_b64_tr_b16 v[200:201], v233 offset:32768
    v_mfma_f32_16x16x32_bf16 v[164:167], v[204:207], v[52:55], v[164:167]
    ds_read_b64_tr_b16 v[202:203], v233 offset:33280
    v_mfma_f32_16x16x32_bf16 v[164:167], v[208:211], v[60:63], v[164:167]
    ds_read_b64_tr_b16 v[204:205], v233 offset:36864
    v_mfma_f32_16x16x32_bf16 v[164:167], v[212:215], v[68:71], v[164:167]
    ds_read_b64_tr_b16 v[206:207], v233 offset:37376
    s_waitcnt lgkmcnt(8)
    v_mfma_f32_16x16x32_bf16 v[136:139], v[184:187], v[72:75], v[136:139]
    ds_read_b64_tr_b16 v[208:209], v233 offset:40960
    v_mfma_f32_16x16x32_bf16 v[136:139], v[188:191], v[80:83], v[136:139]
    ds_read_b64_tr_b16 v[210:211], v233 offset:41472
    s_waitcnt lgkmcnt(6)
    v_mfma_f32_16x16x32_bf16 v[136:139], v[192:195], v[88:91], v[136:139]
    ds_read_b64_tr_b16 v[212:213], v233 offset:45056
    v_mfma_f32_16x16x32_bf16 v[136:139], v[196:199], v[96:99], v[136:139]
    ds_read_b64_tr_b16 v[214:215], v233 offset:45568
    v_mfma_f32_16x16x32_bf16 v[140:143], v[184:187], v[76:79], v[140:143]
    ds_read_b64_tr_b16 v[184:185], v234 offset:32768
    v_mfma_f32_16x16x32_bf16 v[140:143], v[188:191], v[84:87], v[140:143]
    ds_read_b64_tr_b16 v[186:187], v234 offset:33280
    v_mfma_f32_16x16x32_bf16 v[140:143], v[192:195], v[92:95], v[140:143]
    ds_read_b64_tr_b16 v[188:189], v234 offset:36864
    v_mfma_f32_16x16x32_bf16 v[140:143], v[196:199], v[100:103], v[140:143]
    ds_read_b64_tr_b16 v[190:191], v234 offset:37376
    s_waitcnt lgkmcnt(8)
    v_mfma_f32_16x16x32_bf16 v[144:147], v[200:203], v[72:75], v[144:147]
    ds_read_b64_tr_b16 v[192:193], v234 offset:40960
    v_mfma_f32_16x16x32_bf16 v[144:147], v[204:207], v[80:83], v[144:147]
    ds_read_b64_tr_b16 v[194:195], v234 offset:41472
    s_waitcnt lgkmcnt(6)
    v_mfma_f32_16x16x32_bf16 v[144:147], v[208:211], v[88:91], v[144:147]
    ds_read_b64_tr_b16 v[196:197], v234 offset:45056
    v_mfma_f32_16x16x32_bf16 v[144:147], v[212:215], v[96:99], v[144:147]
    ds_read_b64_tr_b16 v[198:199], v234 offset:45568
    v_mfma_f32_16x16x32_bf16 v[148:151], v[200:203], v[76:79], v[148:151]
    ds_read_b64_tr_b16 v[200:201], v235 offset:32768
    v_mfma_f32_16x16x32_bf16 v[148:151], v[204:207], v[84:87], v[148:151]
    ds_read_b64_tr_b16 v[202:203], v235 offset:33280
    v_mfma_f32_16x16x32_bf16 v[148:151], v[208:211], v[92:95], v[148:151]
    ds_read_b64_tr_b16 v[204:205], v235 offset:36864
    v_mfma_f32_16x16x32_bf16 v[148:151], v[212:215], v[100:103], v[148:151]
    ds_read_b64_tr_b16 v[206:207], v235 offset:37376
    s_waitcnt lgkmcnt(8)
    v_mfma_f32_16x16x32_bf16 v[152:155], v[184:187], v[72:75], v[152:155]
    ds_read_b64_tr_b16 v[208:209], v235 offset:40960
    v_mfma_f32_16x16x32_bf16 v[152:155], v[188:191], v[80:83], v[152:155]
    ds_read_b64_tr_b16 v[210:211], v235 offset:41472
    s_waitcnt lgkmcnt(6)
    v_mfma_f32_16x16x32_bf16 v[152:155], v[192:195], v[88:91], v[152:155]
    ds_read_b64_tr_b16 v[212:213], v235 offset:45056
    v_mfma_f32_16x16x32_bf16 v[152:155], v[196:199], v[96:99], v[152:155]
    ds_read_b64_tr_b16 v[214:215], v235 offset:45568
    v_mfma_f32_16x16x32_bf16 v[156:159], v[184:187], v[76:79], v[156:159]
    ds_read_b64_tr_b16 v[184:185], v232 offset:49152
    v_mfma_f32_16x16x32_bf16 v[156:159], v[188:191], v[84:87], v[156:159]
    ds_read_b64_tr_b16 v[186:187], v232 offset:49664
    v_mfma_f32_16x16x32_bf16 v[156:159], v[192:195], v[92:95], v[156:159]
    ds_read_b64_tr_b16 v[188:189], v232 offset:53248
    v_mfma_f32_16x16x32_bf16 v[156:159], v[196:199], v[100:103], v[156:159]
    ds_read_b64_tr_b16 v[190:191], v232 offset:53760
    s_waitcnt lgkmcnt(8)
    v_mfma_f32_16x16x32_bf16 v[160:163], v[200:203], v[72:75], v[160:163]
    ds_read_b64_tr_b16 v[192:193], v232 offset:57344
    v_mfma_f32_16x16x32_bf16 v[160:163], v[204:207], v[80:83], v[160:163]
    ds_read_b64_tr_b16 v[194:195], v232 offset:57856
    s_waitcnt lgkmcnt(6)
    v_mfma_f32_16x16x32_bf16 v[160:163], v[208:211], v[88:91], v[160:163]
    ds_read_b64_tr_b16 v[196:197], v232 offset:61440
    v_mfma_f32_16x16x32_bf16 v[160:163], v[212:215], v[96:99], v[160:163]
    ds_read_b64_tr_b16 v[198:199], v232 offset:61952
    v_mfma_f32_16x16x32_bf16 v[164:167], v[200:203], v[76:79], v[164:167]
    ds_read_b64_tr_b16 v[200:201], v233 offset:49152
    v_mfma_f32_16x16x32_bf16 v[164:167], v[204:207], v[84:87], v[164:167]
    ds_read_b64_tr_b16 v[202:203], v233 offset:49664
    v_mfma_f32_16x16x32_bf16 v[164:167], v[208:211], v[92:95], v[164:167]
    ds_read_b64_tr_b16 v[204:205], v233 offset:53248
    v_mfma_f32_16x16x32_bf16 v[164:167], v[212:215], v[100:103], v[164:167]
    ds_read_b64_tr_b16 v[206:207], v233 offset:53760
    s_waitcnt lgkmcnt(8)
    v_mfma_f32_16x16x32_bf16 v[136:139], v[184:187], v[104:107], v[136:139]
    ds_read_b64_tr_b16 v[208:209], v233 offset:57344
    v_mfma_f32_16x16x32_bf16 v[136:139], v[188:191], v[112:115], v[136:139]
    ds_read_b64_tr_b16 v[210:211], v233 offset:57856
    s_waitcnt lgkmcnt(6)
    v_mfma_f32_16x16x32_bf16 v[136:139], v[192:195], v[120:123], v[136:139]
    ds_read_b64_tr_b16 v[212:213], v233 offset:61440
    v_mfma_f32_16x16x32_bf16 v[136:139], v[196:199], v[128:131], v[136:139]
    ds_read_b64_tr_b16 v[214:215], v233 offset:61952
    v_mfma_f32_16x16x32_bf16 v[140:143], v[184:187], v[108:111], v[140:143]
    ds_read_b64_tr_b16 v[184:185], v234 offset:49152
    v_mfma_f32_16x16x32_bf16 v[140:143], v[188:191], v[116:119], v[140:143]
    ds_read_b64_tr_b16 v[186:187], v234 offset:49664
    v_mfma_f32_16x16x32_bf16 v[140:143], v[192:195], v[124:127], v[140:143]
    ds_read_b64_tr_b16 v[188:189], v234 offset:53248
    v_mfma_f32_16x16x32_bf16 v[140:143], v[196:199], v[132:135], v[140:143]
    ds_read_b64_tr_b16 v[190:191], v234 offset:53760
    s_waitcnt lgkmcnt(8)
    v_mfma_f32_16x16x32_bf16 v[144:147], v[200:203], v[104:107], v[144:147]
    ds_read_b64_tr_b16 v[192:193], v234 offset:57344
    v_mfma_f32_16x16x32_bf16 v[144:147], v[204:207], v[112:115], v[144:147]
    ds_read_b64_tr_b16 v[194:195], v234 offset:57856
    s_waitcnt lgkmcnt(6)
    v_mfma_f32_16x16x32_bf16 v[144:147], v[208:211], v[120:123], v[144:147]
    ds_read_b64_tr_b16 v[196:197], v234 offset:61440
    v_mfma_f32_16x16x32_bf16 v[144:147], v[212:215], v[128:131], v[144:147]
    ds_read_b64_tr_b16 v[198:199], v234 offset:61952
    v_mfma_f32_16x16x32_bf16 v[148:151], v[200:203], v[108:111], v[148:151]
    ds_read_b64_tr_b16 v[200:201], v235 offset:49152
    v_mfma_f32_16x16x32_bf16 v[148:151], v[204:207], v[116:119], v[148:151]
    ds_read_b64_tr_b16 v[202:203], v235 offset:49664
    s_add_u32 s52, s50, 917504
    v_mfma_f32_16x16x32_bf16 v[148:151], v[208:211], v[124:127], v[148:151]
    ds_read_b64_tr_b16 v[204:205], v235 offset:53248
    v_cvt_pk_bf16_f32 v136, v136, v137
    v_mfma_f32_16x16x32_bf16 v[148:151], v[212:215], v[132:135], v[148:151]
    ds_read_b64_tr_b16 v[206:207], v235 offset:53760
    v_cvt_pk_bf16_f32 v137, v138, v139
    s_waitcnt lgkmcnt(8)
    v_mfma_f32_16x16x32_bf16 v[152:155], v[184:187], v[104:107], v[152:155]
    ds_read_b64_tr_b16 v[208:209], v235 offset:57344
    v_cvt_pk_bf16_f32 v138, v144, v145
    v_mfma_f32_16x16x32_bf16 v[152:155], v[188:191], v[112:115], v[152:155]
    ds_read_b64_tr_b16 v[210:211], v235 offset:57856
    v_cvt_pk_bf16_f32 v139, v146, v147
    s_waitcnt lgkmcnt(6)
    v_mfma_f32_16x16x32_bf16 v[152:155], v[192:195], v[120:123], v[152:155]
    ds_read_b64_tr_b16 v[212:213], v235 offset:61440
    buffer_store_dwordx4 v[136:139], v252, s[32:35], s52 offen sc1
    v_mfma_f32_16x16x32_bf16 v[152:155], v[196:199], v[128:131], v[152:155]
    ds_read_b64_tr_b16 v[214:215], v235 offset:61952
    v_mfma_f32_16x16x32_bf16 v[156:159], v[184:187], v[108:111], v[156:159]
    v_mfma_f32_16x16x32_bf16 v[156:159], v[188:191], v[116:119], v[156:159]
    v_mfma_f32_16x16x32_bf16 v[156:159], v[192:195], v[124:127], v[156:159]
    v_cvt_pk_bf16_f32 v140, v140, v141
    v_mfma_f32_16x16x32_bf16 v[156:159], v[196:199], v[132:135], v[156:159]
    v_cvt_pk_bf16_f32 v141, v142, v143
    s_waitcnt lgkmcnt(4)
    v_mfma_f32_16x16x32_bf16 v[160:163], v[200:203], v[104:107], v[160:163]
    v_cvt_pk_bf16_f32 v142, v148, v149
    v_mfma_f32_16x16x32_bf16 v[160:163], v[204:207], v[112:115], v[160:163]
    v_cvt_pk_bf16_f32 v143, v150, v151
    s_waitcnt lgkmcnt(0)
    v_mfma_f32_16x16x32_bf16 v[160:163], v[208:211], v[120:123], v[160:163]
    buffer_store_dwordx4 v[140:143], v252, s[32:35], s52 offen offset:2048 sc1
    v_mfma_f32_16x16x32_bf16 v[160:163], v[212:215], v[128:131], v[160:163]
    v_mfma_f32_16x16x32_bf16 v[164:167], v[200:203], v[108:111], v[164:167]
    v_mfma_f32_16x16x32_bf16 v[164:167], v[204:207], v[116:119], v[164:167]
    v_mfma_f32_16x16x32_bf16 v[164:167], v[208:211], v[124:127], v[164:167]
    v_cvt_pk_bf16_f32 v152, v152, v153
    v_mfma_f32_16x16x32_bf16 v[164:167], v[212:215], v[132:135], v[164:167]
    v_cvt_pk_bf16_f32 v153, v154, v155
    s_nop 1
    v_cvt_pk_bf16_f32 v154, v160, v161
    v_cvt_pk_bf16_f32 v155, v162, v163
    buffer_store_dwordx4 v[152:155], v252, s[32:35], s52 offen offset:1024 sc1
    v_cvt_pk_bf16_f32 v156, v156, v157
    v_cvt_pk_bf16_f32 v157, v158, v159
    v_cvt_pk_bf16_f32 v158, v164, v165
    v_cvt_pk_bf16_f32 v159, v166, v167
    buffer_store_dwordx4 v[156:159], v252, s[32:35], s52 offen offset:3072 sc1
    v_mov_b32 v240, 8
    s_waitcnt vmcnt(0)
    buffer_store_dword v240, v252, s[72:75], 0 offen sc1
    s_lshl_b32 s56, s5, 2
    s_lshr_b32 s58, s6, 1
    s_add_u32 s56, s56, s58
    s_lshl_b32 s56, s56, 10
    s_add_u32 s56, s56, 75497472
    s_add_u32 s72, s92, s56
    s_addc_u32 s73, s93, 0
    s_mov_b32 s74, 1024
    s_mov_b32 s75, 0x20000
    s_mov_b32 s84, 4
    s_branch L_red
    s_endpgm
L_cold:
L_fb_L1_0:
    s_call_b64 s[48:49], L_fbr_1_0_0
    s_branch L_ret_L1_0
L_fb_L1_1:
    s_call_b64 s[48:49], L_fbr_1_1_0
    s_branch L_ret_L1_1
L_fb_L2_0:
    s_call_b64 s[48:49], L_fbr_0_0_0
    s_branch L_ret_L2_0
L_fb_L2_1:
    s_call_b64 s[48:49], L_fbr_0_1_0
    s_branch L_ret_L2_1
L_fb_L3_0:
    s_call_b64 s[48:49], L_fbr_1_0_0
    s_branch L_ret_L3_0
L_fb_L3_1:
    s_call_b64 s[48:49], L_fbr_1_1_0
    s_branch L_ret_L3_1
L_fb_L4_0:
    s_call_b64 s[48:49], L_fbr_0_0_0
    s_branch L_ret_L4_0
L_fb_L4_1:
    s_call_b64 s[48:49], L_fbr_0_1_0
    s_branch L_ret_L4_1
L_fb_L5_0:
    s_call_b64 s[48:49], L_fbr_1_0_0
    s_branch L_ret_L5_0
L_fb_L5_1:
    s_call_b64 s[48:49], L_fbr_1_1_0
    s_branch L_ret_L5_1
L_fb_L6_0:
    s_call_b64 s[48:49], L_fbr_0_0_0
    s_branch L_ret_L6_0
L_fb_L6_1:
    s_call_b64 s[48:49], L_fbr_0_1_0
    s_branch L_ret_L6_1
L_fb_L7_0:
    s_call_b64 s[48:49], L_fbr_1_0_1
    s_branch L_ret_L7_0
L_fb_L7_1:
    s_call_b64 s[48:49], L_fbr_1_1_1
    s_branch L_ret_L7_1
L_fb_T7_0:
    s_call_b64 s[48:49], L_fbr_1_0_1
    s_branch L_ret_T7_0
L_fb_T7_1:
    s_call_b64 s[48:49], L_fbr_1_1_1
    s_branch L_ret_T7_1
L_fbr_1_0_0:
    s_nop 7
    s_nop 3
    v_max3_f32 v224, v104, v105, v106
    v_max3_f32 v224, v224, v107, v112
    v_max3_f32 v224, v224, v113, v114
    v_max3_f32 v224, v224, v115, v136
    v_max3_f32 v224, v224, v137, v138
    v_max3_f32 v224, v224, v139, v144
    v_max3_f32 v224, v224, v145, v146
    v_max_f32 v224, v224, v147
    v_mov_b32 v228, v224
    s_nop 1
    v_permlane32_swap_b32 v228, v224
    v_max_f32 v224, v224, v228
    v_mov_b32 v228, v224
    s_nop 1
    v_permlane16_swap_b32 v228, v224
    v_max_f32 v224, v224, v228
    v_max_f32 v224, 0, v224
    v_ceil_f32 v224, v224
    v_sub_f32 v228, 0, v224
    v_exp_f32 v226, v228
    v_sub_f32 v104, v104, v224
    v_sub_f32 v105, v105, v224
    v_sub_f32 v106, v106, v224
    v_sub_f32 v107, v107, v224
    v_sub_f32 v112, v112, v224
    v_sub_f32 v113, v113, v224
    v_sub_f32 v114, v114, v224
    v_sub_f32 v115, v115, v224
    v_sub_f32 v136, v136, v224
    v_sub_f32 v137, v137, v224
    v_sub_f32 v138, v138, v224
    v_sub_f32 v139, v139, v224
    v_sub_f32 v144, v144, v224
    v_sub_f32 v145, v145, v224
    v_sub_f32 v146, v146, v224
    v_sub_f32 v147, v147, v224
    v_sub_f32 v176, v176, v224
    v_sub_f32 v177, v177, v224
    v_sub_f32 v178, v178, v224
    v_sub_f32 v179, v179, v224
    v_mul_f32 v232, v232, v226
    v_mul_f32 v40, v40, v226
    v_mul_f32 v41, v41, v226
    v_mul_f32 v42, v42, v226
    v_mul_f32 v43, v43, v226
    v_mul_f32 v48, v48, v226
    v_mul_f32 v49, v49, v226
    v_mul_f32 v50, v50, v226
    v_mul_f32 v51, v51, v226
    v_mul_f32 v56, v56, v226
    v_mul_f32 v57, v57, v226
    v_mul_f32 v58, v58, v226
    v_mul_f32 v59, v59, v226
    v_mul_f32 v64, v64, v226
    v_mul_f32 v65, v65, v226
    v_mul_f32 v66, v66, v226
    v_mul_f32 v67, v67, v226
    v_mul_f32 v72, v72, v226
    v_mul_f32 v73, v73, v226
    v_mul_f32 v74, v74, v226
    v_mul_f32 v75, v75, v226
    v_mul_f32 v80, v80, v226
    v_mul_f32 v81, v81, v226
    v_mul_f32 v82, v82, v226
    v_mul_f32 v83, v83, v226
    v_mul_f32 v88, v88, v226
    v_mul_f32 v89, v89, v226
    v_mul_f32 v90, v90, v226
    v_mul_f32 v91, v91, v226
    v_mul_f32 v96, v96, v226
    v_mul_f32 v97, v97, v226
    v_mul_f32 v98, v98, v226
    v_mul_f32 v99, v99, v226
    v_max3_f32 v225, v108, v109, v110
    v_max3_f32 v225, v225, v111, v116
    v_max3_f32 v225, v225, v117, v118
    v_max3_f32 v225, v225, v119, v140
    v_max3_f32 v225, v225, v141, v142
    v_max3_f32 v225, v225, v143, v148
    v_max3_f32 v225, v225, v149, v150
    v_max_f32 v225, v225, v151
    v_mov_b32 v229, v225
    s_nop 1
    v_permlane32_swap_b32 v229, v225
    v_max_f32 v225, v225, v229
    v_mov_b32 v229, v225
    s_nop 1
    v_permlane16_swap_b32 v229, v225
    v_max_f32 v225, v225, v229
    v_max_f32 v225, 0, v225
    v_ceil_f32 v225, v225
    v_sub_f32 v229, 0, v225
    v_exp_f32 v227, v229
    v_sub_f32 v108, v108, v225
    v_sub_f32 v109, v109, v225
    v_sub_f32 v110, v110, v225
    v_sub_f32 v111, v111, v225
    v_sub_f32 v116, v116, v225
    v_sub_f32 v117, v117, v225
    v_sub_f32 v118, v118, v225
    v_sub_f32 v119, v119, v225
    v_sub_f32 v140, v140, v225
    v_sub_f32 v141, v141, v225
    v_sub_f32 v142, v142, v225
    v_sub_f32 v143, v143, v225
    v_sub_f32 v148, v148, v225
    v_sub_f32 v149, v149, v225
    v_sub_f32 v150, v150, v225
    v_sub_f32 v151, v151, v225
    v_sub_f32 v180, v180, v225
    v_sub_f32 v181, v181, v225
    v_sub_f32 v182, v182, v225
    v_sub_f32 v183, v183, v225
    v_mul_f32 v233, v233, v227
    v_mul_f32 v44, v44, v227
    v_mul_f32 v45, v45, v227
    v_mul_f32 v46, v46, v227
    v_mul_f32 v47, v47, v227
    v_mul_f32 v52, v52, v227
    v_mul_f32 v53, v53, v227
    v_mul_f32 v54, v54, v227
    v_mul_f32 v55, v55, v227
    v_mul_f32 v60, v60, v227
    v_mul_f32 v61, v61, v227
    v_mul_f32 v62, v62, v227
    v_mul_f32 v63, v63, v227
    v_mul_f32 v68, v68, v227
    v_mul_f32 v69, v69, v227
    v_mul_f32 v70, v70, v227
    v_mul_f32 v71, v71, v227
    v_mul_f32 v76, v76, v227
    v_mul_f32 v77, v77, v227
    v_mul_f32 v78, v78, v227
    v_mul_f32 v79, v79, v227
    v_mul_f32 v84, v84, v227
    v_mul_f32 v85, v85, v227
    v_mul_f32 v86, v86, v227
    v_mul_f32 v87, v87, v227
    v_mul_f32 v92, v92, v227
    v_mul_f32 v93, v93, v227
    v_mul_f32 v94, v94, v227
    v_mul_f32 v95, v95, v227
    v_mul_f32 v100, v100, v227
    v_mul_f32 v101, v101, v227
    v_mul_f32 v102, v102, v227
    v_mul_f32 v103, v103, v227
    v_exp_f32 v216, v104
    v_exp_f32 v217, v105
    v_exp_f32 v218, v106
    v_exp_f32 v219, v107
    v_add_f32 v236, v216, v217
    v_cvt_pk_bf16_f32 v160, v216, v217
    v_add_f32 v236, v236, v218
    v_add_f32 v236, v236, v219
    v_cvt_pk_bf16_f32 v161, v218, v219
    v_exp_f32 v220, v112
    v_exp_f32 v221, v113
    v_exp_f32 v222, v114
    v_exp_f32 v223, v115
    v_add_f32 v236, v236, v220
    v_add_f32 v236, v236, v221
    v_cvt_pk_bf16_f32 v162, v220, v221
    v_add_f32 v236, v236, v222
    v_add_f32 v236, v236, v223
    v_cvt_pk_bf16_f32 v163, v222, v223
    v_exp_f32 v216, v108
    v_exp_f32 v217, v109
    v_exp_f32 v218, v110
    v_exp_f32 v219, v111
    v_add_f32 v237, v216, v217
    v_cvt_pk_bf16_f32 v164, v216, v217
    v_add_f32 v237, v237, v218
    v_add_f32 v237, v237, v219
    v_cvt_pk_bf16_f32 v165, v218, v219
    v_exp_f32 v220, v116
    v_exp_f32 v221, v117
    v_exp_f32 v222, v118
    v_exp_f32 v223, v119
    v_add_f32 v237, v237, v220
    v_add_f32 v237, v237, v221
    v_cvt_pk_bf16_f32 v166, v220, v221
    v_add_f32 v237, v237, v222
    v_add_f32 v237, v237, v223
    v_cvt_pk_bf16_f32 v167, v222, v223
    s_nop 2
    s_setpc_b64 s[48:49]
L_fbr_1_1_0:
    s_nop 7
    s_nop 3
    v_max3_f32 v224, v136, v137, v138
    v_max3_f32 v224, v224, v139, v144
    v_max3_f32 v224, v224, v145, v146
    v_max_f32 v224, v224, v147
    v_mov_b32 v228, v224
    s_nop 1
    v_permlane32_swap_b32 v228, v224
    v_max_f32 v224, v224, v228
    v_mov_b32 v228, v224
    s_nop 1
    v_permlane16_swap_b32 v228, v224
    v_max_f32 v224, v224, v228
    v_max_f32 v224, 0, v224
    v_ceil_f32 v224, v224
    v_sub_f32 v228, 0, v224
    v_exp_f32 v226, v228
    v_sub_f32 v136, v136, v224
    v_sub_f32 v137, v137, v224
    v_sub_f32 v138, v138, v224
    v_sub_f32 v139, v139, v224
    v_sub_f32 v144, v144, v224
    v_sub_f32 v145, v145, v224
    v_sub_f32 v146, v146, v224
    v_sub_f32 v147, v147, v224
    v_sub_f32 v176, v176, v224
    v_sub_f32 v177, v177, v224
    v_sub_f32 v178, v178, v224
    v_sub_f32 v179, v179, v224
    v_mul_f32 v232, v232, v226
    v_mul_f32 v40, v40, v226
    v_mul_f32 v41, v41, v226
    v_mul_f32 v42, v42, v226
    v_mul_f32 v43, v43, v226
    v_mul_f32 v48, v48, v226
    v_mul_f32 v49, v49, v226
    v_mul_f32 v50, v50, v226
    v_mul_f32 v51, v51, v226
    v_mul_f32 v56, v56, v226
    v_mul_f32 v57, v57, v226
    v_mul_f32 v58, v58, v226
    v_mul_f32 v59, v59, v226
    v_mul_f32 v64, v64, v226
    v_mul_f32 v65, v65, v226
    v_mul_f32 v66, v66, v226
    v_mul_f32 v67, v67, v226
    v_mul_f32 v72, v72, v226
    v_mul_f32 v73, v73, v226
    v_mul_f32 v74, v74, v226
    v_mul_f32 v75, v75, v226
    v_mul_f32 v80, v80, v226
    v_mul_f32 v81, v81, v226
    v_mul_f32 v82, v82, v226
    v_mul_f32 v83, v83, v226
    v_mul_f32 v88, v88, v226
    v_mul_f32 v89, v89, v226
    v_mul_f32 v90, v90, v226
    v_mul_f32 v91, v91, v226
    v_mul_f32 v96, v96, v226
    v_mul_f32 v97, v97, v226
    v_mul_f32 v98, v98, v226
    v_mul_f32 v99, v99, v226
    v_lshlrev_b32 v228, 16, v160
    v_and_b32 v160, 0xffff0000, v160
    v_mul_f32 v228, v228, v226
    v_mul_f32 v160, v160, v226
    v_cvt_pk_bf16_f32 v160, v228, v160
    v_lshlrev_b32 v228, 16, v161
    v_and_b32 v161, 0xffff0000, v161
    v_mul_f32 v228, v228, v226
    v_mul_f32 v161, v161, v226
    v_cvt_pk_bf16_f32 v161, v228, v161
    v_lshlrev_b32 v228, 16, v162
    v_and_b32 v162, 0xffff0000, v162
    v_mul_f32 v228, v228, v226
    v_mul_f32 v162, v162, v226
    v_cvt_pk_bf16_f32 v162, v228, v162
    v_lshlrev_b32 v228, 16, v163
    v_and_b32 v163, 0xffff0000, v163
    v_mul_f32 v228, v228, v226
    v_mul_f32 v163, v163, v226
    v_cvt_pk_bf16_f32 v163, v228, v163
    v_sub_f32 v104, v104, v224
    v_sub_f32 v105, v105, v224
    v_sub_f32 v106, v106, v224
    v_sub_f32 v107, v107, v224
    v_sub_f32 v112, v112, v224
    v_sub_f32 v113, v113, v224
    v_sub_f32 v114, v114, v224
    v_sub_f32 v115, v115, v224
    v_sub_f32 v120, v120, v224
    v_sub_f32 v121, v121, v224
    v_sub_f32 v122, v122, v224
    v_sub_f32 v123, v123, v224
    v_sub_f32 v128, v128, v224
    v_sub_f32 v129, v129, v224
    v_sub_f32 v130, v130, v224
    v_sub_f32 v131, v131, v224
    v_max3_f32 v225, v140, v141, v142
    v_max3_f32 v225, v225, v143, v148
    v_max3_f32 v225, v225, v149, v150
    v_max_f32 v225, v225, v151
    v_mov_b32 v229, v225
    s_nop 1
    v_permlane32_swap_b32 v229, v225
    v_max_f32 v225, v225, v229
    v_mov_b32 v229, v225
    s_nop 1
    v_permlane16_swap_b32 v229, v225
    v_max_f32 v225, v225, v229
    v_max_f32 v225, 0, v225
    v_ceil_f32 v225, v225
    v_sub_f32 v229, 0, v225
    v_exp_f32 v227, v229
    v_sub_f32 v140, v140, v225
    v_sub_f32 v141, v141, v225
    v_sub_f32 v142, v142, v225
    v_sub_f32 v143, v143, v225
    v_sub_f32 v148, v148, v225
    v_sub_f32 v149, v149, v225
    v_sub_f32 v150, v150, v225
    v_sub_f32 v151, v151, v225
    v_sub_f32 v180, v180, v225
    v_sub_f32 v181, v181, v225
    v_sub_f32 v182, v182, v225
    v_sub_f32 v183, v183, v225
    v_mul_f32 v233, v233, v227
    v_mul_f32 v44, v44, v227
    v_mul_f32 v45, v45, v227
    v_mul_f32 v46, v46, v227
    v_mul_f32 v47, v47, v227
    v_mul_f32 v52, v52, v227
    v_mul_f32 v53, v53, v227
    v_mul_f32 v54, v54, v227
    v_mul_f32 v55, v55, v227
    v_mul_f32 v60, v60, v227
    v_mul_f32 v61, v61, v227
    v_mul_f32 v62, v62, v227
    v_mul_f32 v63, v63, v227
    v_mul_f32 v68, v68, v227
    v_mul_f32 v69, v69, v227
    v_mul_f32 v70, v70, v227
    v_mul_f32 v71, v71, v227
    v_mul_f32 v76, v76, v227
    v_mul_f32 v77, v77, v227
    v_mul_f32 v78, v78, v227
    v_mul_f32 v79, v79, v227
    v_mul_f32 v84, v84, v227
    v_mul_f32 v85, v85, v227
    v_mul_f32 v86, v86, v227
    v_mul_f32 v87, v87, v227
    v_mul_f32 v92, v92, v227
    v_mul_f32 v93, v93, v227
    v_mul_f32 v94, v94, v227
    v_mul_f32 v95, v95, v227
    v_mul_f32 v100, v100, v227
    v_mul_f32 v101, v101, v227
    v_mul_f32 v102, v102, v227
    v_mul_f32 v103, v103, v227
    v_lshlrev_b32 v229, 16, v164
    v_and_b32 v164, 0xffff0000, v164
    v_mul_f32 v229, v229, v227
    v_mul_f32 v164, v164, v227
    v_cvt_pk_bf16_f32 v164, v229, v164
    v_lshlrev_b32 v229, 16, v165
    v_and_b32 v165, 0xffff0000, v165
    v_mul_f32 v229, v229, v227
    v_mul_f32 v165, v165, v227
    v_cvt_pk_bf16_f32 v165, v229, v165
    v_lshlrev_b32 v229, 16, v166
    v_and_b32 v166, 0xffff0000, v166
    v_mul_f32 v229, v229, v227
    v_mul_f32 v166, v166, v227
    v_cvt_pk_bf16_f32 v166, v229, v166
    v_lshlrev_b32 v229, 16, v167
    v_and_b32 v167, 0xffff0000, v167
    v_mul_f32 v229, v229, v227
    v_mul_f32 v167, v167, v227
    v_cvt_pk_bf16_f32 v167, v229, v167
    v_sub_f32 v108, v108, v225
    v_sub_f32 v109, v109, v225
    v_sub_f32 v110, v110, v225
    v_sub_f32 v111, v111, v225
    v_sub_f32 v116, v116, v225
    v_sub_f32 v117, v117, v225
    v_sub_f32 v118, v118, v225
    v_sub_f32 v119, v119, v225
    v_sub_f32 v124, v124, v225
    v_sub_f32 v125, v125, v225
    v_sub_f32 v126, v126, v225
    v_sub_f32 v127, v127, v225
    v_sub_f32 v132, v132, v225
    v_sub_f32 v133, v133, v225
    v_sub_f32 v134, v134, v225
    v_sub_f32 v135, v135, v225
    v_exp_f32 v216, v136
    v_exp_f32 v217, v137
    v_exp_f32 v218, v138
    v_exp_f32 v219, v139
    v_add_f32 v236, v216, v217
    v_cvt_pk_bf16_f32 v168, v216, v217
    v_add_f32 v236, v236, v218
    v_add_f32 v236, v236, v219
    v_cvt_pk_bf16_f32 v169, v218, v219
    v_exp_f32 v220, v144
    v_exp_f32 v221, v145
    v_exp_f32 v222, v146
    v_exp_f32 v223, v147
    v_add_f32 v236, v236, v220
    v_add_f32 v236, v236, v221
    v_cvt_pk_bf16_f32 v170, v220, v221
    v_add_f32 v236, v236, v222
    v_add_f32 v236, v236, v223
    v_cvt_pk_bf16_f32 v171, v222, v223
    v_exp_f32 v216, v140
    v_exp_f32 v217, v141
    v_exp_f32 v218, v142
    v_exp_f32 v219, v143
    v_add_f32 v237, v216, v217
    v_cvt_pk_bf16_f32 v172, v216, v217
    v_add_f32 v237, v237, v218
    v_add_f32 v237, v237, v219
    v_cvt_pk_bf16_f32 v173, v218, v219
    v_exp_f32 v220, v148
    v_exp_f32 v221, v149
    v_exp_f32 v222, v150
    v_exp_f32 v223, v151
    v_add_f32 v237, v237, v220
    v_add_f32 v237, v237, v221
    v_cvt_pk_bf16_f32 v174, v220, v221
    v_add_f32 v237, v237, v222
    v_add_f32 v237, v237, v223
    v_cvt_pk_bf16_f32 v175, v222, v223
    s_nop 2
    s_setpc_b64 s[48:49]
L_fbr_0_0_0:
    s_nop 7
    s_nop 3
    v_max3_f32 v224, v104, v105, v106
    v_max3_f32 v224, v224, v107, v112
    v_max3_f32 v224, v224, v113, v114
    v_max3_f32 v224, v224, v115, v120
    v_max3_f32 v224, v224, v121, v122
    v_max3_f32 v224, v224, v123, v128
    v_max3_f32 v224, v224, v129, v130
    v_max_f32 v224, v224, v131
    v_mov_b32 v228, v224
    s_nop 1
    v_permlane32_swap_b32 v228, v224
    v_max_f32 v224, v224, v228
    v_mov_b32 v228, v224
    s_nop 1
    v_permlane16_swap_b32 v228, v224
    v_max_f32 v224, v224, v228
    v_max_f32 v224, 0, v224
    v_ceil_f32 v224, v224
    v_sub_f32 v228, 0, v224
    v_exp_f32 v226, v228
    v_sub_f32 v104, v104, v224
    v_sub_f32 v105, v105, v224
    v_sub_f32 v106, v106, v224
    v_sub_f32 v107, v107, v224
    v_sub_f32 v112, v112, v224
    v_sub_f32 v113, v113, v224
    v_sub_f32 v114, v114, v224
    v_sub_f32 v115, v115, v224
    v_sub_f32 v120, v120, v224
    v_sub_f32 v121, v121, v224
    v_sub_f32 v122, v122, v224
    v_sub_f32 v123, v123, v224
    v_sub_f32 v128, v128, v224
    v_sub_f32 v129, v129, v224
    v_sub_f32 v130, v130, v224
    v_sub_f32 v131, v131, v224
    v_sub_f32 v176, v176, v224
    v_sub_f32 v177, v177, v224
    v_sub_f32 v178, v178, v224
    v_sub_f32 v179, v179, v224
    v_mul_f32 v232, v232, v226
    v_mul_f32 v40, v40, v226
    v_mul_f32 v41, v41, v226
    v_mul_f32 v42, v42, v226
    v_mul_f32 v43, v43, v226
    v_mul_f32 v48, v48, v226
    v_mul_f32 v49, v49, v226
    v_mul_f32 v50, v50, v226
    v_mul_f32 v51, v51, v226
    v_mul_f32 v56, v56, v226
    v_mul_f32 v57, v57, v226
    v_mul_f32 v58, v58, v226
    v_mul_f32 v59, v59, v226
    v_mul_f32 v64, v64, v226
    v_mul_f32 v65, v65, v226
    v_mul_f32 v66, v66, v226
    v_mul_f32 v67, v67, v226
    v_mul_f32 v72, v72, v226
    v_mul_f32 v73, v73, v226
    v_mul_f32 v74, v74, v226
    v_mul_f32 v75, v75, v226
    v_mul_f32 v80, v80, v226
    v_mul_f32 v81, v81, v226
    v_mul_f32 v82, v82, v226
    v_mul_f32 v83, v83, v226
    v_mul_f32 v88, v88, v226
    v_mul_f32 v89, v89, v226
    v_mul_f32 v90, v90, v226
    v_mul_f32 v91, v91, v226
    v_mul_f32 v96, v96, v226
    v_mul_f32 v97, v97, v226
    v_mul_f32 v98, v98, v226
    v_mul_f32 v99, v99, v226
    v_max3_f32 v225, v108, v109, v110
    v_max3_f32 v225, v225, v111, v116
    v_max3_f32 v225, v225, v117, v118
    v_max3_f32 v225, v225, v119, v124
    v_max3_f32 v225, v225, v125, v126
    v_max3_f32 v225, v225, v127, v132
    v_max3_f32 v225, v225, v133, v134
    v_max_f32 v225, v225, v135
    v_mov_b32 v229, v225
    s_nop 1
    v_permlane32_swap_b32 v229, v225
    v_max_f32 v225, v225, v229
    v_mov_b32 v229, v225
    s_nop 1
    v_permlane16_swap_b32 v229, v225
    v_max_f32 v225, v225, v229
    v_max_f32 v225, 0, v225
    v_ceil_f32 v225, v225
    v_sub_f32 v229, 0, v225
    v_exp_f32 v227, v229
    v_sub_f32 v108, v108, v225
    v_sub_f32 v109, v109, v225
    v_sub_f32 v110, v110, v225
    v_sub_f32 v111, v111, v225
    v_sub_f32 v116, v116, v225
    v_sub_f32 v117, v117, v225
    v_sub_f32 v118, v118, v225
    v_sub_f32 v119, v119, v225
    v_sub_f32 v124, v124, v225
    v_sub_f32 v125, v125, v225
    v_sub_f32 v126, v126, v225
    v_sub_f32 v127, v127, v225
    v_sub_f32 v132, v132, v225
    v_sub_f32 v133, v133, v225
    v_sub_f32 v134, v134, v225
    v_sub_f32 v135, v135, v225
    v_sub_f32 v180, v180, v225
    v_sub_f32 v181, v181, v225
    v_sub_f32 v182, v182, v225
    v_sub_f32 v183, v183, v225
    v_mul_f32 v233, v233, v227
    v_mul_f32 v44, v44, v227
    v_mul_f32 v45, v45, v227
    v_mul_f32 v46, v46, v227
    v_mul_f32 v47, v47, v227
    v_mul_f32 v52, v52, v227
    v_mul_f32 v53, v53, v227
    v_mul_f32 v54, v54, v227
    v_mul_f32 v55, v55, v227
    v_mul_f32 v60, v60, v227
    v_mul_f32 v61, v61, v227
    v_mul_f32 v62, v62, v227
    v_mul_f32 v63, v63, v227
    v_mul_f32 v68, v68, v227
    v_mul_f32 v69, v69, v227
    v_mul_f32 v70, v70, v227
    v_mul_f32 v71, v71, v227
    v_mul_f32 v76, v76, v227
    v_mul_f32 v77, v77, v227
    v_mul_f32 v78, v78, v227
    v_mul_f32 v79, v79, v227
    v_mul_f32 v84, v84, v227
    v_mul_f32 v85, v85, v227
    v_mul_f32 v86, v86, v227
    v_mul_f32 v87, v87, v227
    v_mul_f32 v92, v92, v227
    v_mul_f32 v93, v93, v227
    v_mul_f32 v94, v94, v227
    v_mul_f32 v95, v95, v227
    v_mul_f32 v100, v100, v227
    v_mul_f32 v101, v101, v227
    v_mul_f32 v102, v102, v227
    v_mul_f32 v103, v103, v227
    v_exp_f32 v216, v104
    v_exp_f32 v217, v105
    v_exp_f32 v218, v106
    v_exp_f32 v219, v107
    v_add_f32 v236, v216, v217
    v_cvt_pk_bf16_f32 v152, v216, v217
    v_add_f32 v236, v236, v218
    v_add_f32 v236, v236, v219
    v_cvt_pk_bf16_f32 v153, v218, v219
    v_exp_f32 v220, v112
    v_exp_f32 v221, v113
    v_exp_f32 v222, v114
    v_exp_f32 v223, v115
    v_add_f32 v236, v236, v220
    v_add_f32 v236, v236, v221
    v_cvt_pk_bf16_f32 v154, v220, v221
    v_add_f32 v236, v236, v222
    v_add_f32 v236, v236, v223
    v_cvt_pk_bf16_f32 v155, v222, v223
    v_exp_f32 v216, v108
    v_exp_f32 v217, v109
    v_exp_f32 v218, v110
    v_exp_f32 v219, v111
    v_add_f32 v237, v216, v217
    v_cvt_pk_bf16_f32 v156, v216, v217
    v_add_f32 v237, v237, v218
    v_add_f32 v237, v237, v219
    v_cvt_pk_bf16_f32 v157, v218, v219
    v_exp_f32 v220, v116
    v_exp_f32 v221, v117
    v_exp_f32 v222, v118
    v_exp_f32 v223, v119
    v_add_f32 v237, v237, v220
    v_add_f32 v237, v237, v221
    v_cvt_pk_bf16_f32 v158, v220, v221
    v_add_f32 v237, v237, v222
    v_add_f32 v237, v237, v223
    v_cvt_pk_bf16_f32 v159, v222, v223
    s_nop 2
    s_setpc_b64 s[48:49]
L_fbr_0_1_0:
    s_nop 7
    s_nop 3
    v_max3_f32 v224, v120, v121, v122
    v_max3_f32 v224, v224, v123, v128
    v_max3_f32 v224, v224, v129, v130
    v_max_f32 v224, v224, v131
    v_mov_b32 v228, v224
    s_nop 1
    v_permlane32_swap_b32 v228, v224
    v_max_f32 v224, v224, v228
    v_mov_b32 v228, v224
    s_nop 1
    v_permlane16_swap_b32 v228, v224
    v_max_f32 v224, v224, v228
    v_max_f32 v224, 0, v224
    v_ceil_f32 v224, v224
    v_sub_f32 v228, 0, v224
    v_exp_f32 v226, v228
    v_sub_f32 v120, v120, v224
    v_sub_f32 v121, v121, v224
    v_sub_f32 v122, v122, v224
    v_sub_f32 v123, v123, v224
    v_sub_f32 v128, v128, v224
    v_sub_f32 v129, v129, v224
    v_sub_f32 v130, v130, v224
    v_sub_f32 v131, v131, v224
    v_sub_f32 v176, v176, v224
    v_sub_f32 v177, v177, v224
    v_sub_f32 v178, v178, v224
    v_sub_f32 v179, v179, v224
    v_mul_f32 v232, v232, v226
    v_mul_f32 v40, v40, v226
    v_mul_f32 v41, v41, v226
    v_mul_f32 v42, v42, v226
    v_mul_f32 v43, v43, v226
    v_mul_f32 v48, v48, v226
    v_mul_f32 v49, v49, v226
    v_mul_f32 v50, v50, v226
    v_mul_f32 v51, v51, v226
    v_mul_f32 v56, v56, v226
    v_mul_f32 v57, v57, v226
    v_mul_f32 v58, v58, v226
    v_mul_f32 v59, v59, v226
    v_mul_f32 v64, v64, v226
    v_mul_f32 v65, v65, v226
    v_mul_f32 v66, v66, v226
    v_mul_f32 v67, v67, v226
    v_mul_f32 v72, v72, v226
    v_mul_f32 v73, v73, v226
    v_mul_f32 v74, v74, v226
    v_mul_f32 v75, v75, v226
    v_mul_f32 v80, v80, v226
    v_mul_f32 v81, v81, v226
    v_mul_f32 v82, v82, v226
    v_mul_f32 v83, v83, v226
    v_mul_f32 v88, v88, v226
    v_mul_f32 v89, v89, v226
    v_mul_f32 v90, v90, v226
    v_mul_f32 v91, v91, v226
    v_mul_f32 v96, v96, v226
    v_mul_f32 v97, v97, v226
    v_mul_f32 v98, v98, v226
    v_mul_f32 v99, v99, v226
    v_lshlrev_b32 v228, 16, v152
    v_and_b32 v152, 0xffff0000, v152
    v_mul_f32 v228, v228, v226
    v_mul_f32 v152, v152, v226
    v_cvt_pk_bf16_f32 v152, v228, v152
    v_lshlrev_b32 v228, 16, v153
    v_and_b32 v153, 0xffff0000, v153
    v_mul_f32 v228, v228, v226
    v_mul_f32 v153, v153, v226
    v_cvt_pk_bf16_f32 v153, v228, v153
    v_lshlrev_b32 v228, 16, v154
    v_and_b32 v154, 0xffff0000, v154
    v_mul_f32 v228, v228, v226
    v_mul_f32 v154, v154, v226
    v_cvt_pk_bf16_f32 v154, v228, v154
    v_lshlrev_b32 v228, 16, v155
    v_and_b32 v155, 0xffff0000, v155
    v_mul_f32 v228, v228, v226
    v_mul_f32 v155, v155, v226
    v_cvt_pk_bf16_f32 v155, v228, v155
    v_sub_f32 v104, v104, v224
    v_sub_f32 v105, v105, v224
    v_sub_f32 v106, v106, v224
    v_sub_f32 v107, v107, v224
    v_sub_f32 v112, v112, v224
    v_sub_f32 v113, v113, v224
    v_sub_f32 v114, v114, v224
    v_sub_f32 v115, v115, v224
    v_sub_f32 v136, v136, v224
    v_sub_f32 v137, v137, v224
    v_sub_f32 v138, v138, v224
    v_sub_f32 v139, v139, v224
    v_sub_f32 v144, v144, v224
    v_sub_f32 v145, v145, v224
    v_sub_f32 v146, v146, v224
    v_sub_f32 v147, v147, v224
    v_max3_f32 v225, v124, v125, v126
    v_max3_f32 v225, v225, v127, v132
    v_max3_f32 v225, v225, v133, v134
    v_max_f32 v225, v225, v135
    v_mov_b32 v229, v225
    s_nop 1
    v_permlane32_swap_b32 v229, v225
    v_max_f32 v225, v225, v229
    v_mov_b32 v229, v225
    s_nop 1
    v_permlane16_swap_b32 v229, v225
    v_max_f32 v225, v225, v229
    v_max_f32 v225, 0, v225
    v_ceil_f32 v225, v225
    v_sub_f32 v229, 0, v225
    v_exp_f32 v227, v229
    v_sub_f32 v124, v124, v225
    v_sub_f32 v125, v125, v225
    v_sub_f32 v126, v126, v225
    v_sub_f32 v127, v127, v225
    v_sub_f32 v132, v132, v225
    v_sub_f32 v133, v133, v225
    v_sub_f32 v134, v134, v225
    v_sub_f32 v135, v135, v225
    v_sub_f32 v180, v180, v225
    v_sub_f32 v181, v181, v225
    v_sub_f32 v182, v182, v225
    v_sub_f32 v183, v183, v225
    v_mul_f32 v233, v233, v227
    v_mul_f32 v44, v44, v227
    v_mul_f32 v45, v45, v227
    v_mul_f32 v46, v46, v227
    v_mul_f32 v47, v47, v227
    v_mul_f32 v52, v52, v227
    v_mul_f32 v53, v53, v227
    v_mul_f32 v54, v54, v227
    v_mul_f32 v55, v55, v227
    v_mul_f32 v60, v60, v227
    v_mul_f32 v61, v61, v227
    v_mul_f32 v62, v62, v227
    v_mul_f32 v63, v63, v227
    v_mul_f32 v68, v68, v227
    v_mul_f32 v69, v69, v227
    v_mul_f32 v70, v70, v227
    v_mul_f32 v71, v71, v227
    v_mul_f32 v76, v76, v227
    v_mul_f32 v77, v77, v227
    v_mul_f32 v78, v78, v227
    v_mul_f32 v79, v79, v227
    v_mul_f32 v84, v84, v227
    v_mul_f32 v85, v85, v227
    v_mul_f32 v86, v86, v227
    v_mul_f32 v87, v87, v227
    v_mul_f32 v92, v92, v227
    v_mul_f32 v93, v93, v227
    v_mul_f32 v94, v94, v227
    v_mul_f32 v95, v95, v227
    v_mul_f32 v100, v100, v227
    v_mul_f32 v101, v101, v227
    v_mul_f32 v102, v102, v227
    v_mul_f32 v103, v103, v227
    v_lshlrev_b32 v229, 16, v156
    v_and_b32 v156, 0xffff0000, v156
    v_mul_f32 v229, v229, v227
    v_mul_f32 v156, v156, v227
    v_cvt_pk_bf16_f32 v156, v229, v156
    v_lshlrev_b32 v229, 16, v157
    v_and_b32 v157, 0xffff0000, v157
    v_mul_f32 v229, v229, v227
    v_mul_f32 v157, v157, v227
    v_cvt_pk_bf16_f32 v157, v229, v157
    v_lshlrev_b32 v229, 16, v158
    v_and_b32 v158, 0xffff0000, v158
    v_mul_f32 v229, v229, v227
    v_mul_f32 v158, v158, v227
    v_cvt_pk_bf16_f32 v158, v229, v158
    v_lshlrev_b32 v229, 16, v159
    v_and_b32 v159, 0xffff0000, v159
    v_mul_f32 v229, v229, v227
    v_mul_f32 v159, v159, v227
    v_cvt_pk_bf16_f32 v159, v229, v159
    v_sub_f32 v108, v108, v225
    v_sub_f32 v109, v109, v225
    v_sub_f32 v110, v110, v225
    v_sub_f32 v111, v111, v225
    v_sub_f32 v116, v116, v225
    v_sub_f32 v117, v117, v225
    v_sub_f32 v118, v118, v225
    v_sub_f32 v119, v119, v225
    v_sub_f32 v140, v140, v225
    v_sub_f32 v141, v141, v225
    v_sub_f32 v142, v142, v225
    v_sub_f32 v143, v143, v225
    v_sub_f32 v148, v148, v225
    v_sub_f32 v149, v149, v225
    v_sub_f32 v150, v150, v225
    v_sub_f32 v151, v151, v225
    v_exp_f32 v216, v120
    v_exp_f32 v217, v121
    v_exp_f32 v218, v122
    v_exp_f32 v219, v123
    v_add_f32 v236, v216, v217
    v_cvt_pk_bf16_f32 v168, v216, v217
    v_add_f32 v236, v236, v218
    v_add_f32 v236, v236, v219
    v_cvt_pk_bf16_f32 v169, v218, v219
    v_exp_f32 v220, v128
    v_exp_f32 v221, v129
    v_exp_f32 v222, v130
    v_exp_f32 v223, v131
    v_add_f32 v236, v236, v220
    v_add_f32 v236, v236, v221
    v_cvt_pk_bf16_f32 v170, v220, v221
    v_add_f32 v236, v236, v222
    v_add_f32 v236, v236, v223
    v_cvt_pk_bf16_f32 v171, v222, v223
    v_exp_f32 v216, v124
    v_exp_f32 v217, v125
    v_exp_f32 v218, v126
    v_exp_f32 v219, v127
    v_add_f32 v237, v216, v217
    v_cvt_pk_bf16_f32 v172, v216, v217
    v_add_f32 v237, v237, v218
    v_add_f32 v237, v237, v219
    v_cvt_pk_bf16_f32 v173, v218, v219
    v_exp_f32 v220, v132
    v_exp_f32 v221, v133
    v_exp_f32 v222, v134
    v_exp_f32 v223, v135
    v_add_f32 v237, v237, v220
    v_add_f32 v237, v237, v221
    v_cvt_pk_bf16_f32 v174, v220, v221
    v_add_f32 v237, v237, v222
    v_add_f32 v237, v237, v223
    v_cvt_pk_bf16_f32 v175, v222, v223
    s_nop 2
    s_setpc_b64 s[48:49]
L_fbr_1_0_1:
    s_nop 7
    s_nop 3
    v_max3_f32 v224, v104, v105, v106
    v_max3_f32 v224, v224, v107, v112
    v_max3_f32 v224, v224, v113, v114
    v_max3_f32 v224, v224, v115, v136
    v_max3_f32 v224, v224, v137, v138
    v_max3_f32 v224, v224, v139, v144
    v_max3_f32 v224, v224, v145, v146
    v_max_f32 v224, v224, v147
    v_mov_b32 v228, v224
    s_nop 1
    v_permlane32_swap_b32 v228, v224
    v_max_f32 v224, v224, v228
    v_mov_b32 v228, v224
    s_nop 1
    v_permlane16_swap_b32 v228, v224
    v_max_f32 v224, v224, v228
    v_max_f32 v224, 0, v224
    v_ceil_f32 v224, v224
    v_sub_f32 v228, 0, v224
    v_exp_f32 v226, v228
    v_sub_f32 v104, v104, v224
    v_sub_f32 v105, v105, v224
    v_sub_f32 v106, v106, v224
    v_sub_f32 v107, v107, v224
    v_sub_f32 v112, v112, v224
    v_sub_f32 v113, v113, v224
    v_sub_f32 v114, v114, v224
    v_sub_f32 v115, v115, v224
    v_sub_f32 v136, v136, v224
    v_sub_f32 v137, v137, v224
    v_sub_f32 v138, v138, v224
    v_sub_f32 v139, v139, v224
    v_sub_f32 v144, v144, v224
    v_sub_f32 v145, v145, v224
    v_sub_f32 v146, v146, v224
    v_sub_f32 v147, v147, v224
    v_sub_f32 v176, v176, v224
    v_sub_f32 v177, v177, v224
    v_sub_f32 v178, v178, v224
    v_sub_f32 v179, v179, v224
    v_mul_f32 v232, v232, v226
    v_mul_f32 v40, v40, v226
    v_mul_f32 v41, v41, v226
    v_mul_f32 v42, v42, v226
    v_mul_f32 v43, v43, v226
    v_mul_f32 v48, v48, v226
    v_mul_f32 v49, v49, v226
    v_mul_f32 v50, v50, v226
    v_mul_f32 v51, v51, v226
    v_mul_f32 v56, v56, v226
    v_mul_f32 v57, v57, v226
    v_mul_f32 v58, v58, v226
    v_mul_f32 v59, v59, v226
    v_mul_f32 v64, v64, v226
    v_mul_f32 v65, v65, v226
    v_mul_f32 v66, v66, v226
    v_mul_f32 v67, v67, v226
    v_mul_f32 v72, v72, v226
    v_mul_f32 v73, v73, v226
    v_mul_f32 v74, v74, v226
    v_mul_f32 v75, v75, v226
    v_mul_f32 v80, v80, v226
    v_mul_f32 v81, v81, v226
    v_mul_f32 v82, v82, v226
    v_mul_f32 v83, v83, v226
    v_mul_f32 v88, v88, v226
    v_mul_f32 v89, v89, v226
    v_mul_f32 v90, v90, v226
    v_mul_f32 v91, v91, v226
    v_mul_f32 v96, v96, v226
    v_mul_f32 v97, v97, v226
    v_mul_f32 v98, v98, v226
    v_mul_f32 v99, v99, v226
    v_max3_f32 v225, v108, v109, v110
    v_max3_f32 v225, v225, v111, v116
    v_max3_f32 v225, v225, v117, v118
    v_max3_f32 v225, v225, v119, v140
    v_max3_f32 v225, v225, v141, v142
    v_max3_f32 v225, v225, v143, v148
    v_max3_f32 v225, v225, v149, v150
    v_max_f32 v225, v225, v151
    v_mov_b32 v229, v225
    s_nop 1
    v_permlane32_swap_b32 v229, v225
    v_max_f32 v225, v225, v229
    v_mov_b32 v229, v225
    s_nop 1
    v_permlane16_swap_b32 v229, v225
    v_max_f32 v225, v225, v229
    v_max_f32 v225, 0, v225
    v_ceil_f32 v225, v225
    v_sub_f32 v229, 0, v225
    v_exp_f32 v227, v229
    v_sub_f32 v108, v108, v225
    v_sub_f32 v109, v109, v225
    v_sub_f32 v110, v110, v225
    v_sub_f32 v111, v111, v225
    v_sub_f32 v116, v116, v225
    v_sub_f32 v117, v117, v225
    v_sub_f32 v118, v118, v225
    v_sub_f32 v119, v119, v225
    v_sub_f32 v140, v140, v225
    v_sub_f32 v141, v141, v225
    v_sub_f32 v142, v142, v225
    v_sub_f32 v143, v143, v225
    v_sub_f32 v148, v148, v225
    v_sub_f32 v149, v149, v225
    v_sub_f32 v150, v150, v225
    v_sub_f32 v151, v151, v225
    v_sub_f32 v180, v180, v225
    v_sub_f32 v181, v181, v225
    v_sub_f32 v182, v182, v225
    v_sub_f32 v183, v183, v225
    v_mul_f32 v233, v233, v227
    v_mul_f32 v44, v44, v227
    v_mul_f32 v45, v45, v227
    v_mul_f32 v46, v46, v227
    v_mul_f32 v47, v47, v227
    v_mul_f32 v52, v52, v227
    v_mul_f32 v53, v53, v227
    v_mul_f32 v54, v54, v227
    v_mul_f32 v55, v55, v227
    v_mul_f32 v60, v60, v227
    v_mul_f32 v61, v61, v227
    v_mul_f32 v62, v62, v227
    v_mul_f32 v63, v63, v227
    v_mul_f32 v68, v68, v227
    v_mul_f32 v69, v69, v227
    v_mul_f32 v70, v70, v227
    v_mul_f32 v71, v71, v227
    v_mul_f32 v76, v76, v227
    v_mul_f32 v77, v77, v227
    v_mul_f32 v78, v78, v227
    v_mul_f32 v79, v79, v227
    v_mul_f32 v84, v84, v227
    v_mul_f32 v85, v85, v227
    v_mul_f32 v86, v86, v227
    v_mul_f32 v87, v87, v227
    v_mul_f32 v92, v92, v227
    v_mul_f32 v93, v93, v227
    v_mul_f32 v94, v94, v227
    v_mul_f32 v95, v95, v227
    v_mul_f32 v100, v100, v227
    v_mul_f32 v101, v101, v227
    v_mul_f32 v102, v102, v227
    v_mul_f32 v103, v103, v227
    v_exp_f32 v216, v104
    v_exp_f32 v217, v105
    v_exp_f32 v218, v106
    v_exp_f32 v219, v107
    v_add_f32 v236, v216, v217
    v_cvt_pk_bf16_f32 v160, v216, v217
    v_add_f32 v236, v236, v218
    v_add_f32 v236, v236, v219
    v_cvt_pk_bf16_f32 v161, v218, v219
    v_exp_f32 v220, v112
    v_exp_f32 v221, v113
    v_exp_f32 v222, v114
    v_exp_f32 v223, v115
    v_add_f32 v236, v236, v220
    v_add_f32 v236, v236, v221
    v_cvt_pk_bf16_f32 v162, v220, v221
    v_add_f32 v236, v236, v222
    v_add_f32 v236, v236, v223
    v_cvt_pk_bf16_f32 v163, v222, v223
    v_exp_f32 v216, v108
    v_exp_f32 v217, v109
    v_exp_f32 v218, v110
    v_exp_f32 v219, v111
    v_add_f32 v237, v216, v217
    v_cvt_pk_bf16_f32 v164, v216, v217
    v_add_f32 v237, v237, v218
    v_add_f32 v237, v237, v219
    v_cvt_pk_bf16_f32 v165, v218, v219
    v_exp_f32 v220, v116
    v_exp_f32 v221, v117
    v_exp_f32 v222, v118
    v_exp_f32 v223, v119
    v_add_f32 v237, v237, v220
    v_add_f32 v237, v237, v221
    v_cvt_pk_bf16_f32 v166, v220, v221
    v_add_f32 v237, v237, v222
    v_add_f32 v237, v237, v223
    v_cvt_pk_bf16_f32 v167, v222, v223
    s_nop 2
    s_setpc_b64 s[48:49]
L_fbr_1_1_1:
    s_nop 7
    s_nop 3
    v_max3_f32 v224, v136, v137, v138
    v_max3_f32 v224, v224, v139, v144
    v_max3_f32 v224, v224, v145, v146
    v_max_f32 v224, v224, v147
    v_mov_b32 v228, v224
    s_nop 1
    v_permlane32_swap_b32 v228, v224
    v_max_f32 v224, v224, v228
    v_mov_b32 v228, v224
    s_nop 1
    v_permlane16_swap_b32 v228, v224
    v_max_f32 v224, v224, v228
    v_max_f32 v224, 0, v224
    v_ceil_f32 v224, v224
    v_sub_f32 v228, 0, v224
    v_exp_f32 v226, v228
    v_sub_f32 v136, v136, v224
    v_sub_f32 v137, v137, v224
    v_sub_f32 v138, v138, v224
    v_sub_f32 v139, v139, v224
    v_sub_f32 v144, v144, v224
    v_sub_f32 v145, v145, v224
    v_sub_f32 v146, v146, v224
    v_sub_f32 v147, v147, v224
    v_sub_f32 v176, v176, v224
    v_sub_f32 v177, v177, v224
    v_sub_f32 v178, v178, v224
    v_sub_f32 v179, v179, v224
    v_mul_f32 v232, v232, v226
    v_mul_f32 v40, v40, v226
    v_mul_f32 v41, v41, v226
    v_mul_f32 v42, v42, v226
    v_mul_f32 v43, v43, v226
    v_mul_f32 v48, v48, v226
    v_mul_f32 v49, v49, v226
    v_mul_f32 v50, v50, v226
    v_mul_f32 v51, v51, v226
    v_mul_f32 v56, v56, v226
    v_mul_f32 v57, v57, v226
    v_mul_f32 v58, v58, v226
    v_mul_f32 v59, v59, v226
    v_mul_f32 v64, v64, v226
    v_mul_f32 v65, v65, v226
    v_mul_f32 v66, v66, v226
    v_mul_f32 v67, v67, v226
    v_mul_f32 v72, v72, v226
    v_mul_f32 v73, v73, v226
    v_mul_f32 v74, v74, v226
    v_mul_f32 v75, v75, v226
    v_mul_f32 v80, v80, v226
    v_mul_f32 v81, v81, v226
    v_mul_f32 v82, v82, v226
    v_mul_f32 v83, v83, v226
    v_mul_f32 v88, v88, v226
    v_mul_f32 v89, v89, v226
    v_mul_f32 v90, v90, v226
    v_mul_f32 v91, v91, v226
    v_mul_f32 v96, v96, v226
    v_mul_f32 v97, v97, v226
    v_mul_f32 v98, v98, v226
    v_mul_f32 v99, v99, v226
    v_lshlrev_b32 v228, 16, v160
    v_and_b32 v160, 0xffff0000, v160
    v_mul_f32 v228, v228, v226
    v_mul_f32 v160, v160, v226
    v_cvt_pk_bf16_f32 v160, v228, v160
    v_lshlrev_b32 v228, 16, v161
    v_and_b32 v161, 0xffff0000, v161
    v_mul_f32 v228, v228, v226
    v_mul_f32 v161, v161, v226
    v_cvt_pk_bf16_f32 v161, v228, v161
    v_lshlrev_b32 v228, 16, v162
    v_and_b32 v162, 0xffff0000, v162
    v_mul_f32 v228, v228, v226
    v_mul_f32 v162, v162, v226
    v_cvt_pk_bf16_f32 v162, v228, v162
    v_lshlrev_b32 v228, 16, v163
    v_and_b32 v163, 0xffff0000, v163
    v_mul_f32 v228, v228, v226
    v_mul_f32 v163, v163, v226
    v_cvt_pk_bf16_f32 v163, v228, v163
    v_max3_f32 v225, v140, v141, v142
    v_max3_f32 v225, v225, v143, v148
    v_max3_f32 v225, v225, v149, v150
    v_max_f32 v225, v225, v151
    v_mov_b32 v229, v225
    s_nop 1
    v_permlane32_swap_b32 v229, v225
    v_max_f32 v225, v225, v229
    v_mov_b32 v229, v225
    s_nop 1
    v_permlane16_swap_b32 v229, v225
    v_max_f32 v225, v225, v229
    v_max_f32 v225, 0, v225
    v_ceil_f32 v225, v225
    v_sub_f32 v229, 0, v225
    v_exp_f32 v227, v229
    v_sub_f32 v140, v140, v225
    v_sub_f32 v141, v141, v225
    v_sub_f32 v142, v142, v225
    v_sub_f32 v143, v143, v225
    v_sub_f32 v148, v148, v225
    v_sub_f32 v149, v149, v225
    v_sub_f32 v150, v150, v225
    v_sub_f32 v151, v151, v225
    v_sub_f32 v180, v180, v225
    v_sub_f32 v181, v181, v225
    v_sub_f32 v182, v182, v225
    v_sub_f32 v183, v183, v225
    v_mul_f32 v233, v233, v227
    v_mul_f32 v44, v44, v227
    v_mul_f32 v45, v45, v227
    v_mul_f32 v46, v46, v227
    v_mul_f32 v47, v47, v227
    v_mul_f32 v52, v52, v227
    v_mul_f32 v53, v53, v227
    v_mul_f32 v54, v54, v227
    v_mul_f32 v55, v55, v227
    v_mul_f32 v60, v60, v227
    v_mul_f32 v61, v61, v227
    v_mul_f32 v62, v62, v227
    v_mul_f32 v63, v63, v227
    v_mul_f32 v68, v68, v227
    v_mul_f32 v69, v69, v227
    v_mul_f32 v70, v70, v227
    v_mul_f32 v71, v71, v227
    v_mul_f32 v76, v76, v227
    v_mul_f32 v77, v77, v227
    v_mul_f32 v78, v78, v227
    v_mul_f32 v79, v79, v227
    v_mul_f32 v84, v84, v227
    v_mul_f32 v85, v85, v227
    v_mul_f32 v86, v86, v227
    v_mul_f32 v87, v87, v227
    v_mul_f32 v92, v92, v227
    v_mul_f32 v93, v93, v227
    v_mul_f32 v94, v94, v227
    v_mul_f32 v95, v95, v227
    v_mul_f32 v100, v100, v227
    v_mul_f32 v101, v101, v227
    v_mul_f32 v102, v102, v227
    v_mul_f32 v103, v103, v227
    v_lshlrev_b32 v229, 16, v164
    v_and_b32 v164, 0xffff0000, v164
    v_mul_f32 v229, v229, v227
    v_mul_f32 v164, v164, v227
    v_cvt_pk_bf16_f32 v164, v229, v164
    v_lshlrev_b32 v229, 16, v165
    v_and_b32 v165, 0xffff0000, v165
    v_mul_f32 v229, v229, v227
    v_mul_f32 v165, v165, v227
    v_cvt_pk_bf16_f32 v165, v229, v165
    v_lshlrev_b32 v229, 16, v166
    v_and_b32 v166, 0xffff0000, v166
    v_mul_f32 v229, v229, v227
    v_mul_f32 v166, v166, v227
    v_cvt_pk_bf16_f32 v166, v229, v166
    v_lshlrev_b32 v229, 16, v167
    v_and_b32 v167, 0xffff0000, v167
    v_mul_f32 v229, v229, v227
    v_mul_f32 v167, v167, v227
    v_cvt_pk_bf16_f32 v167, v229, v167
    v_exp_f32 v216, v136
    v_exp_f32 v217, v137
    v_exp_f32 v218, v138
    v_exp_f32 v219, v139
    v_add_f32 v236, v216, v217
    v_cvt_pk_bf16_f32 v168, v216, v217
    v_add_f32 v236, v236, v218
    v_add_f32 v236, v236, v219
    v_cvt_pk_bf16_f32 v169, v218, v219
    v_exp_f32 v220, v144
    v_exp_f32 v221, v145
    v_exp_f32 v222, v146
    v_exp_f32 v223, v147
    v_add_f32 v236, v236, v220
    v_add_f32 v236, v236, v221
    v_cvt_pk_bf16_f32 v170, v220, v221
    v_add_f32 v236, v236, v222
    v_add_f32 v236, v236, v223
    v_cvt_pk_bf16_f32 v171, v222, v223
    v_exp_f32 v216, v140
    v_exp_f32 v217, v141
    v_exp_f32 v218, v142
    v_exp_f32 v219, v143
    v_add_f32 v237, v216, v217
    v_cvt_pk_bf16_f32 v172, v216, v217
    v_add_f32 v237, v237, v218
    v_add_f32 v237, v237, v219
    v_cvt_pk_bf16_f32 v173, v218, v219
    v_exp_f32 v220, v148
    v_exp_f32 v221, v149
    v_exp_f32 v222, v150
    v_exp_f32 v223, v151
    v_add_f32 v237, v237, v220
    v_add_f32 v237, v237, v221
    v_cvt_pk_bf16_f32 v174, v220, v221
    v_add_f32 v237, v237, v222
    v_add_f32 v237, v237, v223
    v_cvt_pk_bf16_f32 v175, v222, v223
    s_nop 2
    s_setpc_b64 s[48:49]
L_end:
    s_endpgm
.section .rodata,"a"
.p2align 6
.amdhsa_kernel concat_heads__mha_block_cached__mha_block_cached__near_ridge_kernel
  .amdhsa_next_free_vgpr 256
  .amdhsa_next_free_sgpr 102
  .amdhsa_accum_offset 256
  .amdhsa_group_segment_fixed_size 0
  .amdhsa_kernarg_size 104
  .amdhsa_user_sgpr_count 2
  .amdhsa_user_sgpr_kernarg_segment_ptr 1
  .amdhsa_system_sgpr_workgroup_id_x 1
.end_amdhsa_kernel
```
